```python
import torch

def _softmax(x, axis=-1):
    return torch.softmax(x, dim=axis)

def _gelu(x):
    return torch.nn.functional.gelu(x, approximate='tanh')

def _silu(x):
    return torch.nn.functional.silu(x)

def _sigmoid(x):
    return torch.sigmoid(x)

def _layernorm(x, axis=-1, eps=1e-05):
    m = x.mean(dim=axis, keepdim=True)
    v = x.var(dim=axis, keepdim=True, unbiased=False)
    return (x - m) / torch.sqrt(v + eps)

def _scatter_add(tgt, idx, src, axis=0):
    return tgt.clone().index_add_(axis, idx, src)

def _segment_sum(src, seg, n):
    out = torch.zeros((n,) + src.shape[1:], dtype=src.dtype)
    return out.index_add_(0, seg, src)

def _pad(x, pw):
    flat = tuple((v for pair in reversed(pw) for v in pair))
    return torch.nn.functional.pad(x, flat)
kernel_name = 'sequential_preLN__memory_aug_recurrent_mem_tr__dense_activation_relu__prompt'

def setup_inputs():

    _w = lambda a: (lambda t: t.to(torch.bfloat16) if t.is_floating_point() else t)(torch.as_tensor(a))

    def _A_setup():
        B, S, Dm = (1, 2048, 576)
        H, Dh = (32, 128)
        M, seg = (8, 32)
        seg = min(seg, S)
        S = S // seg * seg
        return {'x': _w((lambda *s: torch.randn(*s, dtype=torch.bfloat16) * 0.05)(B, S, Dm)), 'mem0': _w((lambda *s: torch.randn(*s, dtype=torch.bfloat16) * 0.2)(B, M, Dm)), 'Wq': _w((lambda *s: torch.randn(*s, dtype=torch.bfloat16) * 1.6)(Dm, H, Dh) * Dm ** (-0.5)), 'Wk': _w((lambda *s: torch.randn(*s, dtype=torch.bfloat16) * 1.6)(Dm, H, Dh) * Dm ** (-0.5)), 'Wv': _w((lambda *s: torch.randn(*s, dtype=torch.bfloat16) * 0.2)(Dm, H, Dh) * Dm ** (-0.5)), 'Wo': _w((lambda *s: torch.randn(*s, dtype=torch.bfloat16) * 0.2)(H, Dh, Dm) * (H * Dh) ** (-0.5)), 'seg_len': seg}
    _A_in = _A_setup()

    def _B_setup():
        B, S, D, Dff = (1, 2048, 576, 4608)
        return {'x': _w((lambda *s: torch.randn(*s, dtype=torch.bfloat16) * 0.05)(B, S, D)), 'w1': _w((lambda *s: torch.randn(*s, dtype=torch.bfloat16) * 0.05)(D, Dff)), 'w2': _w((lambda *s: torch.randn(*s, dtype=torch.bfloat16) * 0.05)(Dff, D))}
    _B_in = _B_setup()
    return {'A_x': _A_in['x'], 'A_mem0': _A_in['mem0'], 'A_Wq': _A_in['Wq'], 'A_Wk': _A_in['Wk'], 'A_Wv': _A_in['Wv'], 'A_Wo': _A_in['Wo'], 'A_seg_len': _A_in['seg_len'], 'B_x': _B_in['x'], 'B_w1': _B_in['w1'], 'B_w2': _B_in['w2']}

def reference(A_x, A_mem0, A_Wq, A_Wk, A_Wv, A_Wo, A_seg_len, B_x, B_w1, B_w2):

    def _A_ref(x, mem0, Wq, Wk, Wv, Wo, seg_len):
        B, S, Dm = x.shape
        H, Dh = (Wq.shape[1], Wq.shape[2])
        M = mem0.shape[1]
        scale = Dh ** (-0.5)
        n_seg = S // seg_len
        L = M + seg_len
        idx = torch.arange(L)
        mask = (idx[:, None] < M) | (idx[:, None] >= idx[None, :])
        mem = mem0
        outs = []
        for s in range(n_seg):
            xs = x[:, s * seg_len:(s + 1) * seg_len, :].clone()
            h = torch.concatenate([mem, xs], axis=1)
            q = torch.einsum('btd,dhe->bhte', h, Wq)
            k = torch.einsum('btd,dhe->bhte', h, Wk)
            v = torch.einsum('btd,dhe->bhte', h, Wv)
            scores = torch.einsum('bhqe,bhke->bhqk', q, k) * scale
            scores = torch.where(mask[None, None], scores, -1000000000.0)
            p = _softmax(scores, axis=-1)
            o = torch.einsum('bhqk,bhke->bhqe', p, v)
            o = torch.einsum('bhte,hed->btd', o, Wo)
            mem = o[:, :M, :].clone()
            outs.append(o[:, M:, :])
        return torch.concatenate(outs, axis=1)

    def _B_ref(x, w1, w2):
        h = torch.einsum('bsd,df->bsf', x, w1)
        zero = torch.zeros_like(h)
        h = torch.maximum(h, zero)
        return torch.einsum('bsf,fd->bsd', h, w2)
    x = A_x
    h = x + _A_ref(_layernorm(x, axis=-1), A_mem0, A_Wq, A_Wk, A_Wv, A_Wo, A_seg_len)
    h2 = h + _B_ref(_layernorm(h, axis=-1), B_w1, B_w2)
    return h2
```

```asm
; @launch grid=(256,1,1) block=(256,1,1) lds=163840
.amdgcn_target "amdgcn-amd-amdhsa--gfx950"
.text
.globl sequential_preLN__memory_aug_recurrent_mem_tr__dense_activation_relu__prompt_kernel
.p2align 8
.type sequential_preLN__memory_aug_recurrent_mem_tr__dense_activation_relu__prompt_kernel,@function
sequential_preLN__memory_aug_recurrent_mem_tr__dense_activation_relu__prompt_kernel:

    s_cmp_ge_u32 s2, 256
    s_cbranch_scc1 L_exit
    s_getpc_b64 s[30:31]
L_pcref:
    v_lshrrev_b32 v2, 6, v0
    s_lshr_b32 s32, s2, 3
    s_lshl_b32 s32, s32, 2
    v_add_u32 v2, s32, v2
    s_mov_b32 s33, (L_exit - L_pcref) / 1024
    v_cmp_le_u32 vcc, s33, v2
    v_subrev_u32 v3, s33, v2
    s_nop 0
    v_cndmask_b32 v2, v2, v3, vcc
    v_cmp_le_u32 vcc, s33, v2
    v_subrev_u32 v3, s33, v2
    s_nop 0
    v_cndmask_b32 v2, v2, v3, vcc
    v_min_u32 v2, s33, v2
    v_lshlrev_b32 v2, 10, v2
    v_and_b32 v3, 63, v0
    v_lshlrev_b32 v3, 4, v3
    v_add_u32 v2, v2, v3
    v_min_u32 v2, (L_exit - L_pcref - 16), v2
    global_load_dwordx4 v[200:203], v2, s[30:31]
    s_load_dwordx2 s[4:5], s[0:1], 88
    s_load_dwordx2 s[6:7], s[0:1], 96
    s_getreg_b32 s3, hwreg(HW_REG_XCC_ID)
    s_and_b32 s3, s3, 7
    v_lshrrev_b32 v1, 6, v0
    s_waitcnt lgkmcnt(0)
    s_mov_b32 s8, s6
    s_mov_b32 s9, s7
    s_mov_b32 s10, 268435456
    s_mov_b32 s11, 0x20000
    s_mov_b32 s16, s4
    s_mov_b32 s17, s5
    s_mov_b32 s18, 256
    s_mov_b32 s19, 0x20000
    v_readfirstlane_b32 s20, v1
    s_mov_b32 s23, 0
    s_cmp_lg_u32 s20, 0
    s_cbranch_scc1 L_norank
    s_lshl_b32 s24, s3, 2
    v_mov_b32 v3, s24
    v_mov_b32 v4, 1
    s_mov_b64 exec, 1
    buffer_atomic_add v4, v3, s[16:19], 0 offen sc0 sc1
    s_waitcnt vmcnt(0)
    v_readfirstlane_b32 s25, v4
    s_mov_b32 s26, 0
    s_cmp_eq_u32 s3, 0
    s_cselect_b32 s27, 1, 0
    s_cmp_lt_u32 s25, 32
    s_cselect_b32 s27, s27, 0
    s_cmp_eq_u32 s27, 1
    s_cbranch_scc1 L_have
    v_mov_b32 v3, 32
    v_mov_b32 v4, 1
    buffer_atomic_add v4, v3, s[16:19], 0 offen sc0 sc1
    s_waitcnt vmcnt(0)
    v_readfirstlane_b32 s25, v4
    s_mov_b32 s26, 1
    s_cmp_lt_u32 s25, 224
    s_cbranch_scc1 L_have
    s_mov_b32 s26, 2
    s_cmp_gt_u32 s25, 255
    s_cbranch_scc1 L_have
    s_sub_u32 s25, 255, s25
    s_mov_b32 s26, 0
    v_mov_b32 v3, 40
    v_mov_b32 v4, 1
    buffer_atomic_add v4, v3, s[16:19], 0 offen sc1
    s_waitcnt vmcnt(0)
L_have:
    s_mov_b64 exec, -1
    s_lshl_b32 s26, s26, 16
    s_or_b32 s25, s25, s26
    v_mov_b32 v5, s25
    v_mov_b32 v6, 0
    ds_write_b32 v6, v5
    s_waitcnt lgkmcnt(0)
L_norank:
    s_barrier
    v_mov_b32 v6, 0
    ds_read_b32 v5, v6
    s_waitcnt lgkmcnt(0)
    v_readfirstlane_b32 s25, v5
    s_barrier
    s_and_b32 s21, s25, 0xffff
    s_lshr_b32 s26, s25, 16
    s_cmp_eq_u32 s26, 0
    s_cbranch_scc1 L_team
    s_cmp_eq_u32 s26, 2
    s_cbranch_scc1 L_end
    s_cmp_lg_u32 s21, 0
    s_cbranch_scc1 L_noinit
    v_and_b32 v1, 63, v0
    v_lshlrev_b32 v1, 4, v1
    v_mov_b32 v4, 0
    v_mov_b32 v5, 0
    v_mov_b32 v6, 0
    v_mov_b32 v7, 0
    s_mul_i32 s24, s20, 26624
    s_add_u32 s24, s24, 6029312
    buffer_store_dwordx4 v[4:7], v1, s[8:11], s24 offen sc1
    s_add_u32 s24, s24, 1024
    buffer_store_dwordx4 v[4:7], v1, s[8:11], s24 offen sc1
    s_add_u32 s24, s24, 1024
    buffer_store_dwordx4 v[4:7], v1, s[8:11], s24 offen sc1
    s_add_u32 s24, s24, 1024
    buffer_store_dwordx4 v[4:7], v1, s[8:11], s24 offen sc1
    s_add_u32 s24, s24, 1024
    buffer_store_dwordx4 v[4:7], v1, s[8:11], s24 offen sc1
    s_add_u32 s24, s24, 1024
    buffer_store_dwordx4 v[4:7], v1, s[8:11], s24 offen sc1
    s_add_u32 s24, s24, 1024
    buffer_store_dwordx4 v[4:7], v1, s[8:11], s24 offen sc1
    s_add_u32 s24, s24, 1024
    buffer_store_dwordx4 v[4:7], v1, s[8:11], s24 offen sc1
    s_add_u32 s24, s24, 1024
    buffer_store_dwordx4 v[4:7], v1, s[8:11], s24 offen sc1
    s_add_u32 s24, s24, 1024
    buffer_store_dwordx4 v[4:7], v1, s[8:11], s24 offen sc1
    s_add_u32 s24, s24, 1024
    buffer_store_dwordx4 v[4:7], v1, s[8:11], s24 offen sc1
    s_add_u32 s24, s24, 1024
    buffer_store_dwordx4 v[4:7], v1, s[8:11], s24 offen sc1
    s_add_u32 s24, s24, 1024
    buffer_store_dwordx4 v[4:7], v1, s[8:11], s24 offen sc1
    s_add_u32 s24, s24, 1024
    buffer_store_dwordx4 v[4:7], v1, s[8:11], s24 offen sc1
    s_add_u32 s24, s24, 1024
    buffer_store_dwordx4 v[4:7], v1, s[8:11], s24 offen sc1
    s_add_u32 s24, s24, 1024
    buffer_store_dwordx4 v[4:7], v1, s[8:11], s24 offen sc1
    s_add_u32 s24, s24, 1024
    buffer_store_dwordx4 v[4:7], v1, s[8:11], s24 offen sc1
    s_add_u32 s24, s24, 1024
    buffer_store_dwordx4 v[4:7], v1, s[8:11], s24 offen sc1
    s_add_u32 s24, s24, 1024
    buffer_store_dwordx4 v[4:7], v1, s[8:11], s24 offen sc1
    s_add_u32 s24, s24, 1024
    buffer_store_dwordx4 v[4:7], v1, s[8:11], s24 offen sc1
    s_add_u32 s24, s24, 1024
    buffer_store_dwordx4 v[4:7], v1, s[8:11], s24 offen sc1
    s_add_u32 s24, s24, 1024
    buffer_store_dwordx4 v[4:7], v1, s[8:11], s24 offen sc1
    s_add_u32 s24, s24, 1024
    buffer_store_dwordx4 v[4:7], v1, s[8:11], s24 offen sc1
    s_add_u32 s24, s24, 1024
    buffer_store_dwordx4 v[4:7], v1, s[8:11], s24 offen sc1
    s_add_u32 s24, s24, 1024
    buffer_store_dwordx4 v[4:7], v1, s[8:11], s24 offen sc1
    s_add_u32 s24, s24, 1024
    buffer_store_dwordx4 v[4:7], v1, s[8:11], s24 offen sc1
    s_add_u32 s24, s24, 1024
    s_waitcnt vmcnt(0)
    s_barrier
    s_cmp_lg_u32 s20, 0
    s_cbranch_scc1 L_noinit
    s_mov_b64 exec, 1
    v_mov_b32 v3, 44
    v_mov_b32 v4, 1
    buffer_atomic_add v4, v3, s[16:19], 0 offen sc1
    s_mov_b64 exec, -1
L_noinit:
    s_cmp_lt_u32 s21, 96
    s_cbranch_scc1 L_t1
    s_cmp_lt_u32 s21, 128
    s_cbranch_scc1 L_alpha
    s_cmp_lt_u32 s21, 164
    s_cbranch_scc1 L_ffn
    s_mov_b32 s58, s21
    s_sub_u32 s21, s21, 164
    s_mov_b64 exec, 1
    v_mov_b32 v250, 44
Lwi_1:
    buffer_load_dword v251, v250, s[16:19], 0 offen sc1
    s_waitcnt vmcnt(0)
    v_readfirstlane_b32 s38, v251
    s_cmp_lg_u32 s38, 0
    s_cbranch_scc1 Lwi_2
    s_add_u32 s23, s23, 1
    s_cmp_gt_u32 s23, 3000000
    s_cbranch_scc1 L_wfail
    s_sleep 1
    s_branch Lwi_1
Lwi_2:
    s_mov_b64 exec, -1
    s_load_dwordx2 s[24:25], s[0:1], 0
    s_waitcnt lgkmcnt(0)
    s_mov_b32 s40, s24
    s_mov_b32 s41, s25
    s_mov_b32 s42, 2359296
    s_mov_b32 s43, 0x20000
    v_and_b32 v1, 63, v0
    v_lshrrev_b32 v2, 3, v1
    v_and_b32 v3, 7, v1
    s_lshl_b32 s24, s20, 3
    v_add_u32 v4, s24, v2
    v_mul_u32_u24 v5, 1152, v4
    v_lshlrev_b32 v6, 4, v3
    v_add_u32 v5, v5, v6
    v_lshrrev_b32 v6, 1, v3
    v_lshlrev_b32 v7, 10, v6
    v_and_b32 v8, 1, v3
    v_lshlrev_b32 v9, 9, v8
    v_lshlrev_b32 v10, 4, v4
    v_add3_u32 v7, v7, v9, v10
    v_lshrrev_b32 v9, 2, v4
    v_mul_u32_u24 v9, 4608, v9
    v_and_b32 v10, 3, v4
    v_lshlrev_b32 v10, 4, v10
    v_lshlrev_b32 v11, 7, v6
    v_lshlrev_b32 v12, 3, v8
    v_add3_u32 v9, v9, v10, v11
    v_add_u32 v9, v9, v12
    s_mov_b32 s22, s21
Lln_3:
    s_cmp_ge_u32 s22, 64
    s_cbranch_scc1 Lln_4
    s_mul_i32 s24, s22, 36864
    buffer_load_dwordx4 v[32:35], v5, s[40:43], s24 offen offset:0 nt
    buffer_load_dwordx4 v[36:39], v5, s[40:43], s24 offen offset:128 nt
    buffer_load_dwordx4 v[40:43], v5, s[40:43], s24 offen offset:256 nt
    buffer_load_dwordx4 v[44:47], v5, s[40:43], s24 offen offset:384 nt
    buffer_load_dwordx4 v[48:51], v5, s[40:43], s24 offen offset:512 nt
    buffer_load_dwordx4 v[52:55], v5, s[40:43], s24 offen offset:640 nt
    buffer_load_dwordx4 v[56:59], v5, s[40:43], s24 offen offset:768 nt
    buffer_load_dwordx4 v[60:63], v5, s[40:43], s24 offen offset:896 nt
    buffer_load_dwordx4 v[64:67], v5, s[40:43], s24 offen offset:1024 nt
    s_add_u32 s25, s24, 3670016
    s_add_u32 s26, s25, 4096
    s_waitcnt vmcnt(0)
    buffer_store_dwordx2 v[32:33], v9, s[8:11], s25 offen offset:0 sc1
    buffer_store_dwordx2 v[34:35], v9, s[8:11], s25 offen offset:64 sc1
    buffer_store_dwordx2 v[36:37], v9, s[8:11], s25 offen offset:512 sc1
    buffer_store_dwordx2 v[38:39], v9, s[8:11], s25 offen offset:576 sc1
    buffer_store_dwordx2 v[40:41], v9, s[8:11], s25 offen offset:1024 sc1
    buffer_store_dwordx2 v[42:43], v9, s[8:11], s25 offen offset:1088 sc1
    buffer_store_dwordx2 v[44:45], v9, s[8:11], s25 offen offset:1536 sc1
    buffer_store_dwordx2 v[46:47], v9, s[8:11], s25 offen offset:1600 sc1
    buffer_store_dwordx2 v[48:49], v9, s[8:11], s25 offen offset:2048 sc1
    buffer_store_dwordx2 v[50:51], v9, s[8:11], s25 offen offset:2112 sc1
    buffer_store_dwordx2 v[52:53], v9, s[8:11], s25 offen offset:2560 sc1
    buffer_store_dwordx2 v[54:55], v9, s[8:11], s25 offen offset:2624 sc1
    buffer_store_dwordx2 v[56:57], v9, s[8:11], s25 offen offset:3072 sc1
    buffer_store_dwordx2 v[58:59], v9, s[8:11], s25 offen offset:3136 sc1
    buffer_store_dwordx2 v[60:61], v9, s[8:11], s25 offen offset:3584 sc1
    buffer_store_dwordx2 v[62:63], v9, s[8:11], s25 offen offset:3648 sc1
    buffer_store_dwordx2 v[64:65], v9, s[8:11], s26 offen offset:0 sc1
    buffer_store_dwordx2 v[66:67], v9, s[8:11], s26 offen offset:64 sc1
    v_lshlrev_b32 v80, 16, v32
    v_and_b32 v81, 0xffff0000, v32
    v_lshlrev_b32 v82, 16, v33
    v_and_b32 v83, 0xffff0000, v33
    v_lshlrev_b32 v84, 16, v34
    v_and_b32 v85, 0xffff0000, v34
    v_lshlrev_b32 v86, 16, v35
    v_and_b32 v87, 0xffff0000, v35
    v_lshlrev_b32 v88, 16, v36
    v_and_b32 v89, 0xffff0000, v36
    v_lshlrev_b32 v90, 16, v37
    v_and_b32 v91, 0xffff0000, v37
    v_lshlrev_b32 v92, 16, v38
    v_and_b32 v93, 0xffff0000, v38
    v_lshlrev_b32 v94, 16, v39
    v_and_b32 v95, 0xffff0000, v39
    v_lshlrev_b32 v96, 16, v40
    v_and_b32 v97, 0xffff0000, v40
    v_lshlrev_b32 v98, 16, v41
    v_and_b32 v99, 0xffff0000, v41
    v_lshlrev_b32 v100, 16, v42
    v_and_b32 v101, 0xffff0000, v42
    v_lshlrev_b32 v102, 16, v43
    v_and_b32 v103, 0xffff0000, v43
    v_lshlrev_b32 v104, 16, v44
    v_and_b32 v105, 0xffff0000, v44
    v_lshlrev_b32 v106, 16, v45
    v_and_b32 v107, 0xffff0000, v45
    v_lshlrev_b32 v108, 16, v46
    v_and_b32 v109, 0xffff0000, v46
    v_lshlrev_b32 v110, 16, v47
    v_and_b32 v111, 0xffff0000, v47
    v_lshlrev_b32 v112, 16, v48
    v_and_b32 v113, 0xffff0000, v48
    v_lshlrev_b32 v114, 16, v49
    v_and_b32 v115, 0xffff0000, v49
    v_lshlrev_b32 v116, 16, v50
    v_and_b32 v117, 0xffff0000, v50
    v_lshlrev_b32 v118, 16, v51
    v_and_b32 v119, 0xffff0000, v51
    v_lshlrev_b32 v120, 16, v52
    v_and_b32 v121, 0xffff0000, v52
    v_lshlrev_b32 v122, 16, v53
    v_and_b32 v123, 0xffff0000, v53
    v_lshlrev_b32 v124, 16, v54
    v_and_b32 v125, 0xffff0000, v54
    v_lshlrev_b32 v126, 16, v55
    v_and_b32 v127, 0xffff0000, v55
    v_lshlrev_b32 v128, 16, v56
    v_and_b32 v129, 0xffff0000, v56
    v_lshlrev_b32 v130, 16, v57
    v_and_b32 v131, 0xffff0000, v57
    v_lshlrev_b32 v132, 16, v58
    v_and_b32 v133, 0xffff0000, v58
    v_lshlrev_b32 v134, 16, v59
    v_and_b32 v135, 0xffff0000, v59
    v_lshlrev_b32 v136, 16, v60
    v_and_b32 v137, 0xffff0000, v60
    v_lshlrev_b32 v138, 16, v61
    v_and_b32 v139, 0xffff0000, v61
    v_lshlrev_b32 v140, 16, v62
    v_and_b32 v141, 0xffff0000, v62
    v_lshlrev_b32 v142, 16, v63
    v_and_b32 v143, 0xffff0000, v63
    v_lshlrev_b32 v144, 16, v64
    v_and_b32 v145, 0xffff0000, v64
    v_lshlrev_b32 v146, 16, v65
    v_and_b32 v147, 0xffff0000, v65
    v_lshlrev_b32 v148, 16, v66
    v_and_b32 v149, 0xffff0000, v66
    v_lshlrev_b32 v150, 16, v67
    v_and_b32 v151, 0xffff0000, v67
    v_pk_add_f32 v[14:15], v[80:81], v[82:83]
    v_pk_add_f32 v[14:15], v[14:15], v[84:85]
    v_pk_add_f32 v[14:15], v[14:15], v[86:87]
    v_pk_add_f32 v[14:15], v[14:15], v[88:89]
    v_pk_add_f32 v[14:15], v[14:15], v[90:91]
    v_pk_add_f32 v[14:15], v[14:15], v[92:93]
    v_pk_add_f32 v[14:15], v[14:15], v[94:95]
    v_pk_add_f32 v[14:15], v[14:15], v[96:97]
    v_pk_add_f32 v[14:15], v[14:15], v[98:99]
    v_pk_add_f32 v[14:15], v[14:15], v[100:101]
    v_pk_add_f32 v[14:15], v[14:15], v[102:103]
    v_pk_add_f32 v[14:15], v[14:15], v[104:105]
    v_pk_add_f32 v[14:15], v[14:15], v[106:107]
    v_pk_add_f32 v[14:15], v[14:15], v[108:109]
    v_pk_add_f32 v[14:15], v[14:15], v[110:111]
    v_pk_add_f32 v[14:15], v[14:15], v[112:113]
    v_pk_add_f32 v[14:15], v[14:15], v[114:115]
    v_pk_add_f32 v[14:15], v[14:15], v[116:117]
    v_pk_add_f32 v[14:15], v[14:15], v[118:119]
    v_pk_add_f32 v[14:15], v[14:15], v[120:121]
    v_pk_add_f32 v[14:15], v[14:15], v[122:123]
    v_pk_add_f32 v[14:15], v[14:15], v[124:125]
    v_pk_add_f32 v[14:15], v[14:15], v[126:127]
    v_pk_add_f32 v[14:15], v[14:15], v[128:129]
    v_pk_add_f32 v[14:15], v[14:15], v[130:131]
    v_pk_add_f32 v[14:15], v[14:15], v[132:133]
    v_pk_add_f32 v[14:15], v[14:15], v[134:135]
    v_pk_add_f32 v[14:15], v[14:15], v[136:137]
    v_pk_add_f32 v[14:15], v[14:15], v[138:139]
    v_pk_add_f32 v[14:15], v[14:15], v[140:141]
    v_pk_add_f32 v[14:15], v[14:15], v[142:143]
    v_pk_add_f32 v[14:15], v[14:15], v[144:145]
    v_pk_add_f32 v[14:15], v[14:15], v[146:147]
    v_pk_add_f32 v[14:15], v[14:15], v[148:149]
    v_pk_add_f32 v[14:15], v[14:15], v[150:151]
    v_add_f32 v14, v14, v15
    s_nop 1
    v_add_f32_dpp v14, v14, v14 quad_perm:[1,0,3,2] row_mask:0xf bank_mask:0xf
    s_nop 1
    v_add_f32_dpp v14, v14, v14 quad_perm:[2,3,0,1] row_mask:0xf bank_mask:0xf
    s_nop 1
    v_add_f32_dpp v14, v14, v14 row_half_mirror row_mask:0xf bank_mask:0xf
    v_mul_f32 v14, 0x3ae38e39, v14
    v_mov_b32 v16, 0
    v_mov_b32 v17, 0
    v_pk_add_f32 v[18:19], v[80:81], v[14:15] op_sel_hi:[1,0] neg_lo:[0,1] neg_hi:[0,1]
    v_pk_fma_f32 v[16:17], v[18:19], v[18:19], v[16:17]
    v_pk_add_f32 v[18:19], v[82:83], v[14:15] op_sel_hi:[1,0] neg_lo:[0,1] neg_hi:[0,1]
    v_pk_fma_f32 v[16:17], v[18:19], v[18:19], v[16:17]
    v_pk_add_f32 v[18:19], v[84:85], v[14:15] op_sel_hi:[1,0] neg_lo:[0,1] neg_hi:[0,1]
    v_pk_fma_f32 v[16:17], v[18:19], v[18:19], v[16:17]
    v_pk_add_f32 v[18:19], v[86:87], v[14:15] op_sel_hi:[1,0] neg_lo:[0,1] neg_hi:[0,1]
    v_pk_fma_f32 v[16:17], v[18:19], v[18:19], v[16:17]
    v_pk_add_f32 v[18:19], v[88:89], v[14:15] op_sel_hi:[1,0] neg_lo:[0,1] neg_hi:[0,1]
    v_pk_fma_f32 v[16:17], v[18:19], v[18:19], v[16:17]
    v_pk_add_f32 v[18:19], v[90:91], v[14:15] op_sel_hi:[1,0] neg_lo:[0,1] neg_hi:[0,1]
    v_pk_fma_f32 v[16:17], v[18:19], v[18:19], v[16:17]
    v_pk_add_f32 v[18:19], v[92:93], v[14:15] op_sel_hi:[1,0] neg_lo:[0,1] neg_hi:[0,1]
    v_pk_fma_f32 v[16:17], v[18:19], v[18:19], v[16:17]
    v_pk_add_f32 v[18:19], v[94:95], v[14:15] op_sel_hi:[1,0] neg_lo:[0,1] neg_hi:[0,1]
    v_pk_fma_f32 v[16:17], v[18:19], v[18:19], v[16:17]
    v_pk_add_f32 v[18:19], v[96:97], v[14:15] op_sel_hi:[1,0] neg_lo:[0,1] neg_hi:[0,1]
    v_pk_fma_f32 v[16:17], v[18:19], v[18:19], v[16:17]
    v_pk_add_f32 v[18:19], v[98:99], v[14:15] op_sel_hi:[1,0] neg_lo:[0,1] neg_hi:[0,1]
    v_pk_fma_f32 v[16:17], v[18:19], v[18:19], v[16:17]
    v_pk_add_f32 v[18:19], v[100:101], v[14:15] op_sel_hi:[1,0] neg_lo:[0,1] neg_hi:[0,1]
    v_pk_fma_f32 v[16:17], v[18:19], v[18:19], v[16:17]
    v_pk_add_f32 v[18:19], v[102:103], v[14:15] op_sel_hi:[1,0] neg_lo:[0,1] neg_hi:[0,1]
    v_pk_fma_f32 v[16:17], v[18:19], v[18:19], v[16:17]
    v_pk_add_f32 v[18:19], v[104:105], v[14:15] op_sel_hi:[1,0] neg_lo:[0,1] neg_hi:[0,1]
    v_pk_fma_f32 v[16:17], v[18:19], v[18:19], v[16:17]
    v_pk_add_f32 v[18:19], v[106:107], v[14:15] op_sel_hi:[1,0] neg_lo:[0,1] neg_hi:[0,1]
    v_pk_fma_f32 v[16:17], v[18:19], v[18:19], v[16:17]
    v_pk_add_f32 v[18:19], v[108:109], v[14:15] op_sel_hi:[1,0] neg_lo:[0,1] neg_hi:[0,1]
    v_pk_fma_f32 v[16:17], v[18:19], v[18:19], v[16:17]
    v_pk_add_f32 v[18:19], v[110:111], v[14:15] op_sel_hi:[1,0] neg_lo:[0,1] neg_hi:[0,1]
    v_pk_fma_f32 v[16:17], v[18:19], v[18:19], v[16:17]
    v_pk_add_f32 v[18:19], v[112:113], v[14:15] op_sel_hi:[1,0] neg_lo:[0,1] neg_hi:[0,1]
    v_pk_fma_f32 v[16:17], v[18:19], v[18:19], v[16:17]
    v_pk_add_f32 v[18:19], v[114:115], v[14:15] op_sel_hi:[1,0] neg_lo:[0,1] neg_hi:[0,1]
    v_pk_fma_f32 v[16:17], v[18:19], v[18:19], v[16:17]
    v_pk_add_f32 v[18:19], v[116:117], v[14:15] op_sel_hi:[1,0] neg_lo:[0,1] neg_hi:[0,1]
    v_pk_fma_f32 v[16:17], v[18:19], v[18:19], v[16:17]
    v_pk_add_f32 v[18:19], v[118:119], v[14:15] op_sel_hi:[1,0] neg_lo:[0,1] neg_hi:[0,1]
    v_pk_fma_f32 v[16:17], v[18:19], v[18:19], v[16:17]
    v_pk_add_f32 v[18:19], v[120:121], v[14:15] op_sel_hi:[1,0] neg_lo:[0,1] neg_hi:[0,1]
    v_pk_fma_f32 v[16:17], v[18:19], v[18:19], v[16:17]
    v_pk_add_f32 v[18:19], v[122:123], v[14:15] op_sel_hi:[1,0] neg_lo:[0,1] neg_hi:[0,1]
    v_pk_fma_f32 v[16:17], v[18:19], v[18:19], v[16:17]
    v_pk_add_f32 v[18:19], v[124:125], v[14:15] op_sel_hi:[1,0] neg_lo:[0,1] neg_hi:[0,1]
    v_pk_fma_f32 v[16:17], v[18:19], v[18:19], v[16:17]
    v_pk_add_f32 v[18:19], v[126:127], v[14:15] op_sel_hi:[1,0] neg_lo:[0,1] neg_hi:[0,1]
    v_pk_fma_f32 v[16:17], v[18:19], v[18:19], v[16:17]
    v_pk_add_f32 v[18:19], v[128:129], v[14:15] op_sel_hi:[1,0] neg_lo:[0,1] neg_hi:[0,1]
    v_pk_fma_f32 v[16:17], v[18:19], v[18:19], v[16:17]
    v_pk_add_f32 v[18:19], v[130:131], v[14:15] op_sel_hi:[1,0] neg_lo:[0,1] neg_hi:[0,1]
    v_pk_fma_f32 v[16:17], v[18:19], v[18:19], v[16:17]
    v_pk_add_f32 v[18:19], v[132:133], v[14:15] op_sel_hi:[1,0] neg_lo:[0,1] neg_hi:[0,1]
    v_pk_fma_f32 v[16:17], v[18:19], v[18:19], v[16:17]
    v_pk_add_f32 v[18:19], v[134:135], v[14:15] op_sel_hi:[1,0] neg_lo:[0,1] neg_hi:[0,1]
    v_pk_fma_f32 v[16:17], v[18:19], v[18:19], v[16:17]
    v_pk_add_f32 v[18:19], v[136:137], v[14:15] op_sel_hi:[1,0] neg_lo:[0,1] neg_hi:[0,1]
    v_pk_fma_f32 v[16:17], v[18:19], v[18:19], v[16:17]
    v_pk_add_f32 v[18:19], v[138:139], v[14:15] op_sel_hi:[1,0] neg_lo:[0,1] neg_hi:[0,1]
    v_pk_fma_f32 v[16:17], v[18:19], v[18:19], v[16:17]
    v_pk_add_f32 v[18:19], v[140:141], v[14:15] op_sel_hi:[1,0] neg_lo:[0,1] neg_hi:[0,1]
    v_pk_fma_f32 v[16:17], v[18:19], v[18:19], v[16:17]
    v_pk_add_f32 v[18:19], v[142:143], v[14:15] op_sel_hi:[1,0] neg_lo:[0,1] neg_hi:[0,1]
    v_pk_fma_f32 v[16:17], v[18:19], v[18:19], v[16:17]
    v_pk_add_f32 v[18:19], v[144:145], v[14:15] op_sel_hi:[1,0] neg_lo:[0,1] neg_hi:[0,1]
    v_pk_fma_f32 v[16:17], v[18:19], v[18:19], v[16:17]
    v_pk_add_f32 v[18:19], v[146:147], v[14:15] op_sel_hi:[1,0] neg_lo:[0,1] neg_hi:[0,1]
    v_pk_fma_f32 v[16:17], v[18:19], v[18:19], v[16:17]
    v_pk_add_f32 v[18:19], v[148:149], v[14:15] op_sel_hi:[1,0] neg_lo:[0,1] neg_hi:[0,1]
    v_pk_fma_f32 v[16:17], v[18:19], v[18:19], v[16:17]
    v_pk_add_f32 v[18:19], v[150:151], v[14:15] op_sel_hi:[1,0] neg_lo:[0,1] neg_hi:[0,1]
    v_pk_fma_f32 v[16:17], v[18:19], v[18:19], v[16:17]
    v_add_f32 v16, v16, v17
    s_nop 1
    v_add_f32_dpp v16, v16, v16 quad_perm:[1,0,3,2] row_mask:0xf bank_mask:0xf
    s_nop 1
    v_add_f32_dpp v16, v16, v16 quad_perm:[2,3,0,1] row_mask:0xf bank_mask:0xf
    s_nop 1
    v_add_f32_dpp v16, v16, v16 row_half_mirror row_mask:0xf bank_mask:0xf
    v_mul_f32 v16, 0x3ae38e39, v16
    v_cvt_pk_bf16_f32 v17, v16, v16
    v_lshlrev_b32 v16, 16, v17
    v_add_f32 v16, 0x3727c5ac, v16
    v_cvt_pk_bf16_f32 v17, v16, v16
    v_lshlrev_b32 v16, 16, v17
    v_sqrt_f32 v16, v16
    s_nop 0
    v_cvt_pk_bf16_f32 v17, v16, v16
    v_lshlrev_b32 v16, 16, v17
    v_rcp_f32 v16, v16
    v_cvt_pk_bf16_f32 v17, v14, v14
    v_lshlrev_b32 v14, 16, v17
    v_pk_add_f32 v[18:19], v[80:81], v[14:15] op_sel_hi:[1,0] neg_lo:[0,1] neg_hi:[0,1]
    v_cvt_pk_bf16_f32 v20, v18, v19
    v_lshlrev_b32 v18, 16, v20
    v_and_b32 v19, 0xffff0000, v20
    v_pk_mul_f32 v[18:19], v[18:19], v[16:17] op_sel_hi:[1,0]
    v_cvt_pk_bf16_f32 v32, v18, v19
    v_pk_add_f32 v[18:19], v[82:83], v[14:15] op_sel_hi:[1,0] neg_lo:[0,1] neg_hi:[0,1]
    v_cvt_pk_bf16_f32 v20, v18, v19
    v_lshlrev_b32 v18, 16, v20
    v_and_b32 v19, 0xffff0000, v20
    v_pk_mul_f32 v[18:19], v[18:19], v[16:17] op_sel_hi:[1,0]
    v_cvt_pk_bf16_f32 v33, v18, v19
    v_pk_add_f32 v[18:19], v[84:85], v[14:15] op_sel_hi:[1,0] neg_lo:[0,1] neg_hi:[0,1]
    v_cvt_pk_bf16_f32 v20, v18, v19
    v_lshlrev_b32 v18, 16, v20
    v_and_b32 v19, 0xffff0000, v20
    v_pk_mul_f32 v[18:19], v[18:19], v[16:17] op_sel_hi:[1,0]
    v_cvt_pk_bf16_f32 v34, v18, v19
    v_pk_add_f32 v[18:19], v[86:87], v[14:15] op_sel_hi:[1,0] neg_lo:[0,1] neg_hi:[0,1]
    v_cvt_pk_bf16_f32 v20, v18, v19
    v_lshlrev_b32 v18, 16, v20
    v_and_b32 v19, 0xffff0000, v20
    v_pk_mul_f32 v[18:19], v[18:19], v[16:17] op_sel_hi:[1,0]
    v_cvt_pk_bf16_f32 v35, v18, v19
    v_pk_add_f32 v[18:19], v[88:89], v[14:15] op_sel_hi:[1,0] neg_lo:[0,1] neg_hi:[0,1]
    v_cvt_pk_bf16_f32 v20, v18, v19
    v_lshlrev_b32 v18, 16, v20
    v_and_b32 v19, 0xffff0000, v20
    v_pk_mul_f32 v[18:19], v[18:19], v[16:17] op_sel_hi:[1,0]
    v_cvt_pk_bf16_f32 v36, v18, v19
    v_pk_add_f32 v[18:19], v[90:91], v[14:15] op_sel_hi:[1,0] neg_lo:[0,1] neg_hi:[0,1]
    v_cvt_pk_bf16_f32 v20, v18, v19
    v_lshlrev_b32 v18, 16, v20
    v_and_b32 v19, 0xffff0000, v20
    v_pk_mul_f32 v[18:19], v[18:19], v[16:17] op_sel_hi:[1,0]
    v_cvt_pk_bf16_f32 v37, v18, v19
    v_pk_add_f32 v[18:19], v[92:93], v[14:15] op_sel_hi:[1,0] neg_lo:[0,1] neg_hi:[0,1]
    v_cvt_pk_bf16_f32 v20, v18, v19
    v_lshlrev_b32 v18, 16, v20
    v_and_b32 v19, 0xffff0000, v20
    v_pk_mul_f32 v[18:19], v[18:19], v[16:17] op_sel_hi:[1,0]
    v_cvt_pk_bf16_f32 v38, v18, v19
    v_pk_add_f32 v[18:19], v[94:95], v[14:15] op_sel_hi:[1,0] neg_lo:[0,1] neg_hi:[0,1]
    v_cvt_pk_bf16_f32 v20, v18, v19
    v_lshlrev_b32 v18, 16, v20
    v_and_b32 v19, 0xffff0000, v20
    v_pk_mul_f32 v[18:19], v[18:19], v[16:17] op_sel_hi:[1,0]
    v_cvt_pk_bf16_f32 v39, v18, v19
    v_pk_add_f32 v[18:19], v[96:97], v[14:15] op_sel_hi:[1,0] neg_lo:[0,1] neg_hi:[0,1]
    v_cvt_pk_bf16_f32 v20, v18, v19
    v_lshlrev_b32 v18, 16, v20
    v_and_b32 v19, 0xffff0000, v20
    v_pk_mul_f32 v[18:19], v[18:19], v[16:17] op_sel_hi:[1,0]
    v_cvt_pk_bf16_f32 v40, v18, v19
    v_pk_add_f32 v[18:19], v[98:99], v[14:15] op_sel_hi:[1,0] neg_lo:[0,1] neg_hi:[0,1]
    v_cvt_pk_bf16_f32 v20, v18, v19
    v_lshlrev_b32 v18, 16, v20
    v_and_b32 v19, 0xffff0000, v20
    v_pk_mul_f32 v[18:19], v[18:19], v[16:17] op_sel_hi:[1,0]
    v_cvt_pk_bf16_f32 v41, v18, v19
    v_pk_add_f32 v[18:19], v[100:101], v[14:15] op_sel_hi:[1,0] neg_lo:[0,1] neg_hi:[0,1]
    v_cvt_pk_bf16_f32 v20, v18, v19
    v_lshlrev_b32 v18, 16, v20
    v_and_b32 v19, 0xffff0000, v20
    v_pk_mul_f32 v[18:19], v[18:19], v[16:17] op_sel_hi:[1,0]
    v_cvt_pk_bf16_f32 v42, v18, v19
    v_pk_add_f32 v[18:19], v[102:103], v[14:15] op_sel_hi:[1,0] neg_lo:[0,1] neg_hi:[0,1]
    v_cvt_pk_bf16_f32 v20, v18, v19
    v_lshlrev_b32 v18, 16, v20
    v_and_b32 v19, 0xffff0000, v20
    v_pk_mul_f32 v[18:19], v[18:19], v[16:17] op_sel_hi:[1,0]
    v_cvt_pk_bf16_f32 v43, v18, v19
    v_pk_add_f32 v[18:19], v[104:105], v[14:15] op_sel_hi:[1,0] neg_lo:[0,1] neg_hi:[0,1]
    v_cvt_pk_bf16_f32 v20, v18, v19
    v_lshlrev_b32 v18, 16, v20
    v_and_b32 v19, 0xffff0000, v20
    v_pk_mul_f32 v[18:19], v[18:19], v[16:17] op_sel_hi:[1,0]
    v_cvt_pk_bf16_f32 v44, v18, v19
    v_pk_add_f32 v[18:19], v[106:107], v[14:15] op_sel_hi:[1,0] neg_lo:[0,1] neg_hi:[0,1]
    v_cvt_pk_bf16_f32 v20, v18, v19
    v_lshlrev_b32 v18, 16, v20
    v_and_b32 v19, 0xffff0000, v20
    v_pk_mul_f32 v[18:19], v[18:19], v[16:17] op_sel_hi:[1,0]
    v_cvt_pk_bf16_f32 v45, v18, v19
    v_pk_add_f32 v[18:19], v[108:109], v[14:15] op_sel_hi:[1,0] neg_lo:[0,1] neg_hi:[0,1]
    v_cvt_pk_bf16_f32 v20, v18, v19
    v_lshlrev_b32 v18, 16, v20
    v_and_b32 v19, 0xffff0000, v20
    v_pk_mul_f32 v[18:19], v[18:19], v[16:17] op_sel_hi:[1,0]
    v_cvt_pk_bf16_f32 v46, v18, v19
    v_pk_add_f32 v[18:19], v[110:111], v[14:15] op_sel_hi:[1,0] neg_lo:[0,1] neg_hi:[0,1]
    v_cvt_pk_bf16_f32 v20, v18, v19
    v_lshlrev_b32 v18, 16, v20
    v_and_b32 v19, 0xffff0000, v20
    v_pk_mul_f32 v[18:19], v[18:19], v[16:17] op_sel_hi:[1,0]
    v_cvt_pk_bf16_f32 v47, v18, v19
    v_pk_add_f32 v[18:19], v[112:113], v[14:15] op_sel_hi:[1,0] neg_lo:[0,1] neg_hi:[0,1]
    v_cvt_pk_bf16_f32 v20, v18, v19
    v_lshlrev_b32 v18, 16, v20
    v_and_b32 v19, 0xffff0000, v20
    v_pk_mul_f32 v[18:19], v[18:19], v[16:17] op_sel_hi:[1,0]
    v_cvt_pk_bf16_f32 v48, v18, v19
    v_pk_add_f32 v[18:19], v[114:115], v[14:15] op_sel_hi:[1,0] neg_lo:[0,1] neg_hi:[0,1]
    v_cvt_pk_bf16_f32 v20, v18, v19
    v_lshlrev_b32 v18, 16, v20
    v_and_b32 v19, 0xffff0000, v20
    v_pk_mul_f32 v[18:19], v[18:19], v[16:17] op_sel_hi:[1,0]
    v_cvt_pk_bf16_f32 v49, v18, v19
    v_pk_add_f32 v[18:19], v[116:117], v[14:15] op_sel_hi:[1,0] neg_lo:[0,1] neg_hi:[0,1]
    v_cvt_pk_bf16_f32 v20, v18, v19
    v_lshlrev_b32 v18, 16, v20
    v_and_b32 v19, 0xffff0000, v20
    v_pk_mul_f32 v[18:19], v[18:19], v[16:17] op_sel_hi:[1,0]
    v_cvt_pk_bf16_f32 v50, v18, v19
    v_pk_add_f32 v[18:19], v[118:119], v[14:15] op_sel_hi:[1,0] neg_lo:[0,1] neg_hi:[0,1]
    v_cvt_pk_bf16_f32 v20, v18, v19
    v_lshlrev_b32 v18, 16, v20
    v_and_b32 v19, 0xffff0000, v20
    v_pk_mul_f32 v[18:19], v[18:19], v[16:17] op_sel_hi:[1,0]
    v_cvt_pk_bf16_f32 v51, v18, v19
    v_pk_add_f32 v[18:19], v[120:121], v[14:15] op_sel_hi:[1,0] neg_lo:[0,1] neg_hi:[0,1]
    v_cvt_pk_bf16_f32 v20, v18, v19
    v_lshlrev_b32 v18, 16, v20
    v_and_b32 v19, 0xffff0000, v20
    v_pk_mul_f32 v[18:19], v[18:19], v[16:17] op_sel_hi:[1,0]
    v_cvt_pk_bf16_f32 v52, v18, v19
    v_pk_add_f32 v[18:19], v[122:123], v[14:15] op_sel_hi:[1,0] neg_lo:[0,1] neg_hi:[0,1]
    v_cvt_pk_bf16_f32 v20, v18, v19
    v_lshlrev_b32 v18, 16, v20
    v_and_b32 v19, 0xffff0000, v20
    v_pk_mul_f32 v[18:19], v[18:19], v[16:17] op_sel_hi:[1,0]
    v_cvt_pk_bf16_f32 v53, v18, v19
    v_pk_add_f32 v[18:19], v[124:125], v[14:15] op_sel_hi:[1,0] neg_lo:[0,1] neg_hi:[0,1]
    v_cvt_pk_bf16_f32 v20, v18, v19
    v_lshlrev_b32 v18, 16, v20
    v_and_b32 v19, 0xffff0000, v20
    v_pk_mul_f32 v[18:19], v[18:19], v[16:17] op_sel_hi:[1,0]
    v_cvt_pk_bf16_f32 v54, v18, v19
    v_pk_add_f32 v[18:19], v[126:127], v[14:15] op_sel_hi:[1,0] neg_lo:[0,1] neg_hi:[0,1]
    v_cvt_pk_bf16_f32 v20, v18, v19
    v_lshlrev_b32 v18, 16, v20
    v_and_b32 v19, 0xffff0000, v20
    v_pk_mul_f32 v[18:19], v[18:19], v[16:17] op_sel_hi:[1,0]
    v_cvt_pk_bf16_f32 v55, v18, v19
    v_pk_add_f32 v[18:19], v[128:129], v[14:15] op_sel_hi:[1,0] neg_lo:[0,1] neg_hi:[0,1]
    v_cvt_pk_bf16_f32 v20, v18, v19
    v_lshlrev_b32 v18, 16, v20
    v_and_b32 v19, 0xffff0000, v20
    v_pk_mul_f32 v[18:19], v[18:19], v[16:17] op_sel_hi:[1,0]
    v_cvt_pk_bf16_f32 v56, v18, v19
    v_pk_add_f32 v[18:19], v[130:131], v[14:15] op_sel_hi:[1,0] neg_lo:[0,1] neg_hi:[0,1]
    v_cvt_pk_bf16_f32 v20, v18, v19
    v_lshlrev_b32 v18, 16, v20
    v_and_b32 v19, 0xffff0000, v20
    v_pk_mul_f32 v[18:19], v[18:19], v[16:17] op_sel_hi:[1,0]
    v_cvt_pk_bf16_f32 v57, v18, v19
    v_pk_add_f32 v[18:19], v[132:133], v[14:15] op_sel_hi:[1,0] neg_lo:[0,1] neg_hi:[0,1]
    v_cvt_pk_bf16_f32 v20, v18, v19
    v_lshlrev_b32 v18, 16, v20
    v_and_b32 v19, 0xffff0000, v20
    v_pk_mul_f32 v[18:19], v[18:19], v[16:17] op_sel_hi:[1,0]
    v_cvt_pk_bf16_f32 v58, v18, v19
    v_pk_add_f32 v[18:19], v[134:135], v[14:15] op_sel_hi:[1,0] neg_lo:[0,1] neg_hi:[0,1]
    v_cvt_pk_bf16_f32 v20, v18, v19
    v_lshlrev_b32 v18, 16, v20
    v_and_b32 v19, 0xffff0000, v20
    v_pk_mul_f32 v[18:19], v[18:19], v[16:17] op_sel_hi:[1,0]
    v_cvt_pk_bf16_f32 v59, v18, v19
    v_pk_add_f32 v[18:19], v[136:137], v[14:15] op_sel_hi:[1,0] neg_lo:[0,1] neg_hi:[0,1]
    v_cvt_pk_bf16_f32 v20, v18, v19
    v_lshlrev_b32 v18, 16, v20
    v_and_b32 v19, 0xffff0000, v20
    v_pk_mul_f32 v[18:19], v[18:19], v[16:17] op_sel_hi:[1,0]
    v_cvt_pk_bf16_f32 v60, v18, v19
    v_pk_add_f32 v[18:19], v[138:139], v[14:15] op_sel_hi:[1,0] neg_lo:[0,1] neg_hi:[0,1]
    v_cvt_pk_bf16_f32 v20, v18, v19
    v_lshlrev_b32 v18, 16, v20
    v_and_b32 v19, 0xffff0000, v20
    v_pk_mul_f32 v[18:19], v[18:19], v[16:17] op_sel_hi:[1,0]
    v_cvt_pk_bf16_f32 v61, v18, v19
    v_pk_add_f32 v[18:19], v[140:141], v[14:15] op_sel_hi:[1,0] neg_lo:[0,1] neg_hi:[0,1]
    v_cvt_pk_bf16_f32 v20, v18, v19
    v_lshlrev_b32 v18, 16, v20
    v_and_b32 v19, 0xffff0000, v20
    v_pk_mul_f32 v[18:19], v[18:19], v[16:17] op_sel_hi:[1,0]
    v_cvt_pk_bf16_f32 v62, v18, v19
    v_pk_add_f32 v[18:19], v[142:143], v[14:15] op_sel_hi:[1,0] neg_lo:[0,1] neg_hi:[0,1]
    v_cvt_pk_bf16_f32 v20, v18, v19
    v_lshlrev_b32 v18, 16, v20
    v_and_b32 v19, 0xffff0000, v20
    v_pk_mul_f32 v[18:19], v[18:19], v[16:17] op_sel_hi:[1,0]
    v_cvt_pk_bf16_f32 v63, v18, v19
    v_pk_add_f32 v[18:19], v[144:145], v[14:15] op_sel_hi:[1,0] neg_lo:[0,1] neg_hi:[0,1]
    v_cvt_pk_bf16_f32 v20, v18, v19
    v_lshlrev_b32 v18, 16, v20
    v_and_b32 v19, 0xffff0000, v20
    v_pk_mul_f32 v[18:19], v[18:19], v[16:17] op_sel_hi:[1,0]
    v_cvt_pk_bf16_f32 v64, v18, v19
    v_pk_add_f32 v[18:19], v[146:147], v[14:15] op_sel_hi:[1,0] neg_lo:[0,1] neg_hi:[0,1]
    v_cvt_pk_bf16_f32 v20, v18, v19
    v_lshlrev_b32 v18, 16, v20
    v_and_b32 v19, 0xffff0000, v20
    v_pk_mul_f32 v[18:19], v[18:19], v[16:17] op_sel_hi:[1,0]
    v_cvt_pk_bf16_f32 v65, v18, v19
    v_pk_add_f32 v[18:19], v[148:149], v[14:15] op_sel_hi:[1,0] neg_lo:[0,1] neg_hi:[0,1]
    v_cvt_pk_bf16_f32 v20, v18, v19
    v_lshlrev_b32 v18, 16, v20
    v_and_b32 v19, 0xffff0000, v20
    v_pk_mul_f32 v[18:19], v[18:19], v[16:17] op_sel_hi:[1,0]
    v_cvt_pk_bf16_f32 v66, v18, v19
    v_pk_add_f32 v[18:19], v[150:151], v[14:15] op_sel_hi:[1,0] neg_lo:[0,1] neg_hi:[0,1]
    v_cvt_pk_bf16_f32 v20, v18, v19
    v_lshlrev_b32 v18, 16, v20
    v_and_b32 v19, 0xffff0000, v20
    v_pk_mul_f32 v[18:19], v[18:19], v[16:17] op_sel_hi:[1,0]
    v_cvt_pk_bf16_f32 v67, v18, v19
    s_add_u32 s25, s24, 1048576
    buffer_store_dwordx4 v[32:35], v7, s[8:11], s25 offen sc1
    s_add_u32 s25, s25, 4096
    buffer_store_dwordx4 v[36:39], v7, s[8:11], s25 offen sc1
    s_add_u32 s25, s25, 4096
    buffer_store_dwordx4 v[40:43], v7, s[8:11], s25 offen sc1
    s_add_u32 s25, s25, 4096
    buffer_store_dwordx4 v[44:47], v7, s[8:11], s25 offen sc1
    s_add_u32 s25, s25, 4096
    buffer_store_dwordx4 v[48:51], v7, s[8:11], s25 offen sc1
    s_add_u32 s25, s25, 4096
    buffer_store_dwordx4 v[52:55], v7, s[8:11], s25 offen sc1
    s_add_u32 s25, s25, 4096
    buffer_store_dwordx4 v[56:59], v7, s[8:11], s25 offen sc1
    s_add_u32 s25, s25, 4096
    buffer_store_dwordx4 v[60:63], v7, s[8:11], s25 offen sc1
    s_add_u32 s25, s25, 4096
    buffer_store_dwordx4 v[64:67], v7, s[8:11], s25 offen sc1
    s_add_u32 s25, s25, 4096
    s_waitcnt vmcnt(0)
    s_barrier
    s_cmp_lg_u32 s20, 0
    s_cbranch_scc1 Lln_5
    s_mul_i32 s27, s22, 64
    s_add_u32 s27, s27, 6127616
    s_mov_b64 exec, 1
    v_mov_b32 v250, 1
    buffer_store_dword v250, off, s[8:11], s27 sc1
    s_mov_b64 exec, -1
Lln_5:
    s_add_u32 s22, s22, 60
    s_branch Lln_3
Lln_4:
    s_waitcnt vmcnt(0)
    s_mov_b32 s21, s58
    s_cmp_lt_u32 s21, 196
    s_cbranch_scc1 L_b0
    s_cmp_lt_u32 s21, 220
    s_cbranch_scc1 L_gamma
    s_sub_u32 s21, s21, 188
    s_branch L_spare
L_t1:
    s_mov_b32 s59, s21
    s_lshr_b32 s44, s21, 5
    s_and_b32 s45, s21, 31
    s_lshl_b32 s46, s44, 3
    s_add_u32 s46, s46, 16
    s_load_dwordx2 s[24:25], s[0:1], s46
    s_waitcnt lgkmcnt(0)
    s_mov_b32 s12, s24
    s_mov_b32 s13, s25
    s_mov_b32 s14, 4718592
    s_mov_b32 s15, 0x20000
    s_lshl_b32 s47, s45, 8
    v_and_b32 v1, 63, v0
    v_lshrrev_b32 v2, 4, v1
    v_and_b32 v3, 15, v1
    v_lshlrev_b32 v4, 2, v2
    v_xor_b32 v3, v3, v4
    v_lshlrev_b32 v3, 4, v3
    v_mul_u32_u24 v4, 8192, v2
    v_add_u32 v3, v3, v4
    s_mul_i32 s28, s20, 36
    s_lshl_b32 s29, s28, 10
    s_add_u32 s29, s29, 0
    s_mul_i32 s30, s28, 32768
    s_add_u32 s30, s30, s47
    s_mov_b32 s31, 0
Lwd_7:
    s_mov_b32 m0, s29
    s_add_u32 s29, s29, 1024
    buffer_load_dwordx4 v3, s[12:15], s30 offen  lds
    s_add_u32 s30, s30, 32768
    s_add_u32 s31, s31, 1
    s_cmp_lt_u32 s31, 36
    s_cbranch_scc1 Lwd_7
    v_lshrrev_b32 v4, 4, v1
    v_lshrrev_b32 v5, 2, v1
    v_and_b32 v5, 3, v5
    v_and_b32 v6, 3, v1
    v_lshrrev_b32 v7, 1, v4
    v_and_b32 v8, 1, v4
    v_lshlrev_b32 v8, 1, v8
    v_lshrrev_b32 v9, 1, v6
    s_lshl_b32 s28, s20, 2
    v_add3_u32 v8, v8, v9, s28
    v_lshlrev_b32 v9, 2, v5
    v_xor_b32 v8, v8, v9
    v_lshlrev_b32 v8, 4, v8
    v_and_b32 v9, 1, v6
    v_lshlrev_b32 v9, 3, v9
    v_add_u32 v8, v8, v9
    v_lshlrev_b32 v9, 3, v7
    v_add_u32 v9, v9, v5
    v_lshlrev_b32 v9, 8, v9
    v_add_u32 v10, v8, v9
    v_add_u32 v10, 0, v10
    s_waitcnt vmcnt(0)
    s_barrier
    ds_read_b64_tr_b16 v[64:65], v10 offset:0
    ds_read_b64_tr_b16 v[66:67], v10 offset:1024
    ds_read_b64_tr_b16 v[68:69], v10 offset:4096
    ds_read_b64_tr_b16 v[70:71], v10 offset:5120
    ds_read_b64_tr_b16 v[72:73], v10 offset:8192
    ds_read_b64_tr_b16 v[74:75], v10 offset:9216
    ds_read_b64_tr_b16 v[76:77], v10 offset:12288
    ds_read_b64_tr_b16 v[78:79], v10 offset:13312
    s_waitcnt lgkmcnt(4)
    ds_read_b64_tr_b16 v[80:81], v10 offset:16384
    ds_read_b64_tr_b16 v[82:83], v10 offset:17408
    ds_read_b64_tr_b16 v[84:85], v10 offset:20480
    ds_read_b64_tr_b16 v[86:87], v10 offset:21504
    ds_read_b64_tr_b16 v[88:89], v10 offset:24576
    ds_read_b64_tr_b16 v[90:91], v10 offset:25600
    ds_read_b64_tr_b16 v[92:93], v10 offset:28672
    ds_read_b64_tr_b16 v[94:95], v10 offset:29696
    s_waitcnt lgkmcnt(4)
    v_add_u32 v10, 32768, v10
    ds_read_b64_tr_b16 v[96:97], v10 offset:0
    ds_read_b64_tr_b16 v[98:99], v10 offset:1024
    ds_read_b64_tr_b16 v[100:101], v10 offset:4096
    ds_read_b64_tr_b16 v[102:103], v10 offset:5120
    ds_read_b64_tr_b16 v[104:105], v10 offset:8192
    ds_read_b64_tr_b16 v[106:107], v10 offset:9216
    ds_read_b64_tr_b16 v[108:109], v10 offset:12288
    ds_read_b64_tr_b16 v[110:111], v10 offset:13312
    s_waitcnt lgkmcnt(4)
    ds_read_b64_tr_b16 v[112:113], v10 offset:16384
    ds_read_b64_tr_b16 v[114:115], v10 offset:17408
    ds_read_b64_tr_b16 v[116:117], v10 offset:20480
    ds_read_b64_tr_b16 v[118:119], v10 offset:21504
    ds_read_b64_tr_b16 v[120:121], v10 offset:24576
    ds_read_b64_tr_b16 v[122:123], v10 offset:25600
    ds_read_b64_tr_b16 v[124:125], v10 offset:28672
    ds_read_b64_tr_b16 v[126:127], v10 offset:29696
    s_waitcnt lgkmcnt(4)
    v_add_u32 v10, 32768, v10
    ds_read_b64_tr_b16 v[128:129], v10 offset:0
    ds_read_b64_tr_b16 v[130:131], v10 offset:1024
    ds_read_b64_tr_b16 v[132:133], v10 offset:4096
    ds_read_b64_tr_b16 v[134:135], v10 offset:5120
    ds_read_b64_tr_b16 v[136:137], v10 offset:8192
    ds_read_b64_tr_b16 v[138:139], v10 offset:9216
    ds_read_b64_tr_b16 v[140:141], v10 offset:12288
    ds_read_b64_tr_b16 v[142:143], v10 offset:13312
    s_waitcnt lgkmcnt(4)
    ds_read_b64_tr_b16 v[144:145], v10 offset:16384
    ds_read_b64_tr_b16 v[146:147], v10 offset:17408
    ds_read_b64_tr_b16 v[148:149], v10 offset:20480
    ds_read_b64_tr_b16 v[150:151], v10 offset:21504
    ds_read_b64_tr_b16 v[152:153], v10 offset:24576
    ds_read_b64_tr_b16 v[154:155], v10 offset:25600
    ds_read_b64_tr_b16 v[156:157], v10 offset:28672
    ds_read_b64_tr_b16 v[158:159], v10 offset:29696
    s_waitcnt lgkmcnt(4)
    v_add_u32 v10, 32768, v10
    ds_read_b64_tr_b16 v[160:161], v10 offset:0
    ds_read_b64_tr_b16 v[162:163], v10 offset:1024
    ds_read_b64_tr_b16 v[164:165], v10 offset:4096
    ds_read_b64_tr_b16 v[166:167], v10 offset:5120
    ds_read_b64_tr_b16 v[168:169], v10 offset:8192
    ds_read_b64_tr_b16 v[170:171], v10 offset:9216
    ds_read_b64_tr_b16 v[172:173], v10 offset:12288
    ds_read_b64_tr_b16 v[174:175], v10 offset:13312
    s_waitcnt lgkmcnt(4)
    ds_read_b64_tr_b16 v[176:177], v10 offset:16384
    ds_read_b64_tr_b16 v[178:179], v10 offset:17408
    ds_read_b64_tr_b16 v[180:181], v10 offset:20480
    ds_read_b64_tr_b16 v[182:183], v10 offset:21504
    ds_read_b64_tr_b16 v[184:185], v10 offset:24576
    ds_read_b64_tr_b16 v[186:187], v10 offset:25600
    ds_read_b64_tr_b16 v[188:189], v10 offset:28672
    ds_read_b64_tr_b16 v[190:191], v10 offset:29696
    s_waitcnt lgkmcnt(4)
    v_add_u32 v10, 32768, v10
    ds_read_b64_tr_b16 v[192:193], v10 offset:0
    ds_read_b64_tr_b16 v[194:195], v10 offset:1024
    ds_read_b64_tr_b16 v[196:197], v10 offset:4096
    ds_read_b64_tr_b16 v[198:199], v10 offset:5120
    ds_read_b64_tr_b16 v[200:201], v10 offset:8192
    ds_read_b64_tr_b16 v[202:203], v10 offset:9216
    ds_read_b64_tr_b16 v[204:205], v10 offset:12288
    ds_read_b64_tr_b16 v[206:207], v10 offset:13312
    s_waitcnt lgkmcnt(4)
    s_waitcnt lgkmcnt(0)
    s_barrier
    s_lshl_b32 s48, s44, 24
    s_add_u32 s48, s48, 6291456
    s_lshl_b32 s49, s45, 13
    s_add_u32 s48, s48, s49
    s_lshl_b32 s49, s20, 11
    s_add_u32 s48, s48, s49
    s_lshl_b32 s50, s45, 4
    s_lshl_b32 s49, s44, 2
    s_add_u32 s50, s50, s49
    s_add_u32 s50, s50, 6029312
    v_and_b32 v1, 63, v0
    v_lshlrev_b32 v1, 4, v1
    s_mov_b64 exec, 1
    v_mov_b32 v250, 44
Lwi_8:
    buffer_load_dword v251, v250, s[16:19], 0 offen sc1
    s_waitcnt vmcnt(0)
    v_readfirstlane_b32 s38, v251
    s_cmp_lg_u32 s38, 0
    s_cbranch_scc1 Lwi_9
    s_add_u32 s23, s23, 1
    s_cmp_gt_u32 s23, 3000000
    s_cbranch_scc1 L_wfail
    s_sleep 1
    s_branch Lwi_8
Lwi_9:
    s_mov_b64 exec, -1
    s_mov_b32 s22, 0
    s_mov_b32 s51, 6127616
    s_cmp_lg_u32 s20, 0
    s_cbranch_scc1 Lt1_10
    s_mov_b32 exec_lo, 0x1
    s_mov_b32 exec_hi, 0x0
    v_mbcnt_lo_u32_b32 v250, -1, 0
    v_mbcnt_hi_u32_b32 v250, -1, v250
    v_lshlrev_b32 v250, 2, v250
Lwf_11:
    buffer_load_dword v251, v250, s[8:11], s51 offen sc1
    s_waitcnt vmcnt(0)
    v_cmp_eq_u32 vcc, 0, v251
    s_cbranch_vccz Lwf_12
    s_add_u32 s23, s23, 1
    s_cmp_gt_u32 s23, 3000000
    s_cbranch_scc1 L_wfail
    s_sleep 2
    s_branch Lwf_11
Lwf_12:
    s_mov_b64 exec, -1
    s_add_u32 s51, s51, 64
    s_mov_b32 exec_lo, 0x1
    s_mov_b32 exec_hi, 0x0
    v_mbcnt_lo_u32_b32 v250, -1, 0
    v_mbcnt_hi_u32_b32 v250, -1, v250
    v_lshlrev_b32 v250, 2, v250
Lwf_13:
    buffer_load_dword v251, v250, s[8:11], s51 offen sc1
    s_waitcnt vmcnt(0)
    v_cmp_eq_u32 vcc, 0, v251
    s_cbranch_vccz Lwf_14
    s_add_u32 s23, s23, 1
    s_cmp_gt_u32 s23, 3000000
    s_cbranch_scc1 L_wfail
    s_sleep 2
    s_branch Lwf_13
Lwf_14:
    s_mov_b64 exec, -1
Lt1_10:
    s_barrier
    s_mov_b32 s52, 1048576
    s_mov_b32 s53, 0
    s_mul_i32 s32, s20, 9216
    s_add_u32 s33, s32, s53
    s_add_u32 s32, s32, s52
    s_mov_b32 m0, s33
    s_add_u32 s33, s33, 1024
    buffer_load_dwordx4 v1, s[8:11], s32 offen sc1 lds
    s_add_u32 s32, s32, 1024
    s_mov_b32 m0, s33
    s_add_u32 s33, s33, 1024
    buffer_load_dwordx4 v1, s[8:11], s32 offen sc1 lds
    s_add_u32 s32, s32, 1024
    s_mov_b32 m0, s33
    s_add_u32 s33, s33, 1024
    buffer_load_dwordx4 v1, s[8:11], s32 offen sc1 lds
    s_add_u32 s32, s32, 1024
    s_mov_b32 m0, s33
    s_add_u32 s33, s33, 1024
    buffer_load_dwordx4 v1, s[8:11], s32 offen sc1 lds
    s_add_u32 s32, s32, 1024
    s_mov_b32 m0, s33
    s_add_u32 s33, s33, 1024
    buffer_load_dwordx4 v1, s[8:11], s32 offen sc1 lds
    s_add_u32 s32, s32, 1024
    s_mov_b32 m0, s33
    s_add_u32 s33, s33, 1024
    buffer_load_dwordx4 v1, s[8:11], s32 offen sc1 lds
    s_add_u32 s32, s32, 1024
    s_mov_b32 m0, s33
    s_add_u32 s33, s33, 1024
    buffer_load_dwordx4 v1, s[8:11], s32 offen sc1 lds
    s_add_u32 s32, s32, 1024
    s_mov_b32 m0, s33
    s_add_u32 s33, s33, 1024
    buffer_load_dwordx4 v1, s[8:11], s32 offen sc1 lds
    s_add_u32 s32, s32, 1024
    s_mov_b32 m0, s33
    s_add_u32 s33, s33, 1024
    buffer_load_dwordx4 v1, s[8:11], s32 offen sc1 lds
    s_add_u32 s32, s32, 1024
    s_waitcnt vmcnt(0)
Lt1_15:
    s_waitcnt vmcnt(2)
    s_barrier
    s_cmp_lg_u32 s20, 0
    s_cbranch_scc1 Lt1_18
    s_cmp_lt_u32 s22, 2
    s_cbranch_scc1 Lt1_18
    s_sub_u32 s25, s22, 2
    s_lshl_b32 s25, s25, 9
    s_add_u32 s25, s25, s50
    s_sub_u32 s22, s22, 2
    s_mov_b64 exec, 1
    v_mov_b32 v250, 1
    buffer_store_dword v250, off, s[8:11], s25 sc1
    s_mov_b64 exec, -1
    s_add_u32 s22, s22, 2
Lt1_18:
    s_cmp_ge_u32 s22, 63
    s_cbranch_scc1 Lt1_16
    s_add_u32 s52, s52, 36864
    s_xor_b32 s54, s53, 36864
    s_mul_i32 s32, s20, 9216
    s_add_u32 s33, s32, s54
    s_add_u32 s32, s32, s52
    s_mov_b32 m0, s33
    s_add_u32 s33, s33, 1024
    buffer_load_dwordx4 v1, s[8:11], s32 offen sc1 lds
    s_add_u32 s32, s32, 1024
    s_mov_b32 m0, s33
    s_add_u32 s33, s33, 1024
    buffer_load_dwordx4 v1, s[8:11], s32 offen sc1 lds
    s_add_u32 s32, s32, 1024
    s_mov_b32 m0, s33
    s_add_u32 s33, s33, 1024
    buffer_load_dwordx4 v1, s[8:11], s32 offen sc1 lds
    s_add_u32 s32, s32, 1024
    s_mov_b32 m0, s33
    s_add_u32 s33, s33, 1024
    buffer_load_dwordx4 v1, s[8:11], s32 offen sc1 lds
    s_add_u32 s32, s32, 1024
    s_mov_b32 m0, s33
    s_add_u32 s33, s33, 1024
    buffer_load_dwordx4 v1, s[8:11], s32 offen sc1 lds
    s_add_u32 s32, s32, 1024
    s_mov_b32 m0, s33
    s_add_u32 s33, s33, 1024
    buffer_load_dwordx4 v1, s[8:11], s32 offen sc1 lds
    s_add_u32 s32, s32, 1024
    s_mov_b32 m0, s33
    s_add_u32 s33, s33, 1024
    buffer_load_dwordx4 v1, s[8:11], s32 offen sc1 lds
    s_add_u32 s32, s32, 1024
    s_mov_b32 m0, s33
    s_add_u32 s33, s33, 1024
    buffer_load_dwordx4 v1, s[8:11], s32 offen sc1 lds
    s_add_u32 s32, s32, 1024
    s_mov_b32 m0, s33
    s_add_u32 s33, s33, 1024
    buffer_load_dwordx4 v1, s[8:11], s32 offen sc1 lds
    s_add_u32 s32, s32, 1024
Lt1_16:
    s_add_u32 s55, s22, 2
    s_min_u32 s55, s55, 63
    s_lshl_b32 s55, s55, 6
    s_add_u32 s55, s55, 6127616
    s_mov_b64 exec, 1
    buffer_load_dword v3, off, s[8:11], s55 sc1
    s_mov_b64 exec, -1
    v_add_u32 v2, s53, v1
    ds_read_b128 v[32:35], v2 offset:0
    ds_read_b128 v[36:39], v2 offset:1024
    ds_read_b128 v[40:43], v2 offset:2048
    ds_read_b128 v[44:47], v2 offset:3072
    ds_read_b128 v[48:51], v2 offset:4096
    ds_read_b128 v[52:55], v2 offset:5120
    ds_read_b128 v[56:59], v2 offset:6144
    ds_read_b128 v[60:63], v2 offset:7168
    s_cmp_eq_u32 s44, 2
    s_cbranch_scc1 Lt1v_6
    s_waitcnt lgkmcnt(7)
    v_mfma_f32_32x32x16_bf16 v[16:31], v[64:67], v[32:35], 0
    s_waitcnt lgkmcnt(6)
    v_mfma_f32_32x32x16_bf16 v[16:31], v[68:71], v[36:39], v[16:31]
    ds_read_b128 v[32:35], v2 offset:8192
    s_waitcnt lgkmcnt(6)
    v_mfma_f32_32x32x16_bf16 v[16:31], v[72:75], v[40:43], v[16:31]
    ds_read_b128 v[36:39], v2 offset:9216
    s_waitcnt lgkmcnt(6)
    v_mfma_f32_32x32x16_bf16 v[16:31], v[76:79], v[44:47], v[16:31]
    ds_read_b128 v[40:43], v2 offset:10240
    s_waitcnt lgkmcnt(6)
    v_mfma_f32_32x32x16_bf16 v[16:31], v[80:83], v[48:51], v[16:31]
    ds_read_b128 v[44:47], v2 offset:11264
    s_waitcnt lgkmcnt(6)
    v_mfma_f32_32x32x16_bf16 v[16:31], v[84:87], v[52:55], v[16:31]
    ds_read_b128 v[48:51], v2 offset:12288
    s_waitcnt lgkmcnt(6)
    v_mfma_f32_32x32x16_bf16 v[16:31], v[88:91], v[56:59], v[16:31]
    ds_read_b128 v[52:55], v2 offset:13312
    s_waitcnt lgkmcnt(6)
    v_mfma_f32_32x32x16_bf16 v[16:31], v[92:95], v[60:63], v[16:31]
    ds_read_b128 v[56:59], v2 offset:14336
    s_waitcnt lgkmcnt(6)
    v_mfma_f32_32x32x16_bf16 v[16:31], v[96:99], v[32:35], v[16:31]
    ds_read_b128 v[60:63], v2 offset:15360
    s_waitcnt lgkmcnt(6)
    v_mfma_f32_32x32x16_bf16 v[16:31], v[100:103], v[36:39], v[16:31]
    ds_read_b128 v[32:35], v2 offset:16384
    s_waitcnt lgkmcnt(6)
    v_mfma_f32_32x32x16_bf16 v[16:31], v[104:107], v[40:43], v[16:31]
    ds_read_b128 v[36:39], v2 offset:17408
    s_waitcnt lgkmcnt(6)
    v_mfma_f32_32x32x16_bf16 v[16:31], v[108:111], v[44:47], v[16:31]
    ds_read_b128 v[40:43], v2 offset:18432
    s_waitcnt lgkmcnt(6)
    v_mfma_f32_32x32x16_bf16 v[16:31], v[112:115], v[48:51], v[16:31]
    ds_read_b128 v[44:47], v2 offset:19456
    s_waitcnt lgkmcnt(6)
    v_mfma_f32_32x32x16_bf16 v[16:31], v[116:119], v[52:55], v[16:31]
    ds_read_b128 v[48:51], v2 offset:20480
    s_waitcnt lgkmcnt(6)
    v_mfma_f32_32x32x16_bf16 v[16:31], v[120:123], v[56:59], v[16:31]
    ds_read_b128 v[52:55], v2 offset:21504
    s_waitcnt lgkmcnt(6)
    v_mfma_f32_32x32x16_bf16 v[16:31], v[124:127], v[60:63], v[16:31]
    ds_read_b128 v[56:59], v2 offset:22528
    s_waitcnt lgkmcnt(6)
    v_mfma_f32_32x32x16_bf16 v[16:31], v[128:131], v[32:35], v[16:31]
    ds_read_b128 v[60:63], v2 offset:23552
    s_waitcnt lgkmcnt(6)
    v_mfma_f32_32x32x16_bf16 v[16:31], v[132:135], v[36:39], v[16:31]
    ds_read_b128 v[32:35], v2 offset:24576
    s_waitcnt lgkmcnt(6)
    v_mfma_f32_32x32x16_bf16 v[16:31], v[136:139], v[40:43], v[16:31]
    ds_read_b128 v[36:39], v2 offset:25600
    s_waitcnt lgkmcnt(6)
    v_mfma_f32_32x32x16_bf16 v[16:31], v[140:143], v[44:47], v[16:31]
    ds_read_b128 v[40:43], v2 offset:26624
    s_waitcnt lgkmcnt(6)
    v_mfma_f32_32x32x16_bf16 v[16:31], v[144:147], v[48:51], v[16:31]
    ds_read_b128 v[44:47], v2 offset:27648
    s_waitcnt lgkmcnt(6)
    v_mfma_f32_32x32x16_bf16 v[16:31], v[148:151], v[52:55], v[16:31]
    ds_read_b128 v[48:51], v2 offset:28672
    s_waitcnt lgkmcnt(6)
    v_mfma_f32_32x32x16_bf16 v[16:31], v[152:155], v[56:59], v[16:31]
    ds_read_b128 v[52:55], v2 offset:29696
    s_waitcnt lgkmcnt(6)
    v_mfma_f32_32x32x16_bf16 v[16:31], v[156:159], v[60:63], v[16:31]
    ds_read_b128 v[56:59], v2 offset:30720
    s_waitcnt lgkmcnt(6)
    v_mfma_f32_32x32x16_bf16 v[16:31], v[160:163], v[32:35], v[16:31]
    ds_read_b128 v[60:63], v2 offset:31744
    s_waitcnt lgkmcnt(6)
    v_mfma_f32_32x32x16_bf16 v[16:31], v[164:167], v[36:39], v[16:31]
    ds_read_b128 v[32:35], v2 offset:32768
    s_waitcnt lgkmcnt(6)
    v_mfma_f32_32x32x16_bf16 v[16:31], v[168:171], v[40:43], v[16:31]
    ds_read_b128 v[36:39], v2 offset:33792
    s_waitcnt lgkmcnt(6)
    v_mfma_f32_32x32x16_bf16 v[16:31], v[172:175], v[44:47], v[16:31]
    ds_read_b128 v[40:43], v2 offset:34816
    s_waitcnt lgkmcnt(6)
    v_mfma_f32_32x32x16_bf16 v[16:31], v[176:179], v[48:51], v[16:31]
    ds_read_b128 v[44:47], v2 offset:35840
    s_waitcnt lgkmcnt(6)
    v_mfma_f32_32x32x16_bf16 v[16:31], v[180:183], v[52:55], v[16:31]
    s_waitcnt lgkmcnt(5)
    v_mfma_f32_32x32x16_bf16 v[16:31], v[184:187], v[56:59], v[16:31]
    s_waitcnt lgkmcnt(4)
    v_mfma_f32_32x32x16_bf16 v[16:31], v[188:191], v[60:63], v[16:31]
    s_waitcnt lgkmcnt(3)
    v_mfma_f32_32x32x16_bf16 v[16:31], v[192:195], v[32:35], v[16:31]
    s_waitcnt lgkmcnt(2)
    v_mfma_f32_32x32x16_bf16 v[16:31], v[196:199], v[36:39], v[16:31]
    s_waitcnt lgkmcnt(1)
    v_mfma_f32_32x32x16_bf16 v[16:31], v[200:203], v[40:43], v[16:31]
    s_waitcnt lgkmcnt(0)
    v_mfma_f32_32x32x16_bf16 v[16:31], v[204:207], v[44:47], v[16:31]
    s_nop 7
    s_nop 3
    v_cvt_pk_bf16_f32 v32, v16, v17
    v_cvt_pk_bf16_f32 v33, v18, v19
    v_cvt_pk_bf16_f32 v34, v20, v21
    v_cvt_pk_bf16_f32 v35, v22, v23
    v_cvt_pk_bf16_f32 v36, v24, v25
    v_cvt_pk_bf16_f32 v37, v26, v27
    v_cvt_pk_bf16_f32 v38, v28, v29
    v_cvt_pk_bf16_f32 v39, v30, v31
    s_branch Lt1_17
Lt1v_6:
    s_waitcnt lgkmcnt(7)
    v_mfma_f32_32x32x16_bf16 v[16:31], v[32:35], v[64:67], 0
    s_waitcnt lgkmcnt(6)
    v_mfma_f32_32x32x16_bf16 v[16:31], v[36:39], v[68:71], v[16:31]
    ds_read_b128 v[32:35], v2 offset:8192
    s_waitcnt lgkmcnt(6)
    v_mfma_f32_32x32x16_bf16 v[16:31], v[40:43], v[72:75], v[16:31]
    ds_read_b128 v[36:39], v2 offset:9216
    s_waitcnt lgkmcnt(6)
    v_mfma_f32_32x32x16_bf16 v[16:31], v[44:47], v[76:79], v[16:31]
    ds_read_b128 v[40:43], v2 offset:10240
    s_waitcnt lgkmcnt(6)
    v_mfma_f32_32x32x16_bf16 v[16:31], v[48:51], v[80:83], v[16:31]
    ds_read_b128 v[44:47], v2 offset:11264
    s_waitcnt lgkmcnt(6)
    v_mfma_f32_32x32x16_bf16 v[16:31], v[52:55], v[84:87], v[16:31]
    ds_read_b128 v[48:51], v2 offset:12288
    s_waitcnt lgkmcnt(6)
    v_mfma_f32_32x32x16_bf16 v[16:31], v[56:59], v[88:91], v[16:31]
    ds_read_b128 v[52:55], v2 offset:13312
    s_waitcnt lgkmcnt(6)
    v_mfma_f32_32x32x16_bf16 v[16:31], v[60:63], v[92:95], v[16:31]
    ds_read_b128 v[56:59], v2 offset:14336
    s_waitcnt lgkmcnt(6)
    v_mfma_f32_32x32x16_bf16 v[16:31], v[32:35], v[96:99], v[16:31]
    ds_read_b128 v[60:63], v2 offset:15360
    s_waitcnt lgkmcnt(6)
    v_mfma_f32_32x32x16_bf16 v[16:31], v[36:39], v[100:103], v[16:31]
    ds_read_b128 v[32:35], v2 offset:16384
    s_waitcnt lgkmcnt(6)
    v_mfma_f32_32x32x16_bf16 v[16:31], v[40:43], v[104:107], v[16:31]
    ds_read_b128 v[36:39], v2 offset:17408
    s_waitcnt lgkmcnt(6)
    v_mfma_f32_32x32x16_bf16 v[16:31], v[44:47], v[108:111], v[16:31]
    ds_read_b128 v[40:43], v2 offset:18432
    s_waitcnt lgkmcnt(6)
    v_mfma_f32_32x32x16_bf16 v[16:31], v[48:51], v[112:115], v[16:31]
    ds_read_b128 v[44:47], v2 offset:19456
    s_waitcnt lgkmcnt(6)
    v_mfma_f32_32x32x16_bf16 v[16:31], v[52:55], v[116:119], v[16:31]
    ds_read_b128 v[48:51], v2 offset:20480
    s_waitcnt lgkmcnt(6)
    v_mfma_f32_32x32x16_bf16 v[16:31], v[56:59], v[120:123], v[16:31]
    ds_read_b128 v[52:55], v2 offset:21504
    s_waitcnt lgkmcnt(6)
    v_mfma_f32_32x32x16_bf16 v[16:31], v[60:63], v[124:127], v[16:31]
    ds_read_b128 v[56:59], v2 offset:22528
    s_waitcnt lgkmcnt(6)
    v_mfma_f32_32x32x16_bf16 v[16:31], v[32:35], v[128:131], v[16:31]
    ds_read_b128 v[60:63], v2 offset:23552
    s_waitcnt lgkmcnt(6)
    v_mfma_f32_32x32x16_bf16 v[16:31], v[36:39], v[132:135], v[16:31]
    ds_read_b128 v[32:35], v2 offset:24576
    s_waitcnt lgkmcnt(6)
    v_mfma_f32_32x32x16_bf16 v[16:31], v[40:43], v[136:139], v[16:31]
    ds_read_b128 v[36:39], v2 offset:25600
    s_waitcnt lgkmcnt(6)
    v_mfma_f32_32x32x16_bf16 v[16:31], v[44:47], v[140:143], v[16:31]
    ds_read_b128 v[40:43], v2 offset:26624
    s_waitcnt lgkmcnt(6)
    v_mfma_f32_32x32x16_bf16 v[16:31], v[48:51], v[144:147], v[16:31]
    ds_read_b128 v[44:47], v2 offset:27648
    s_waitcnt lgkmcnt(6)
    v_mfma_f32_32x32x16_bf16 v[16:31], v[52:55], v[148:151], v[16:31]
    ds_read_b128 v[48:51], v2 offset:28672
    s_waitcnt lgkmcnt(6)
    v_mfma_f32_32x32x16_bf16 v[16:31], v[56:59], v[152:155], v[16:31]
    ds_read_b128 v[52:55], v2 offset:29696
    s_waitcnt lgkmcnt(6)
    v_mfma_f32_32x32x16_bf16 v[16:31], v[60:63], v[156:159], v[16:31]
    ds_read_b128 v[56:59], v2 offset:30720
    s_waitcnt lgkmcnt(6)
    v_mfma_f32_32x32x16_bf16 v[16:31], v[32:35], v[160:163], v[16:31]
    ds_read_b128 v[60:63], v2 offset:31744
    s_waitcnt lgkmcnt(6)
    v_mfma_f32_32x32x16_bf16 v[16:31], v[36:39], v[164:167], v[16:31]
    ds_read_b128 v[32:35], v2 offset:32768
    s_waitcnt lgkmcnt(6)
    v_mfma_f32_32x32x16_bf16 v[16:31], v[40:43], v[168:171], v[16:31]
    ds_read_b128 v[36:39], v2 offset:33792
    s_waitcnt lgkmcnt(6)
    v_mfma_f32_32x32x16_bf16 v[16:31], v[44:47], v[172:175], v[16:31]
    ds_read_b128 v[40:43], v2 offset:34816
    s_waitcnt lgkmcnt(6)
    v_mfma_f32_32x32x16_bf16 v[16:31], v[48:51], v[176:179], v[16:31]
    ds_read_b128 v[44:47], v2 offset:35840
    s_waitcnt lgkmcnt(6)
    v_mfma_f32_32x32x16_bf16 v[16:31], v[52:55], v[180:183], v[16:31]
    s_waitcnt lgkmcnt(5)
    v_mfma_f32_32x32x16_bf16 v[16:31], v[56:59], v[184:187], v[16:31]
    s_waitcnt lgkmcnt(4)
    v_mfma_f32_32x32x16_bf16 v[16:31], v[60:63], v[188:191], v[16:31]
    s_waitcnt lgkmcnt(3)
    v_mfma_f32_32x32x16_bf16 v[16:31], v[32:35], v[192:195], v[16:31]
    s_waitcnt lgkmcnt(2)
    v_mfma_f32_32x32x16_bf16 v[16:31], v[36:39], v[196:199], v[16:31]
    s_waitcnt lgkmcnt(1)
    v_mfma_f32_32x32x16_bf16 v[16:31], v[40:43], v[200:203], v[16:31]
    s_waitcnt lgkmcnt(0)
    v_mfma_f32_32x32x16_bf16 v[16:31], v[44:47], v[204:207], v[16:31]
    s_nop 7
    s_nop 3
    v_cvt_pk_bf16_f32 v32, v16, v17
    v_cvt_pk_bf16_f32 v33, v18, v19
    v_cvt_pk_bf16_f32 v34, v24, v25
    v_cvt_pk_bf16_f32 v35, v26, v27
    v_cvt_pk_bf16_f32 v36, v20, v21
    v_cvt_pk_bf16_f32 v37, v22, v23
    v_cvt_pk_bf16_f32 v38, v28, v29
    v_cvt_pk_bf16_f32 v39, v30, v31
Lt1_17:
    s_mul_i32 s24, s22, 262144
    s_add_u32 s24, s24, s48
    buffer_store_dwordx4 v[32:35], v1, s[8:11], s24 offen sc1
    buffer_store_dwordx4 v[36:39], v1, s[8:11], s24 offen offset:1024 sc1
    s_cmp_lg_u32 s20, 0
    s_cbranch_scc1 Lt1_19
    s_waitcnt vmcnt(2)
    v_readfirstlane_b32 s25, v3
    s_cmp_lg_u32 s25, 0
    s_cbranch_scc1 Lt1_19
    s_mov_b32 exec_lo, 0x1
    s_mov_b32 exec_hi, 0x0
    v_mbcnt_lo_u32_b32 v250, -1, 0
    v_mbcnt_hi_u32_b32 v250, -1, v250
    v_lshlrev_b32 v250, 2, v250
Lwf_20:
    buffer_load_dword v251, v250, s[8:11], s55 offen sc1
    s_waitcnt vmcnt(0)
    v_cmp_eq_u32 vcc, 0, v251
    s_cbranch_vccz Lwf_21
    s_add_u32 s23, s23, 1
    s_cmp_gt_u32 s23, 3000000
    s_cbranch_scc1 L_wfail
    s_sleep 2
    s_branch Lwf_20
Lwf_21:
    s_mov_b64 exec, -1
Lt1_19:
    s_xor_b32 s53, s53, 36864
    s_add_u32 s22, s22, 1
    s_cmp_lt_u32 s22, 64
    s_cbranch_scc1 Lt1_15
    s_waitcnt vmcnt(0)
    s_barrier
    s_cmp_lg_u32 s20, 0
    s_cbranch_scc1 Lt1_22
    s_add_u32 s25, s50, 31744
    s_mov_b32 s22, 62
    s_mov_b64 exec, 1
    v_mov_b32 v250, 1
    buffer_store_dword v250, off, s[8:11], s25 sc1
    s_mov_b64 exec, -1
    s_add_u32 s25, s50, 32256
    s_mov_b32 s22, 63
    s_mov_b64 exec, 1
    v_mov_b32 v250, 1
    buffer_store_dword v250, off, s[8:11], s25 sc1
    s_mov_b64 exec, -1
Lt1_22:
    s_waitcnt vmcnt(0)
    s_lshr_b32 s63, s59, 5
    s_and_b32 s21, s59, 31
    s_cmp_ge_u32 s63, 2
    s_cbranch_scc1 L_ffn2
    s_add_u32 s63, s63, 62
    s_and_b32 s21, s59, 31
    s_barrier
    s_load_dwordx2 s[24:25], s[0:1], 40
    s_waitcnt lgkmcnt(0)
    s_mov_b32 s12, s24
    s_mov_b32 s13, s25
    s_mov_b32 s14, 4718592
    s_mov_b32 s15, 0x20000
    s_mul_i32 s44, s21, 147456
    v_and_b32 v1, 63, v0
    v_lshrrev_b32 v2, 2, v1
    v_and_b32 v3, 3, v1
    v_mul_u32_u24 v2, 1152, v2
    v_lshlrev_b32 v3, 4, v3
    v_add_u32 v3, v2, v3
    s_mov_b32 s28, s20
Lti_23:
    s_cmp_ge_u32 s28, 18
    s_cbranch_scc1 Lti_24
    s_mul_i32 s29, s28, 8192
    s_add_u32 s29, s29, 0
    s_mul_i32 s30, s28, 64
    s_add_u32 s30, s30, s44
    s_mov_b32 m0, s29
    s_add_u32 s29, s29, 1024
    s_add_u32 s31, s30, 0
    buffer_load_dwordx4 v3, s[12:15], s31 offen nt lds
    s_mov_b32 m0, s29
    s_add_u32 s29, s29, 1024
    s_add_u32 s31, s30, 18432
    buffer_load_dwordx4 v3, s[12:15], s31 offen nt lds
    s_mov_b32 m0, s29
    s_add_u32 s29, s29, 1024
    s_add_u32 s31, s30, 36864
    buffer_load_dwordx4 v3, s[12:15], s31 offen nt lds
    s_mov_b32 m0, s29
    s_add_u32 s29, s29, 1024
    s_add_u32 s31, s30, 55296
    buffer_load_dwordx4 v3, s[12:15], s31 offen nt lds
    s_mov_b32 m0, s29
    s_add_u32 s29, s29, 1024
    s_add_u32 s31, s30, 73728
    buffer_load_dwordx4 v3, s[12:15], s31 offen nt lds
    s_mov_b32 m0, s29
    s_add_u32 s29, s29, 1024
    s_add_u32 s31, s30, 92160
    buffer_load_dwordx4 v3, s[12:15], s31 offen nt lds
    s_mov_b32 m0, s29
    s_add_u32 s29, s29, 1024
    s_add_u32 s31, s30, 110592
    buffer_load_dwordx4 v3, s[12:15], s31 offen nt lds
    s_mov_b32 m0, s29
    s_add_u32 s29, s29, 1024
    s_add_u32 s31, s30, 129024
    buffer_load_dwordx4 v3, s[12:15], s31 offen nt lds
    s_add_u32 s28, s28, 4
    s_branch Lti_23
Lti_24:
    v_lshrrev_b32 v4, 4, v1
    v_lshrrev_b32 v5, 2, v1
    v_and_b32 v5, 3, v5
    v_and_b32 v6, 3, v1
    v_lshrrev_b32 v7, 1, v4
    v_lshlrev_b32 v7, 2, v7
    v_add_u32 v7, v7, v5
    v_lshlrev_b32 v7, 6, v7
    v_and_b32 v8, 1, v4
    v_lshlrev_b32 v8, 5, v8
    v_lshlrev_b32 v6, 3, v6
    v_add3_u32 v7, v7, v8, v6
    v_lshlrev_b32 v8, 4, v1
    s_waitcnt vmcnt(0)
    s_mov_b32 s28, s20
Lti_25:
    s_cmp_ge_u32 s28, 18
    s_cbranch_scc1 Lti_26
    s_mul_i32 s29, s28, 8192
    s_add_u32 s29, s29, 0
    v_add_u32 v9, s29, v7
    v_add_u32 v10, s29, v8
    ds_read_b64_tr_b16 v[16:17], v9 offset:0
    ds_read_b64_tr_b16 v[18:19], v9 offset:512
    ds_read_b64_tr_b16 v[20:21], v9 offset:1024
    ds_read_b64_tr_b16 v[22:23], v9 offset:1536
    ds_read_b64_tr_b16 v[24:25], v9 offset:2048
    ds_read_b64_tr_b16 v[26:27], v9 offset:2560
    ds_read_b64_tr_b16 v[28:29], v9 offset:3072
    ds_read_b64_tr_b16 v[30:31], v9 offset:3584
    ds_read_b64_tr_b16 v[32:33], v9 offset:4096
    ds_read_b64_tr_b16 v[34:35], v9 offset:4608
    ds_read_b64_tr_b16 v[36:37], v9 offset:5120
    ds_read_b64_tr_b16 v[38:39], v9 offset:5632
    ds_read_b64_tr_b16 v[40:41], v9 offset:6144
    ds_read_b64_tr_b16 v[42:43], v9 offset:6656
    ds_read_b64_tr_b16 v[44:45], v9 offset:7168
    ds_read_b64_tr_b16 v[46:47], v9 offset:7680
    s_waitcnt lgkmcnt(0)
    ds_write_b128 v10, v[16:19] offset:0
    ds_write_b128 v10, v[20:23] offset:1024
    ds_write_b128 v10, v[24:27] offset:2048
    ds_write_b128 v10, v[28:31] offset:3072
    ds_write_b128 v10, v[32:35] offset:4096
    ds_write_b128 v10, v[36:39] offset:5120
    ds_write_b128 v10, v[40:43] offset:6144
    ds_write_b128 v10, v[44:47] offset:7168
    s_waitcnt lgkmcnt(0)
    s_add_u32 s28, s28, 4
    s_branch Lti_25
Lti_26:
    s_barrier
    v_and_b32 v1, 63, v0
    v_lshlrev_b32 v2, 4, v1
    v_and_b32 v3, 31, v1
    v_lshrrev_b32 v4, 5, v1
    v_add_u32 v16, 147456, v2
    v_mov_b32 v12, v16
    v_and_b32 v5, 7, v3
    v_lshlrev_b32 v6, 4, v4
    v_add3_u32 v5, v5, v6, 8
    v_lshlrev_b32 v5, 4, v5
    v_add_u32 v5, 147456, v5
    v_and_b32 v6, 15, v3
    v_lshlrev_b32 v7, 5, v4
    v_add_u32 v6, v6, v7
    v_lshlrev_b32 v6, 4, v6
    v_lshrrev_b32 v7, 4, v3
    v_lshlrev_b32 v7, 3, v7
    v_add_u32 v6, v6, v7
    s_lshl_b32 s59, s20, 10
    v_add_u32 v6, s59, v6
    v_lshrrev_b32 v7, 2, v3
    v_mul_u32_u24 v7, 4608, v7
    v_lshlrev_b32 v8, 6, v4
    v_and_b32 v9, 3, v3
    v_lshlrev_b32 v9, 4, v9
    v_add3_u32 v7, v7, v8, v9
    v_lshlrev_b32 v8, 2, v4
    v_sub_u32 v8, v3, v8
    s_lshl_b32 s59, s20, 11
    v_add_u32 v9, s59, v12
    s_lshl_b32 s59, s20, 13
    v_add_u32 v13, s59, v2
    s_mov_b32 s45, 0x3e0293ee
    s_mov_b32 s46, 0xff800000
    s_mov_b64 exec, 1
    v_mov_b32 v250, 44
Lwi_27:
    buffer_load_dword v251, v250, s[16:19], 0 offen sc1
    s_waitcnt vmcnt(0)
    v_readfirstlane_b32 s38, v251
    s_cmp_lg_u32 s38, 0
    s_cbranch_scc1 Lwi_28
    s_add_u32 s23, s23, 1
    s_cmp_gt_u32 s23, 3000000
    s_cbranch_scc1 L_wfail
    s_sleep 1
    s_branch Lwi_27
Lwi_28:
    s_mov_b64 exec, -1
    s_mov_b32 s22, s63
Lal_29:
    s_lshl_b32 s47, s22, 5
    s_add_u32 s47, s47, s21
    s_lshl_b32 s48, s47, 13
    s_lshl_b32 s49, s47, 12
    s_lshl_b32 s58, s47, 4
    s_add_u32 s50, s58, 6029312
    s_cmp_lg_u32 s20, 0
    s_cbranch_scc1 Lww_31
    s_mov_b32 exec_lo, 0x7
    s_mov_b32 exec_hi, 0x0
    v_mbcnt_lo_u32_b32 v250, -1, 0
    v_mbcnt_hi_u32_b32 v250, -1, v250
    v_lshlrev_b32 v250, 2, v250
Lwf_32:
    buffer_load_dword v251, v250, s[8:11], s50 offen sc1
    s_waitcnt vmcnt(0)
    v_cmp_eq_u32 vcc, 0, v251
    s_cbranch_vccz Lwf_33
    s_add_u32 s23, s23, 1
    s_cmp_gt_u32 s23, 3000000
    s_cbranch_scc1 L_wfail
    s_sleep 2
    s_branch Lwf_32
Lwf_33:
    s_mov_b64 exec, -1
Lww_31:
    s_barrier
    s_lshl_b32 s51, s20, 11
    s_add_u32 s52, s48, s51
    s_add_u32 s53, s51, 147456
    s_add_u32 s54, s53, 0
    s_mov_b32 m0, s54
    s_add_u32 s55, s52, 6291456
    buffer_load_dwordx4 v2, s[8:11], s55 offen sc1 lds
    s_add_u32 s54, s53, 1024
    s_mov_b32 m0, s54
    s_add_u32 s55, s52, 6292480
    buffer_load_dwordx4 v2, s[8:11], s55 offen sc1 lds
    s_add_u32 s54, s53, 8192
    s_mov_b32 m0, s54
    s_add_u32 s55, s52, 23068672
    buffer_load_dwordx4 v2, s[8:11], s55 offen sc1 lds
    s_add_u32 s54, s53, 9216
    s_mov_b32 m0, s54
    s_add_u32 s55, s52, 23069696
    buffer_load_dwordx4 v2, s[8:11], s55 offen sc1 lds
    s_add_u32 s55, s52, 39845888
    buffer_load_dwordx4 v[64:67], v2, s[8:11], s55 offen sc1
    buffer_load_dwordx4 v[68:71], v2, s[8:11], s55 offen offset:1024 sc1
    s_waitcnt vmcnt(2)
    s_barrier
    ds_read_b128 v[16:19], v12 offset:0
    ds_read_b128 v[20:23], v12 offset:1024
    ds_read_b128 v[24:27], v12 offset:2048
    ds_read_b128 v[28:31], v12 offset:3072
    ds_read_b128 v[32:35], v12 offset:4096
    ds_read_b128 v[36:39], v12 offset:5120
    ds_read_b128 v[40:43], v12 offset:6144
    ds_read_b128 v[44:47], v12 offset:7168
    ds_read_b128 v[48:51], v12 offset:8192
    ds_read_b128 v[52:55], v12 offset:9216
    ds_read_b128 v[56:59], v12 offset:10240
    s_waitcnt lgkmcnt(2)
    v_mfma_f32_32x32x16_bf16 v[80:95], v[48:51], v[16:19], 0
    ds_read_b128 v[60:63], v12 offset:11264
    s_waitcnt lgkmcnt(2)
    v_mfma_f32_32x32x16_bf16 v[80:95], v[52:55], v[20:23], v[80:95]
    ds_read_b128 v[48:51], v12 offset:12288
    s_waitcnt lgkmcnt(2)
    v_mfma_f32_32x32x16_bf16 v[80:95], v[56:59], v[24:27], v[80:95]
    ds_read_b128 v[52:55], v12 offset:13312
    s_waitcnt lgkmcnt(2)
    v_mfma_f32_32x32x16_bf16 v[80:95], v[60:63], v[28:31], v[80:95]
    ds_read_b128 v[56:59], v12 offset:14336
    s_waitcnt lgkmcnt(2)
    v_mfma_f32_32x32x16_bf16 v[80:95], v[48:51], v[32:35], v[80:95]
    ds_read_b128 v[60:63], v12 offset:15360
    s_waitcnt lgkmcnt(2)
    v_mfma_f32_32x32x16_bf16 v[80:95], v[52:55], v[36:39], v[80:95]
    s_waitcnt lgkmcnt(1)
    v_mfma_f32_32x32x16_bf16 v[80:95], v[56:59], v[40:43], v[80:95]
    s_waitcnt lgkmcnt(0)
    v_mfma_f32_32x32x16_bf16 v[80:95], v[60:63], v[44:47], v[80:95]
    s_add_u32 s50, s58, 6062080
    s_cmp_lg_u32 s20, 0
    s_cbranch_scc1 Lww_34
    s_mov_b32 exec_lo, 0x1
    s_mov_b32 exec_hi, 0x0
    v_mbcnt_lo_u32_b32 v250, -1, 0
    v_mbcnt_hi_u32_b32 v250, -1, v250
    v_lshlrev_b32 v250, 2, v250
Lwf_35:
    buffer_load_dword v251, v250, s[8:11], s50 offen sc1
    s_waitcnt vmcnt(0)
    v_cmp_eq_u32 vcc, 0, v251
    s_cbranch_vccz Lwf_36
    s_add_u32 s23, s23, 1
    s_cmp_gt_u32 s23, 3000000
    s_cbranch_scc1 L_wfail
    s_sleep 1
    s_branch Lwf_35
Lwf_36:
    s_mov_b64 exec, -1
Lww_34:
    s_barrier
    s_lshl_b32 s51, s20, 10
    s_add_u32 s54, s51, 147456
    s_mov_b32 m0, s54
    s_add_u32 s55, s49, s51
    s_add_u32 s55, s55, 56623104
    buffer_load_dwordx4 v2, s[8:11], s55 offen sc1 lds
    s_add_u32 s56, s49, 65011712
    buffer_load_dword v124, v6, s[8:11], s56 offen sc1
    buffer_load_dword v125, v6, s[8:11], s56 offen offset:256 sc1
    v_mov_b32 v126, 0
    v_mov_b32 v127, 0
    v_cmp_le_i32 vcc, 0, v8
    v_mov_b32 v10, s46
    s_nop 0
    v_cndmask_b32 v80, v10, v80, vcc
    v_cmp_le_i32 vcc, 1, v8
    v_mov_b32 v10, s46
    s_nop 0
    v_cndmask_b32 v81, v10, v81, vcc
    v_cmp_le_i32 vcc, 2, v8
    v_mov_b32 v10, s46
    s_nop 0
    v_cndmask_b32 v82, v10, v82, vcc
    v_cmp_le_i32 vcc, 3, v8
    v_mov_b32 v10, s46
    s_nop 0
    v_cndmask_b32 v83, v10, v83, vcc
    v_cmp_le_i32 vcc, 8, v8
    v_mov_b32 v10, s46
    s_nop 0
    v_cndmask_b32 v84, v10, v84, vcc
    v_cmp_le_i32 vcc, 9, v8
    v_mov_b32 v10, s46
    s_nop 0
    v_cndmask_b32 v85, v10, v85, vcc
    v_cmp_le_i32 vcc, 10, v8
    v_mov_b32 v10, s46
    s_nop 0
    v_cndmask_b32 v86, v10, v86, vcc
    v_cmp_le_i32 vcc, 11, v8
    v_mov_b32 v10, s46
    s_nop 0
    v_cndmask_b32 v87, v10, v87, vcc
    v_cmp_le_i32 vcc, 16, v8
    v_mov_b32 v10, s46
    s_nop 0
    v_cndmask_b32 v88, v10, v88, vcc
    v_cmp_le_i32 vcc, 17, v8
    v_mov_b32 v10, s46
    s_nop 0
    v_cndmask_b32 v89, v10, v89, vcc
    v_cmp_le_i32 vcc, 18, v8
    v_mov_b32 v10, s46
    s_nop 0
    v_cndmask_b32 v90, v10, v90, vcc
    v_cmp_le_i32 vcc, 19, v8
    v_mov_b32 v10, s46
    s_nop 0
    v_cndmask_b32 v91, v10, v91, vcc
    v_cmp_le_i32 vcc, 24, v8
    v_mov_b32 v10, s46
    s_nop 0
    v_cndmask_b32 v92, v10, v92, vcc
    v_cmp_le_i32 vcc, 25, v8
    v_mov_b32 v10, s46
    s_nop 0
    v_cndmask_b32 v93, v10, v93, vcc
    v_cmp_le_i32 vcc, 26, v8
    v_mov_b32 v10, s46
    s_nop 0
    v_cndmask_b32 v94, v10, v94, vcc
    v_cmp_le_i32 vcc, 27, v8
    v_mov_b32 v10, s46
    s_nop 0
    v_cndmask_b32 v95, v10, v95, vcc
    s_waitcnt vmcnt(2)
    s_barrier
    ds_read_b128 v[48:51], v5 offset:0
    ds_read_b128 v[52:55], v5 offset:512
    ds_read_b128 v[56:59], v5 offset:1024
    s_waitcnt lgkmcnt(2)
    v_mfma_f32_32x32x16_bf16 v[96:111], v[48:51], v[16:19], 0
    ds_read_b128 v[60:63], v5 offset:1536
    s_waitcnt lgkmcnt(2)
    v_mfma_f32_32x32x16_bf16 v[96:111], v[52:55], v[20:23], v[96:111]
    ds_read_b128 v[48:51], v5 offset:2048
    s_waitcnt lgkmcnt(2)
    v_mfma_f32_32x32x16_bf16 v[96:111], v[56:59], v[24:27], v[96:111]
    ds_read_b128 v[52:55], v5 offset:2560
    s_waitcnt lgkmcnt(2)
    v_mfma_f32_32x32x16_bf16 v[96:111], v[60:63], v[28:31], v[96:111]
    ds_read_b128 v[56:59], v5 offset:3072
    s_waitcnt lgkmcnt(2)
    v_mfma_f32_32x32x16_bf16 v[96:111], v[48:51], v[32:35], v[96:111]
    ds_read_b128 v[60:63], v5 offset:3584
    s_waitcnt lgkmcnt(2)
    v_mfma_f32_32x32x16_bf16 v[96:111], v[52:55], v[36:39], v[96:111]
    s_waitcnt lgkmcnt(1)
    v_mfma_f32_32x32x16_bf16 v[96:111], v[56:59], v[40:43], v[96:111]
    s_waitcnt lgkmcnt(0)
    v_mfma_f32_32x32x16_bf16 v[96:111], v[60:63], v[44:47], v[96:111]
    v_max3_f32 v10, v80, v81, v82
    v_max3_f32 v10, v10, v83, v84
    v_max3_f32 v10, v10, v85, v86
    v_max3_f32 v10, v10, v87, v88
    v_max3_f32 v10, v10, v89, v90
    v_max3_f32 v10, v10, v91, v92
    v_max3_f32 v10, v10, v93, v94
    v_max_f32 v10, v10, v95
    s_nop 3
    v_max3_f32 v10, v10, v96, v97
    v_max3_f32 v10, v10, v98, v99
    v_mov_b32 v11, v10
    s_nop 1
    v_permlane32_swap_b32 v10, v11
    v_max_f32 v10, v10, v11
    v_mul_f32 v10, s45, v10
    v_fma_f32 v80, v80, s45, -v10
    v_fma_f32 v81, v81, s45, -v10
    v_fma_f32 v82, v82, s45, -v10
    v_fma_f32 v83, v83, s45, -v10
    v_fma_f32 v84, v84, s45, -v10
    v_fma_f32 v85, v85, s45, -v10
    v_fma_f32 v86, v86, s45, -v10
    v_fma_f32 v87, v87, s45, -v10
    v_fma_f32 v88, v88, s45, -v10
    v_fma_f32 v89, v89, s45, -v10
    v_fma_f32 v90, v90, s45, -v10
    v_fma_f32 v91, v91, s45, -v10
    v_fma_f32 v92, v92, s45, -v10
    v_fma_f32 v93, v93, s45, -v10
    v_fma_f32 v94, v94, s45, -v10
    v_fma_f32 v95, v95, s45, -v10
    v_fma_f32 v96, v96, s45, -v10
    v_fma_f32 v97, v97, s45, -v10
    v_fma_f32 v98, v98, s45, -v10
    v_fma_f32 v99, v99, s45, -v10
    v_exp_f32 v80, v80
    v_exp_f32 v81, v81
    v_exp_f32 v82, v82
    v_exp_f32 v83, v83
    v_exp_f32 v84, v84
    v_exp_f32 v85, v85
    v_exp_f32 v86, v86
    v_exp_f32 v87, v87
    v_exp_f32 v88, v88
    v_exp_f32 v89, v89
    v_exp_f32 v90, v90
    v_exp_f32 v91, v91
    v_exp_f32 v92, v92
    v_exp_f32 v93, v93
    v_exp_f32 v94, v94
    v_exp_f32 v95, v95
    v_exp_f32 v96, v96
    v_exp_f32 v97, v97
    v_exp_f32 v98, v98
    v_exp_f32 v99, v99
    s_nop 0
    v_add_f32 v11, v80, v81
    v_add_f32 v14, v82, v83
    v_add_f32 v11, v11, v84
    v_add_f32 v14, v14, v85
    v_add_f32 v11, v11, v86
    v_add_f32 v14, v14, v87
    v_add_f32 v11, v11, v88
    v_add_f32 v14, v14, v89
    v_add_f32 v11, v11, v90
    v_add_f32 v14, v14, v91
    v_add_f32 v11, v11, v92
    v_add_f32 v14, v14, v93
    v_add_f32 v11, v11, v94
    v_add_f32 v14, v14, v95
    v_add_f32 v11, v11, v96
    v_add_f32 v14, v14, v97
    v_add_f32 v11, v11, v98
    v_add_f32 v14, v14, v99
    v_add_f32 v11, v11, v14
    v_mov_b32 v14, v11
    s_nop 1
    v_permlane32_swap_b32 v11, v14
    v_add_f32 v11, v11, v14
    v_rcp_f32 v14, v11
    s_nop 0
    v_pk_mul_f32 v[80:81], v[80:81], v[14:15] op_sel_hi:[1,0]
    v_pk_mul_f32 v[82:83], v[82:83], v[14:15] op_sel_hi:[1,0]
    v_pk_mul_f32 v[84:85], v[84:85], v[14:15] op_sel_hi:[1,0]
    v_pk_mul_f32 v[86:87], v[86:87], v[14:15] op_sel_hi:[1,0]
    v_pk_mul_f32 v[88:89], v[88:89], v[14:15] op_sel_hi:[1,0]
    v_pk_mul_f32 v[90:91], v[90:91], v[14:15] op_sel_hi:[1,0]
    v_pk_mul_f32 v[92:93], v[92:93], v[14:15] op_sel_hi:[1,0]
    v_pk_mul_f32 v[94:95], v[94:95], v[14:15] op_sel_hi:[1,0]
    v_pk_mul_f32 v[96:97], v[96:97], v[14:15] op_sel_hi:[1,0]
    v_pk_mul_f32 v[98:99], v[98:99], v[14:15] op_sel_hi:[1,0]
    v_cvt_pk_bf16_f32 v112, v80, v81
    v_cvt_pk_bf16_f32 v113, v82, v83
    v_cvt_pk_bf16_f32 v114, v88, v89
    v_cvt_pk_bf16_f32 v115, v90, v91
    v_cvt_pk_bf16_f32 v116, v84, v85
    v_cvt_pk_bf16_f32 v117, v86, v87
    v_cvt_pk_bf16_f32 v118, v92, v93
    v_cvt_pk_bf16_f32 v119, v94, v95
    v_cvt_pk_bf16_f32 v120, v96, v97
    v_cvt_pk_bf16_f32 v121, v98, v99
    v_mov_b32 v122, 0
    v_mov_b32 v123, 0
    s_waitcnt vmcnt(0)
    s_nop 1
    v_mfma_f32_32x32x16_bf16 v[128:143], v[64:67], v[112:115], 0
    v_mfma_f32_32x32x16_bf16 v[128:143], v[68:71], v[116:119], v[128:143]
    v_mfma_f32_32x32x16_bf16 v[128:143], v[124:127], v[120:123], v[128:143]
    ds_read_b128 a[0:3], v13 offset:0
    ds_read_b128 a[4:7], v13 offset:1024
    ds_read_b128 a[8:11], v13 offset:2048
    ds_read_b128 a[12:15], v13 offset:3072
    ds_read_b128 a[16:19], v13 offset:4096
    ds_read_b128 a[20:23], v13 offset:5120
    ds_read_b128 a[24:27], v13 offset:6144
    s_nop 5
    v_cvt_pk_bf16_f32 v176, v128, v129
    v_cvt_pk_bf16_f32 v177, v130, v131
    v_cvt_pk_bf16_f32 v178, v132, v133
    v_cvt_pk_bf16_f32 v179, v134, v135
    v_cvt_pk_bf16_f32 v180, v136, v137
    v_cvt_pk_bf16_f32 v181, v138, v139
    v_cvt_pk_bf16_f32 v182, v140, v141
    v_cvt_pk_bf16_f32 v183, v142, v143
    ds_write_b128 v9, v[176:179] offset:8192
    ds_write_b128 v9, v[180:183] offset:9216
    s_waitcnt lgkmcnt(0)
    s_barrier
    ds_read_b128 v[144:147], v12 offset:8192
    ds_read_b128 v[148:151], v12 offset:9216
    ds_read_b128 v[152:155], v12 offset:10240
    ds_read_b128 v[156:159], v12 offset:11264
    ds_read_b128 v[160:163], v12 offset:12288
    ds_read_b128 v[164:167], v12 offset:13312
    ds_read_b128 v[168:171], v12 offset:14336
    ds_read_b128 v[172:175], v12 offset:15360
    s_mul_i32 s57, s47, 36864
    s_add_u32 s57, s57, 73400320
    s_lshl_b32 s59, s20, 8
    s_add_u32 s57, s57, s59
    s_waitcnt lgkmcnt(0)
    s_cmp_lt_u32 s20, 2
    s_cbranch_scc0 Lal_37
    v_mov_b32 v15, v13
    s_waitcnt lgkmcnt(6)
    v_mfma_f32_32x32x16_bf16 v[192:207], a[0:3], v[144:147], 0
    ds_read_b128 a[28:31], v15 offset:7168
    s_waitcnt lgkmcnt(6)
    v_mfma_f32_32x32x16_bf16 v[192:207], a[4:7], v[148:151], v[192:207]
    ds_read_b128 a[0:3], v15 offset:32768
    s_waitcnt lgkmcnt(6)
    v_mfma_f32_32x32x16_bf16 v[192:207], a[8:11], v[152:155], v[192:207]
    ds_read_b128 a[4:7], v15 offset:33792
    s_waitcnt lgkmcnt(6)
    v_mfma_f32_32x32x16_bf16 v[192:207], a[12:15], v[156:159], v[192:207]
    ds_read_b128 a[8:11], v15 offset:34816
    s_waitcnt lgkmcnt(6)
    v_mfma_f32_32x32x16_bf16 v[192:207], a[16:19], v[160:163], v[192:207]
    ds_read_b128 a[12:15], v15 offset:35840
    s_waitcnt lgkmcnt(6)
    v_mfma_f32_32x32x16_bf16 v[192:207], a[20:23], v[164:167], v[192:207]
    ds_read_b128 a[16:19], v15 offset:36864
    s_waitcnt lgkmcnt(6)
    v_mfma_f32_32x32x16_bf16 v[192:207], a[24:27], v[168:171], v[192:207]
    ds_read_b128 a[20:23], v15 offset:37888
    s_waitcnt lgkmcnt(6)
    v_mfma_f32_32x32x16_bf16 v[192:207], a[28:31], v[172:175], v[192:207]
    ds_read_b128 a[24:27], v15 offset:38912
    s_waitcnt lgkmcnt(6)
    v_mfma_f32_32x32x16_bf16 v[208:223], a[0:3], v[144:147], 0
    ds_read_b128 a[28:31], v15 offset:39936
    s_waitcnt lgkmcnt(6)
    v_mfma_f32_32x32x16_bf16 v[208:223], a[4:7], v[148:151], v[208:223]
    v_add_u32 v15, 65536, v15
    ds_read_b128 a[0:3], v15 offset:0
    s_waitcnt lgkmcnt(6)
    v_mfma_f32_32x32x16_bf16 v[208:223], a[8:11], v[152:155], v[208:223]
    ds_read_b128 a[4:7], v15 offset:1024
    s_waitcnt lgkmcnt(6)
    v_mfma_f32_32x32x16_bf16 v[208:223], a[12:15], v[156:159], v[208:223]
    ds_read_b128 a[8:11], v15 offset:2048
    v_cvt_pk_bf16_f32 v176, v192, v193
    v_cvt_pk_bf16_f32 v177, v194, v195
    v_cvt_pk_bf16_f32 v178, v196, v197
    v_cvt_pk_bf16_f32 v179, v198, v199
    v_cvt_pk_bf16_f32 v180, v200, v201
    v_cvt_pk_bf16_f32 v181, v202, v203
    v_cvt_pk_bf16_f32 v182, v204, v205
    v_cvt_pk_bf16_f32 v183, v206, v207
    buffer_store_dwordx4 v[176:179], v7, s[8:11], s57 offen offset:0 sc1
    buffer_store_dwordx4 v[180:183], v7, s[8:11], s57 offen offset:128 sc1
    s_add_u32 s57, s57, 1024
    s_nop 1
    s_waitcnt lgkmcnt(6)
    v_mfma_f32_32x32x16_bf16 v[208:223], a[16:19], v[160:163], v[208:223]
    ds_read_b128 a[12:15], v15 offset:3072
    s_waitcnt lgkmcnt(6)
    v_mfma_f32_32x32x16_bf16 v[208:223], a[20:23], v[164:167], v[208:223]
    ds_read_b128 a[16:19], v15 offset:4096
    s_waitcnt lgkmcnt(6)
    v_mfma_f32_32x32x16_bf16 v[208:223], a[24:27], v[168:171], v[208:223]
    ds_read_b128 a[20:23], v15 offset:5120
    s_waitcnt lgkmcnt(6)
    v_mfma_f32_32x32x16_bf16 v[208:223], a[28:31], v[172:175], v[208:223]
    ds_read_b128 a[24:27], v15 offset:6144
    s_waitcnt lgkmcnt(6)
    v_mfma_f32_32x32x16_bf16 v[192:207], a[0:3], v[144:147], 0
    ds_read_b128 a[28:31], v15 offset:7168
    s_waitcnt lgkmcnt(6)
    v_mfma_f32_32x32x16_bf16 v[192:207], a[4:7], v[148:151], v[192:207]
    ds_read_b128 a[0:3], v15 offset:32768
    s_waitcnt lgkmcnt(6)
    v_mfma_f32_32x32x16_bf16 v[192:207], a[8:11], v[152:155], v[192:207]
    ds_read_b128 a[4:7], v15 offset:33792
    s_waitcnt lgkmcnt(6)
    v_mfma_f32_32x32x16_bf16 v[192:207], a[12:15], v[156:159], v[192:207]
    ds_read_b128 a[8:11], v15 offset:34816
    v_cvt_pk_bf16_f32 v176, v208, v209
    v_cvt_pk_bf16_f32 v177, v210, v211
    v_cvt_pk_bf16_f32 v178, v212, v213
    v_cvt_pk_bf16_f32 v179, v214, v215
    v_cvt_pk_bf16_f32 v180, v216, v217
    v_cvt_pk_bf16_f32 v181, v218, v219
    v_cvt_pk_bf16_f32 v182, v220, v221
    v_cvt_pk_bf16_f32 v183, v222, v223
    buffer_store_dwordx4 v[176:179], v7, s[8:11], s57 offen offset:0 sc1
    buffer_store_dwordx4 v[180:183], v7, s[8:11], s57 offen offset:128 sc1
    s_add_u32 s57, s57, 1024
    s_nop 1
    s_waitcnt lgkmcnt(6)
    v_mfma_f32_32x32x16_bf16 v[192:207], a[16:19], v[160:163], v[192:207]
    ds_read_b128 a[12:15], v15 offset:35840
    s_waitcnt lgkmcnt(6)
    v_mfma_f32_32x32x16_bf16 v[192:207], a[20:23], v[164:167], v[192:207]
    ds_read_b128 a[16:19], v15 offset:36864
    s_waitcnt lgkmcnt(6)
    v_mfma_f32_32x32x16_bf16 v[192:207], a[24:27], v[168:171], v[192:207]
    ds_read_b128 a[20:23], v15 offset:37888
    s_waitcnt lgkmcnt(6)
    v_mfma_f32_32x32x16_bf16 v[192:207], a[28:31], v[172:175], v[192:207]
    ds_read_b128 a[24:27], v15 offset:38912
    s_waitcnt lgkmcnt(6)
    v_mfma_f32_32x32x16_bf16 v[208:223], a[0:3], v[144:147], 0
    ds_read_b128 a[28:31], v15 offset:39936
    s_waitcnt lgkmcnt(6)
    v_mfma_f32_32x32x16_bf16 v[208:223], a[4:7], v[148:151], v[208:223]
    v_add_u32 v15, 65536, v15
    ds_read_b128 a[0:3], v15 offset:0
    s_waitcnt lgkmcnt(6)
    v_mfma_f32_32x32x16_bf16 v[208:223], a[8:11], v[152:155], v[208:223]
    ds_read_b128 a[4:7], v15 offset:1024
    s_waitcnt lgkmcnt(6)
    v_mfma_f32_32x32x16_bf16 v[208:223], a[12:15], v[156:159], v[208:223]
    ds_read_b128 a[8:11], v15 offset:2048
    v_cvt_pk_bf16_f32 v176, v192, v193
    v_cvt_pk_bf16_f32 v177, v194, v195
    v_cvt_pk_bf16_f32 v178, v196, v197
    v_cvt_pk_bf16_f32 v179, v198, v199
    v_cvt_pk_bf16_f32 v180, v200, v201
    v_cvt_pk_bf16_f32 v181, v202, v203
    v_cvt_pk_bf16_f32 v182, v204, v205
    v_cvt_pk_bf16_f32 v183, v206, v207
    buffer_store_dwordx4 v[176:179], v7, s[8:11], s57 offen offset:0 sc1
    buffer_store_dwordx4 v[180:183], v7, s[8:11], s57 offen offset:128 sc1
    s_add_u32 s57, s57, 1024
    s_nop 1
    s_waitcnt lgkmcnt(6)
    v_mfma_f32_32x32x16_bf16 v[208:223], a[16:19], v[160:163], v[208:223]
    ds_read_b128 a[12:15], v15 offset:3072
    s_waitcnt lgkmcnt(6)
    v_mfma_f32_32x32x16_bf16 v[208:223], a[20:23], v[164:167], v[208:223]
    ds_read_b128 a[16:19], v15 offset:4096
    s_waitcnt lgkmcnt(6)
    v_mfma_f32_32x32x16_bf16 v[208:223], a[24:27], v[168:171], v[208:223]
    ds_read_b128 a[20:23], v15 offset:5120
    s_waitcnt lgkmcnt(6)
    v_mfma_f32_32x32x16_bf16 v[208:223], a[28:31], v[172:175], v[208:223]
    ds_read_b128 a[24:27], v15 offset:6144
    s_waitcnt lgkmcnt(6)
    v_mfma_f32_32x32x16_bf16 v[192:207], a[0:3], v[144:147], 0
    ds_read_b128 a[28:31], v15 offset:7168
    s_waitcnt lgkmcnt(6)
    v_mfma_f32_32x32x16_bf16 v[192:207], a[4:7], v[148:151], v[192:207]
    s_waitcnt lgkmcnt(5)
    v_mfma_f32_32x32x16_bf16 v[192:207], a[8:11], v[152:155], v[192:207]
    s_waitcnt lgkmcnt(4)
    v_mfma_f32_32x32x16_bf16 v[192:207], a[12:15], v[156:159], v[192:207]
    v_cvt_pk_bf16_f32 v176, v208, v209
    v_cvt_pk_bf16_f32 v177, v210, v211
    v_cvt_pk_bf16_f32 v178, v212, v213
    v_cvt_pk_bf16_f32 v179, v214, v215
    v_cvt_pk_bf16_f32 v180, v216, v217
    v_cvt_pk_bf16_f32 v181, v218, v219
    v_cvt_pk_bf16_f32 v182, v220, v221
    v_cvt_pk_bf16_f32 v183, v222, v223
    buffer_store_dwordx4 v[176:179], v7, s[8:11], s57 offen offset:0 sc1
    buffer_store_dwordx4 v[180:183], v7, s[8:11], s57 offen offset:128 sc1
    s_add_u32 s57, s57, 1024
    s_nop 1
    s_waitcnt lgkmcnt(3)
    v_mfma_f32_32x32x16_bf16 v[192:207], a[16:19], v[160:163], v[192:207]
    s_waitcnt lgkmcnt(2)
    v_mfma_f32_32x32x16_bf16 v[192:207], a[20:23], v[164:167], v[192:207]
    s_waitcnt lgkmcnt(1)
    v_mfma_f32_32x32x16_bf16 v[192:207], a[24:27], v[168:171], v[192:207]
    s_waitcnt lgkmcnt(0)
    v_mfma_f32_32x32x16_bf16 v[192:207], a[28:31], v[172:175], v[192:207]
    s_nop 7
    s_nop 3
    v_cvt_pk_bf16_f32 v176, v192, v193
    v_cvt_pk_bf16_f32 v177, v194, v195
    v_cvt_pk_bf16_f32 v178, v196, v197
    v_cvt_pk_bf16_f32 v179, v198, v199
    v_cvt_pk_bf16_f32 v180, v200, v201
    v_cvt_pk_bf16_f32 v181, v202, v203
    v_cvt_pk_bf16_f32 v182, v204, v205
    v_cvt_pk_bf16_f32 v183, v206, v207
    buffer_store_dwordx4 v[176:179], v7, s[8:11], s57 offen offset:0 sc1
    buffer_store_dwordx4 v[180:183], v7, s[8:11], s57 offen offset:128 sc1
    s_add_u32 s57, s57, 1024
    s_nop 1
    s_branch Lal_38
Lal_37:
    v_mov_b32 v15, v13
    s_waitcnt lgkmcnt(6)
    v_mfma_f32_32x32x16_bf16 v[192:207], a[0:3], v[144:147], 0
    ds_read_b128 a[28:31], v15 offset:7168
    s_waitcnt lgkmcnt(6)
    v_mfma_f32_32x32x16_bf16 v[192:207], a[4:7], v[148:151], v[192:207]
    ds_read_b128 a[0:3], v15 offset:32768
    s_waitcnt lgkmcnt(6)
    v_mfma_f32_32x32x16_bf16 v[192:207], a[8:11], v[152:155], v[192:207]
    ds_read_b128 a[4:7], v15 offset:33792
    s_waitcnt lgkmcnt(6)
    v_mfma_f32_32x32x16_bf16 v[192:207], a[12:15], v[156:159], v[192:207]
    ds_read_b128 a[8:11], v15 offset:34816
    s_waitcnt lgkmcnt(6)
    v_mfma_f32_32x32x16_bf16 v[192:207], a[16:19], v[160:163], v[192:207]
    ds_read_b128 a[12:15], v15 offset:35840
    s_waitcnt lgkmcnt(6)
    v_mfma_f32_32x32x16_bf16 v[192:207], a[20:23], v[164:167], v[192:207]
    ds_read_b128 a[16:19], v15 offset:36864
    s_waitcnt lgkmcnt(6)
    v_mfma_f32_32x32x16_bf16 v[192:207], a[24:27], v[168:171], v[192:207]
    ds_read_b128 a[20:23], v15 offset:37888
    s_waitcnt lgkmcnt(6)
    v_mfma_f32_32x32x16_bf16 v[192:207], a[28:31], v[172:175], v[192:207]
    ds_read_b128 a[24:27], v15 offset:38912
    s_waitcnt lgkmcnt(6)
    v_mfma_f32_32x32x16_bf16 v[208:223], a[0:3], v[144:147], 0
    ds_read_b128 a[28:31], v15 offset:39936
    s_waitcnt lgkmcnt(6)
    v_mfma_f32_32x32x16_bf16 v[208:223], a[4:7], v[148:151], v[208:223]
    v_add_u32 v15, 65536, v15
    ds_read_b128 a[0:3], v15 offset:0
    s_waitcnt lgkmcnt(6)
    v_mfma_f32_32x32x16_bf16 v[208:223], a[8:11], v[152:155], v[208:223]
    ds_read_b128 a[4:7], v15 offset:1024
    s_waitcnt lgkmcnt(6)
    v_mfma_f32_32x32x16_bf16 v[208:223], a[12:15], v[156:159], v[208:223]
    ds_read_b128 a[8:11], v15 offset:2048
    v_cvt_pk_bf16_f32 v176, v192, v193
    v_cvt_pk_bf16_f32 v177, v194, v195
    v_cvt_pk_bf16_f32 v178, v196, v197
    v_cvt_pk_bf16_f32 v179, v198, v199
    v_cvt_pk_bf16_f32 v180, v200, v201
    v_cvt_pk_bf16_f32 v181, v202, v203
    v_cvt_pk_bf16_f32 v182, v204, v205
    v_cvt_pk_bf16_f32 v183, v206, v207
    buffer_store_dwordx4 v[176:179], v7, s[8:11], s57 offen offset:0 sc1
    buffer_store_dwordx4 v[180:183], v7, s[8:11], s57 offen offset:128 sc1
    s_add_u32 s57, s57, 1024
    s_nop 1
    s_waitcnt lgkmcnt(6)
    v_mfma_f32_32x32x16_bf16 v[208:223], a[16:19], v[160:163], v[208:223]
    ds_read_b128 a[12:15], v15 offset:3072
    s_waitcnt lgkmcnt(6)
    v_mfma_f32_32x32x16_bf16 v[208:223], a[20:23], v[164:167], v[208:223]
    ds_read_b128 a[16:19], v15 offset:4096
    s_waitcnt lgkmcnt(6)
    v_mfma_f32_32x32x16_bf16 v[208:223], a[24:27], v[168:171], v[208:223]
    ds_read_b128 a[20:23], v15 offset:5120
    s_waitcnt lgkmcnt(6)
    v_mfma_f32_32x32x16_bf16 v[208:223], a[28:31], v[172:175], v[208:223]
    ds_read_b128 a[24:27], v15 offset:6144
    s_waitcnt lgkmcnt(6)
    v_mfma_f32_32x32x16_bf16 v[192:207], a[0:3], v[144:147], 0
    ds_read_b128 a[28:31], v15 offset:7168
    s_waitcnt lgkmcnt(6)
    v_mfma_f32_32x32x16_bf16 v[192:207], a[4:7], v[148:151], v[192:207]
    ds_read_b128 a[0:3], v15 offset:32768
    s_waitcnt lgkmcnt(6)
    v_mfma_f32_32x32x16_bf16 v[192:207], a[8:11], v[152:155], v[192:207]
    ds_read_b128 a[4:7], v15 offset:33792
    s_waitcnt lgkmcnt(6)
    v_mfma_f32_32x32x16_bf16 v[192:207], a[12:15], v[156:159], v[192:207]
    ds_read_b128 a[8:11], v15 offset:34816
    v_cvt_pk_bf16_f32 v176, v208, v209
    v_cvt_pk_bf16_f32 v177, v210, v211
    v_cvt_pk_bf16_f32 v178, v212, v213
    v_cvt_pk_bf16_f32 v179, v214, v215
    v_cvt_pk_bf16_f32 v180, v216, v217
    v_cvt_pk_bf16_f32 v181, v218, v219
    v_cvt_pk_bf16_f32 v182, v220, v221
    v_cvt_pk_bf16_f32 v183, v222, v223
    buffer_store_dwordx4 v[176:179], v7, s[8:11], s57 offen offset:0 sc1
    buffer_store_dwordx4 v[180:183], v7, s[8:11], s57 offen offset:128 sc1
    s_add_u32 s57, s57, 1024
    s_nop 1
    s_waitcnt lgkmcnt(6)
    v_mfma_f32_32x32x16_bf16 v[192:207], a[16:19], v[160:163], v[192:207]
    ds_read_b128 a[12:15], v15 offset:35840
    s_waitcnt lgkmcnt(6)
    v_mfma_f32_32x32x16_bf16 v[192:207], a[20:23], v[164:167], v[192:207]
    ds_read_b128 a[16:19], v15 offset:36864
    s_waitcnt lgkmcnt(6)
    v_mfma_f32_32x32x16_bf16 v[192:207], a[24:27], v[168:171], v[192:207]
    ds_read_b128 a[20:23], v15 offset:37888
    s_waitcnt lgkmcnt(6)
    v_mfma_f32_32x32x16_bf16 v[192:207], a[28:31], v[172:175], v[192:207]
    ds_read_b128 a[24:27], v15 offset:38912
    s_waitcnt lgkmcnt(6)
    v_mfma_f32_32x32x16_bf16 v[208:223], a[0:3], v[144:147], 0
    ds_read_b128 a[28:31], v15 offset:39936
    s_waitcnt lgkmcnt(6)
    v_mfma_f32_32x32x16_bf16 v[208:223], a[4:7], v[148:151], v[208:223]
    s_waitcnt lgkmcnt(5)
    v_mfma_f32_32x32x16_bf16 v[208:223], a[8:11], v[152:155], v[208:223]
    s_waitcnt lgkmcnt(4)
    v_mfma_f32_32x32x16_bf16 v[208:223], a[12:15], v[156:159], v[208:223]
    v_cvt_pk_bf16_f32 v176, v192, v193
    v_cvt_pk_bf16_f32 v177, v194, v195
    v_cvt_pk_bf16_f32 v178, v196, v197
    v_cvt_pk_bf16_f32 v179, v198, v199
    v_cvt_pk_bf16_f32 v180, v200, v201
    v_cvt_pk_bf16_f32 v181, v202, v203
    v_cvt_pk_bf16_f32 v182, v204, v205
    v_cvt_pk_bf16_f32 v183, v206, v207
    buffer_store_dwordx4 v[176:179], v7, s[8:11], s57 offen offset:0 sc1
    buffer_store_dwordx4 v[180:183], v7, s[8:11], s57 offen offset:128 sc1
    s_add_u32 s57, s57, 1024
    s_nop 1
    s_waitcnt lgkmcnt(3)
    v_mfma_f32_32x32x16_bf16 v[208:223], a[16:19], v[160:163], v[208:223]
    s_waitcnt lgkmcnt(2)
    v_mfma_f32_32x32x16_bf16 v[208:223], a[20:23], v[164:167], v[208:223]
    s_waitcnt lgkmcnt(1)
    v_mfma_f32_32x32x16_bf16 v[208:223], a[24:27], v[168:171], v[208:223]
    s_waitcnt lgkmcnt(0)
    v_mfma_f32_32x32x16_bf16 v[208:223], a[28:31], v[172:175], v[208:223]
    s_nop 7
    s_nop 3
    v_cvt_pk_bf16_f32 v176, v208, v209
    v_cvt_pk_bf16_f32 v177, v210, v211
    v_cvt_pk_bf16_f32 v178, v212, v213
    v_cvt_pk_bf16_f32 v179, v214, v215
    v_cvt_pk_bf16_f32 v180, v216, v217
    v_cvt_pk_bf16_f32 v181, v218, v219
    v_cvt_pk_bf16_f32 v182, v220, v221
    v_cvt_pk_bf16_f32 v183, v222, v223
    buffer_store_dwordx4 v[176:179], v7, s[8:11], s57 offen offset:0 sc1
    buffer_store_dwordx4 v[180:183], v7, s[8:11], s57 offen offset:128 sc1
    s_add_u32 s57, s57, 1024
    s_nop 1
Lal_38:
    s_waitcnt vmcnt(0)
    s_barrier
    s_cmp_lg_u32 s20, 0
    s_cbranch_scc1 Lal_39
    s_mul_i32 s50, s22, 128
    s_add_u32 s50, s50, 6094848
    s_mul_i32 s37, s21, 4
    s_add_u32 s50, s50, s37
    s_mov_b64 exec, 1
    v_mov_b32 v250, 1
    buffer_store_dword v250, off, s[8:11], s50 sc1
    s_mov_b64 exec, -1
Lal_39:
    s_waitcnt vmcnt(0)
    s_branch L_end
L_alpha:
    s_mov_b32 s23, 0
    s_mov_b64 exec, 1
    v_mov_b32 v250, 44
Lwi_40:
    buffer_load_dword v251, v250, s[16:19], 0 offen sc1
    s_waitcnt vmcnt(0)
    v_readfirstlane_b32 s38, v251
    s_cmp_lg_u32 s38, 0
    s_cbranch_scc1 Lwi_41
    s_add_u32 s23, s23, 1
    s_cmp_gt_u32 s23, 3000000
    s_cbranch_scc1 L_wfail
    s_sleep 1
    s_branch Lwi_40
Lwi_41:
    s_mov_b64 exec, -1
    s_and_b32 s44, s21, 31
    s_lshl_b32 s44, s44, 4
    s_add_u32 s44, s44, 6031872
    s_cmp_lg_u32 s20, 0
    s_cbranch_scc1 Lww_42
    s_mov_b32 exec_lo, 0x7
    s_mov_b32 exec_hi, 0x0
    v_mbcnt_lo_u32_b32 v250, -1, 0
    v_mbcnt_hi_u32_b32 v250, -1, v250
    v_lshlrev_b32 v250, 2, v250
Lwf_43:
    buffer_load_dword v251, v250, s[8:11], s44 offen sc1
    s_waitcnt vmcnt(0)
    v_cmp_eq_u32 vcc, 0, v251
    s_cbranch_vccz Lwf_44
    s_add_u32 s23, s23, 1
    s_cmp_gt_u32 s23, 3000000
    s_cbranch_scc1 L_wfail
    s_sleep 8
    s_branch Lwf_43
Lwf_44:
    s_mov_b64 exec, -1
Lww_42:
    s_barrier
    s_sub_u32 s21, s21, 96
    s_load_dwordx2 s[24:25], s[0:1], 40
    s_waitcnt lgkmcnt(0)
    s_mov_b32 s12, s24
    s_mov_b32 s13, s25
    s_mov_b32 s14, 4718592
    s_mov_b32 s15, 0x20000
    s_mul_i32 s44, s21, 147456
    v_and_b32 v1, 63, v0
    v_lshrrev_b32 v2, 2, v1
    v_and_b32 v3, 3, v1
    v_mul_u32_u24 v2, 1152, v2
    v_lshlrev_b32 v3, 4, v3
    v_add_u32 v3, v2, v3
    s_mov_b32 s28, s20
Lti_45:
    s_cmp_ge_u32 s28, 18
    s_cbranch_scc1 Lti_46
    s_mul_i32 s29, s28, 8192
    s_add_u32 s29, s29, 0
    s_mul_i32 s30, s28, 64
    s_add_u32 s30, s30, s44
    s_mov_b32 m0, s29
    s_add_u32 s29, s29, 1024
    s_add_u32 s31, s30, 0
    buffer_load_dwordx4 v3, s[12:15], s31 offen nt lds
    s_mov_b32 m0, s29
    s_add_u32 s29, s29, 1024
    s_add_u32 s31, s30, 18432
    buffer_load_dwordx4 v3, s[12:15], s31 offen nt lds
    s_mov_b32 m0, s29
    s_add_u32 s29, s29, 1024
    s_add_u32 s31, s30, 36864
    buffer_load_dwordx4 v3, s[12:15], s31 offen nt lds
    s_mov_b32 m0, s29
    s_add_u32 s29, s29, 1024
    s_add_u32 s31, s30, 55296
    buffer_load_dwordx4 v3, s[12:15], s31 offen nt lds
    s_mov_b32 m0, s29
    s_add_u32 s29, s29, 1024
    s_add_u32 s31, s30, 73728
    buffer_load_dwordx4 v3, s[12:15], s31 offen nt lds
    s_mov_b32 m0, s29
    s_add_u32 s29, s29, 1024
    s_add_u32 s31, s30, 92160
    buffer_load_dwordx4 v3, s[12:15], s31 offen nt lds
    s_mov_b32 m0, s29
    s_add_u32 s29, s29, 1024
    s_add_u32 s31, s30, 110592
    buffer_load_dwordx4 v3, s[12:15], s31 offen nt lds
    s_mov_b32 m0, s29
    s_add_u32 s29, s29, 1024
    s_add_u32 s31, s30, 129024
    buffer_load_dwordx4 v3, s[12:15], s31 offen nt lds
    s_add_u32 s28, s28, 4
    s_branch Lti_45
Lti_46:
    v_lshrrev_b32 v4, 4, v1
    v_lshrrev_b32 v5, 2, v1
    v_and_b32 v5, 3, v5
    v_and_b32 v6, 3, v1
    v_lshrrev_b32 v7, 1, v4
    v_lshlrev_b32 v7, 2, v7
    v_add_u32 v7, v7, v5
    v_lshlrev_b32 v7, 6, v7
    v_and_b32 v8, 1, v4
    v_lshlrev_b32 v8, 5, v8
    v_lshlrev_b32 v6, 3, v6
    v_add3_u32 v7, v7, v8, v6
    v_lshlrev_b32 v8, 4, v1
    s_waitcnt vmcnt(0)
    s_mov_b32 s28, s20
Lti_47:
    s_cmp_ge_u32 s28, 18
    s_cbranch_scc1 Lti_48
    s_mul_i32 s29, s28, 8192
    s_add_u32 s29, s29, 0
    v_add_u32 v9, s29, v7
    v_add_u32 v10, s29, v8
    ds_read_b64_tr_b16 v[16:17], v9 offset:0
    ds_read_b64_tr_b16 v[18:19], v9 offset:512
    ds_read_b64_tr_b16 v[20:21], v9 offset:1024
    ds_read_b64_tr_b16 v[22:23], v9 offset:1536
    ds_read_b64_tr_b16 v[24:25], v9 offset:2048
    ds_read_b64_tr_b16 v[26:27], v9 offset:2560
    ds_read_b64_tr_b16 v[28:29], v9 offset:3072
    ds_read_b64_tr_b16 v[30:31], v9 offset:3584
    ds_read_b64_tr_b16 v[32:33], v9 offset:4096
    ds_read_b64_tr_b16 v[34:35], v9 offset:4608
    ds_read_b64_tr_b16 v[36:37], v9 offset:5120
    ds_read_b64_tr_b16 v[38:39], v9 offset:5632
    ds_read_b64_tr_b16 v[40:41], v9 offset:6144
    ds_read_b64_tr_b16 v[42:43], v9 offset:6656
    ds_read_b64_tr_b16 v[44:45], v9 offset:7168
    ds_read_b64_tr_b16 v[46:47], v9 offset:7680
    s_waitcnt lgkmcnt(0)
    ds_write_b128 v10, v[16:19] offset:0
    ds_write_b128 v10, v[20:23] offset:1024
    ds_write_b128 v10, v[24:27] offset:2048
    ds_write_b128 v10, v[28:31] offset:3072
    ds_write_b128 v10, v[32:35] offset:4096
    ds_write_b128 v10, v[36:39] offset:5120
    ds_write_b128 v10, v[40:43] offset:6144
    ds_write_b128 v10, v[44:47] offset:7168
    s_waitcnt lgkmcnt(0)
    s_add_u32 s28, s28, 4
    s_branch Lti_47
Lti_48:
    s_barrier
    v_and_b32 v1, 63, v0
    v_lshlrev_b32 v2, 4, v1
    v_and_b32 v3, 31, v1
    v_lshrrev_b32 v4, 5, v1
    v_and_b32 v5, 7, v3
    v_lshlrev_b32 v6, 4, v4
    v_add3_u32 v5, v5, v6, 8
    v_lshlrev_b32 v5, 4, v5
    v_and_b32 v6, 15, v3
    v_lshlrev_b32 v7, 5, v4
    v_add_u32 v6, v6, v7
    v_lshlrev_b32 v6, 4, v6
    v_lshrrev_b32 v7, 4, v3
    v_lshlrev_b32 v7, 3, v7
    v_add_u32 v6, v6, v7
    v_lshrrev_b32 v7, 2, v3
    v_mul_u32_u24 v7, 4608, v7
    v_lshlrev_b32 v8, 6, v4
    v_and_b32 v9, 3, v3
    v_lshlrev_b32 v9, 4, v9
    v_add3_u32 v7, v7, v8, v9
    v_lshlrev_b32 v8, 2, v4
    v_sub_u32 v8, v3, v8
    s_mov_b32 s45, 0x3e0293ee
    s_mov_b32 s46, 0xff800000
    s_mov_b64 exec, 1
    v_mov_b32 v250, 44
Lwi_49:
    buffer_load_dword v251, v250, s[16:19], 0 offen sc1
    s_waitcnt vmcnt(0)
    v_readfirstlane_b32 s38, v251
    s_cmp_lg_u32 s38, 0
    s_cbranch_scc1 Lwi_50
    s_add_u32 s23, s23, 1
    s_cmp_gt_u32 s23, 3000000
    s_cbranch_scc1 L_wfail
    s_sleep 1
    s_branch Lwi_49
Lwi_50:
    s_mov_b64 exec, -1
    s_mov_b32 s22, s20
Lal_51:
    s_cmp_ge_u32 s22, 62
    s_cbranch_scc1 Lal_52
    s_lshl_b32 s47, s22, 5
    s_add_u32 s47, s47, s21
    s_lshl_b32 s48, s47, 13
    s_lshl_b32 s49, s47, 12
    s_lshl_b32 s58, s47, 4
    s_add_u32 s50, s58, 6029312
    s_mov_b32 exec_lo, 0x7
    s_mov_b32 exec_hi, 0x0
    v_mbcnt_lo_u32_b32 v14, -1, 0
    v_mbcnt_hi_u32_b32 v14, -1, v14
    v_lshlrev_b32 v14, 2, v14
Lwf_53:
    buffer_load_dword v15, v14, s[8:11], s50 offen sc1
    s_waitcnt vmcnt(0)
    v_cmp_eq_u32 vcc, 0, v15
    s_cbranch_vccz Lwf_54
    s_add_u32 s23, s23, 1
    s_cmp_gt_u32 s23, 3000000
    s_cbranch_scc1 L_wfail
    s_sleep 8
    s_branch Lwf_53
Lwf_54:
    s_mov_b64 exec, -1
    s_add_u32 s51, s48, 6291456
    s_add_u32 s52, s51, 4096
    s_add_u32 s53, s48, 23068672
    s_add_u32 s54, s53, 4096
    buffer_load_dwordx4 v[16:19], v2, s[8:11], s51 offen offset:0 sc1
    buffer_load_dwordx4 v[20:23], v2, s[8:11], s51 offen offset:1024 sc1
    buffer_load_dwordx4 v[24:27], v2, s[8:11], s51 offen offset:2048 sc1
    buffer_load_dwordx4 v[28:31], v2, s[8:11], s51 offen offset:3072 sc1
    buffer_load_dwordx4 v[32:35], v2, s[8:11], s52 offen offset:0 sc1
    buffer_load_dwordx4 v[36:39], v2, s[8:11], s52 offen offset:1024 sc1
    buffer_load_dwordx4 v[40:43], v2, s[8:11], s52 offen offset:2048 sc1
    buffer_load_dwordx4 v[44:47], v2, s[8:11], s52 offen offset:3072 sc1
    buffer_load_dwordx4 v[48:51], v2, s[8:11], s53 offen offset:0 sc1
    buffer_load_dwordx4 v[52:55], v2, s[8:11], s53 offen offset:1024 sc1
    buffer_load_dwordx4 v[56:59], v2, s[8:11], s53 offen offset:2048 sc1
    buffer_load_dwordx4 v[60:63], v2, s[8:11], s53 offen offset:3072 sc1
    buffer_load_dwordx4 v[64:67], v2, s[8:11], s54 offen offset:0 sc1
    buffer_load_dwordx4 v[68:71], v2, s[8:11], s54 offen offset:1024 sc1
    buffer_load_dwordx4 v[72:75], v2, s[8:11], s54 offen offset:2048 sc1
    buffer_load_dwordx4 v[76:79], v2, s[8:11], s54 offen offset:3072 sc1
    s_waitcnt vmcnt(0)
    v_mfma_f32_32x32x16_bf16 v[80:95], v[48:51], v[16:19], 0
    v_mfma_f32_32x32x16_bf16 v[80:95], v[52:55], v[20:23], v[80:95]
    v_mfma_f32_32x32x16_bf16 v[80:95], v[56:59], v[24:27], v[80:95]
    v_mfma_f32_32x32x16_bf16 v[80:95], v[60:63], v[28:31], v[80:95]
    v_mfma_f32_32x32x16_bf16 v[80:95], v[64:67], v[32:35], v[80:95]
    v_mfma_f32_32x32x16_bf16 v[80:95], v[68:71], v[36:39], v[80:95]
    v_mfma_f32_32x32x16_bf16 v[80:95], v[72:75], v[40:43], v[80:95]
    v_mfma_f32_32x32x16_bf16 v[80:95], v[76:79], v[44:47], v[80:95]
    s_add_u32 s53, s48, 39845888
    s_add_u32 s54, s53, 4096
    s_nop 7
    buffer_load_dwordx4 v[48:51], v2, s[8:11], s53 offen offset:0 sc1
    buffer_load_dwordx4 v[52:55], v2, s[8:11], s53 offen offset:1024 sc1
    buffer_load_dwordx4 v[56:59], v2, s[8:11], s53 offen offset:2048 sc1
    buffer_load_dwordx4 v[60:63], v2, s[8:11], s53 offen offset:3072 sc1
    buffer_load_dwordx4 v[64:67], v2, s[8:11], s54 offen offset:0 sc1
    buffer_load_dwordx4 v[68:71], v2, s[8:11], s54 offen offset:1024 sc1
    buffer_load_dwordx4 v[72:75], v2, s[8:11], s54 offen offset:2048 sc1
    buffer_load_dwordx4 v[76:79], v2, s[8:11], s54 offen offset:3072 sc1
    s_add_u32 s50, s58, 6062080
    s_mov_b32 exec_lo, 0x1
    s_mov_b32 exec_hi, 0x0
    v_mbcnt_lo_u32_b32 v14, -1, 0
    v_mbcnt_hi_u32_b32 v14, -1, v14
    v_lshlrev_b32 v14, 2, v14
Lwf_55:
    buffer_load_dword v15, v14, s[8:11], s50 offen sc1
    s_waitcnt vmcnt(0)
    v_cmp_eq_u32 vcc, 0, v15
    s_cbranch_vccz Lwf_56
    s_add_u32 s23, s23, 1
    s_cmp_gt_u32 s23, 3000000
    s_cbranch_scc1 L_wfail
    s_sleep 8
    s_branch Lwf_55
Lwf_56:
    s_mov_b64 exec, -1
    s_add_u32 s55, s49, 56623104
    s_add_u32 s56, s49, 65011712
    buffer_load_dwordx4 v[112:115], v5, s[8:11], s55 offen offset:0 sc1
    buffer_load_dwordx4 v[116:119], v5, s[8:11], s55 offen offset:512 sc1
    buffer_load_dwordx4 v[120:123], v5, s[8:11], s55 offen offset:1024 sc1
    buffer_load_dwordx4 v[124:127], v5, s[8:11], s55 offen offset:1536 sc1
    buffer_load_dwordx4 v[128:131], v5, s[8:11], s55 offen offset:2048 sc1
    buffer_load_dwordx4 v[132:135], v5, s[8:11], s55 offen offset:2560 sc1
    buffer_load_dwordx4 v[136:139], v5, s[8:11], s55 offen offset:3072 sc1
    buffer_load_dwordx4 v[140:143], v5, s[8:11], s55 offen offset:3584 sc1
    buffer_load_dword v204, v6, s[8:11], s56 offen offset:0 sc1
    buffer_load_dword v205, v6, s[8:11], s56 offen offset:256 sc1
    v_mov_b32 v206, 0
    v_mov_b32 v207, 0
    buffer_load_dword v208, v6, s[8:11], s56 offen offset:1024 sc1
    buffer_load_dword v209, v6, s[8:11], s56 offen offset:1280 sc1
    v_mov_b32 v210, 0
    v_mov_b32 v211, 0
    buffer_load_dword v212, v6, s[8:11], s56 offen offset:2048 sc1
    buffer_load_dword v213, v6, s[8:11], s56 offen offset:2304 sc1
    v_mov_b32 v214, 0
    v_mov_b32 v215, 0
    buffer_load_dword v216, v6, s[8:11], s56 offen offset:3072 sc1
    buffer_load_dword v217, v6, s[8:11], s56 offen offset:3328 sc1
    v_mov_b32 v218, 0
    v_mov_b32 v219, 0
    s_waitcnt vmcnt(8)
    v_mfma_f32_32x32x16_bf16 v[96:111], v[112:115], v[16:19], 0
    v_mfma_f32_32x32x16_bf16 v[96:111], v[116:119], v[20:23], v[96:111]
    v_mfma_f32_32x32x16_bf16 v[96:111], v[120:123], v[24:27], v[96:111]
    v_mfma_f32_32x32x16_bf16 v[96:111], v[124:127], v[28:31], v[96:111]
    v_mfma_f32_32x32x16_bf16 v[96:111], v[128:131], v[32:35], v[96:111]
    v_mfma_f32_32x32x16_bf16 v[96:111], v[132:135], v[36:39], v[96:111]
    v_mfma_f32_32x32x16_bf16 v[96:111], v[136:139], v[40:43], v[96:111]
    v_mfma_f32_32x32x16_bf16 v[96:111], v[140:143], v[44:47], v[96:111]
    v_cmp_le_i32 vcc, 0, v8
    s_nop 1
    v_mov_b32 v10, s46
    v_cndmask_b32 v80, v10, v80, vcc
    v_cmp_le_i32 vcc, 1, v8
    s_nop 0
    v_mov_b32 v10, s46
    v_cndmask_b32 v81, v10, v81, vcc
    v_cmp_le_i32 vcc, 2, v8
    s_nop 0
    v_mov_b32 v10, s46
    v_cndmask_b32 v82, v10, v82, vcc
    v_cmp_le_i32 vcc, 3, v8
    s_nop 0
    v_mov_b32 v10, s46
    v_cndmask_b32 v83, v10, v83, vcc
    v_cmp_le_i32 vcc, 8, v8
    s_nop 0
    v_mov_b32 v10, s46
    v_cndmask_b32 v84, v10, v84, vcc
    v_cmp_le_i32 vcc, 9, v8
    s_nop 0
    v_mov_b32 v10, s46
    v_cndmask_b32 v85, v10, v85, vcc
    v_cmp_le_i32 vcc, 10, v8
    s_nop 0
    v_mov_b32 v10, s46
    v_cndmask_b32 v86, v10, v86, vcc
    v_cmp_le_i32 vcc, 11, v8
    s_nop 0
    v_mov_b32 v10, s46
    v_cndmask_b32 v87, v10, v87, vcc
    v_cmp_le_i32 vcc, 16, v8
    s_nop 0
    v_mov_b32 v10, s46
    v_cndmask_b32 v88, v10, v88, vcc
    v_cmp_le_i32 vcc, 17, v8
    s_nop 0
    v_mov_b32 v10, s46
    v_cndmask_b32 v89, v10, v89, vcc
    v_cmp_le_i32 vcc, 18, v8
    s_nop 0
    v_mov_b32 v10, s46
    v_cndmask_b32 v90, v10, v90, vcc
    v_cmp_le_i32 vcc, 19, v8
    s_nop 0
    v_mov_b32 v10, s46
    v_cndmask_b32 v91, v10, v91, vcc
    v_cmp_le_i32 vcc, 24, v8
    s_nop 0
    v_mov_b32 v10, s46
    v_cndmask_b32 v92, v10, v92, vcc
    v_cmp_le_i32 vcc, 25, v8
    s_nop 0
    v_mov_b32 v10, s46
    v_cndmask_b32 v93, v10, v93, vcc
    v_cmp_le_i32 vcc, 26, v8
    s_nop 0
    v_mov_b32 v10, s46
    v_cndmask_b32 v94, v10, v94, vcc
    v_cmp_le_i32 vcc, 27, v8
    s_nop 0
    v_mov_b32 v10, s46
    v_cndmask_b32 v95, v10, v95, vcc
    s_nop 7
    s_nop 3
    v_max3_f32 v10, v80, v81, v82
    v_max3_f32 v10, v10, v83, v84
    v_max3_f32 v10, v10, v85, v86
    v_max3_f32 v10, v10, v87, v88
    v_max3_f32 v10, v10, v89, v90
    v_max3_f32 v10, v10, v91, v92
    v_max3_f32 v10, v10, v93, v94
    v_max3_f32 v10, v10, v95, v96
    v_max3_f32 v10, v10, v97, v98
    v_max_f32 v10, v10, v99
    v_mov_b32 v11, v10
    s_nop 1
    v_permlane32_swap_b32 v10, v11
    v_max_f32 v10, v10, v11
    v_mul_f32 v10, s45, v10
    v_fma_f32 v80, v80, s45, -v10
    v_exp_f32 v80, v80
    v_fma_f32 v81, v81, s45, -v10
    v_exp_f32 v81, v81
    v_fma_f32 v82, v82, s45, -v10
    v_exp_f32 v82, v82
    v_fma_f32 v83, v83, s45, -v10
    v_exp_f32 v83, v83
    v_fma_f32 v84, v84, s45, -v10
    v_exp_f32 v84, v84
    v_fma_f32 v85, v85, s45, -v10
    v_exp_f32 v85, v85
    v_fma_f32 v86, v86, s45, -v10
    v_exp_f32 v86, v86
    v_fma_f32 v87, v87, s45, -v10
    v_exp_f32 v87, v87
    v_fma_f32 v88, v88, s45, -v10
    v_exp_f32 v88, v88
    v_fma_f32 v89, v89, s45, -v10
    v_exp_f32 v89, v89
    v_fma_f32 v90, v90, s45, -v10
    v_exp_f32 v90, v90
    v_fma_f32 v91, v91, s45, -v10
    v_exp_f32 v91, v91
    v_fma_f32 v92, v92, s45, -v10
    v_exp_f32 v92, v92
    v_fma_f32 v93, v93, s45, -v10
    v_exp_f32 v93, v93
    v_fma_f32 v94, v94, s45, -v10
    v_exp_f32 v94, v94
    v_fma_f32 v95, v95, s45, -v10
    v_exp_f32 v95, v95
    v_fma_f32 v96, v96, s45, -v10
    v_exp_f32 v96, v96
    v_fma_f32 v97, v97, s45, -v10
    v_exp_f32 v97, v97
    v_fma_f32 v98, v98, s45, -v10
    v_exp_f32 v98, v98
    v_fma_f32 v99, v99, s45, -v10
    v_exp_f32 v99, v99
    s_nop 0
    v_add_f32 v11, v80, v81
    v_add_f32 v11, v11, v82
    v_add_f32 v11, v11, v83
    v_add_f32 v11, v11, v84
    v_add_f32 v11, v11, v85
    v_add_f32 v11, v11, v86
    v_add_f32 v11, v11, v87
    v_add_f32 v11, v11, v88
    v_add_f32 v11, v11, v89
    v_add_f32 v11, v11, v90
    v_add_f32 v11, v11, v91
    v_add_f32 v11, v11, v92
    v_add_f32 v11, v11, v93
    v_add_f32 v11, v11, v94
    v_add_f32 v11, v11, v95
    v_add_f32 v11, v11, v96
    v_add_f32 v11, v11, v97
    v_add_f32 v11, v11, v98
    v_add_f32 v11, v11, v99
    v_mov_b32 v12, v11
    s_nop 1
    v_permlane32_swap_b32 v11, v12
    v_add_f32 v11, v11, v12
    v_rcp_f32 v11, v11
    s_nop 0
    v_mul_f32 v80, v80, v11
    v_mul_f32 v81, v81, v11
    v_mul_f32 v82, v82, v11
    v_mul_f32 v83, v83, v11
    v_mul_f32 v84, v84, v11
    v_mul_f32 v85, v85, v11
    v_mul_f32 v86, v86, v11
    v_mul_f32 v87, v87, v11
    v_mul_f32 v88, v88, v11
    v_mul_f32 v89, v89, v11
    v_mul_f32 v90, v90, v11
    v_mul_f32 v91, v91, v11
    v_mul_f32 v92, v92, v11
    v_mul_f32 v93, v93, v11
    v_mul_f32 v94, v94, v11
    v_mul_f32 v95, v95, v11
    v_mul_f32 v96, v96, v11
    v_mul_f32 v97, v97, v11
    v_mul_f32 v98, v98, v11
    v_mul_f32 v99, v99, v11
    v_cvt_pk_bf16_f32 v144, v80, v81
    v_cvt_pk_bf16_f32 v145, v82, v83
    v_cvt_pk_bf16_f32 v146, v88, v89
    v_cvt_pk_bf16_f32 v147, v90, v91
    v_cvt_pk_bf16_f32 v148, v84, v85
    v_cvt_pk_bf16_f32 v149, v86, v87
    v_cvt_pk_bf16_f32 v150, v92, v93
    v_cvt_pk_bf16_f32 v151, v94, v95
    v_cvt_pk_bf16_f32 v152, v96, v97
    v_cvt_pk_bf16_f32 v153, v98, v99
    v_mov_b32 v154, 0
    v_mov_b32 v155, 0
    s_waitcnt vmcnt(0)
    s_nop 1
    v_mfma_f32_32x32x16_bf16 v[188:203], v[48:51], v[144:147], 0
    v_mfma_f32_32x32x16_bf16 v[188:203], v[52:55], v[148:151], v[188:203]
    v_mfma_f32_32x32x16_bf16 v[188:203], v[204:207], v[152:155], v[188:203]
    s_nop 7
    s_nop 3
    v_cvt_pk_bf16_f32 v156, v188, v189
    v_cvt_pk_bf16_f32 v157, v190, v191
    v_cvt_pk_bf16_f32 v158, v192, v193
    v_cvt_pk_bf16_f32 v159, v194, v195
    v_cvt_pk_bf16_f32 v160, v196, v197
    v_cvt_pk_bf16_f32 v161, v198, v199
    v_cvt_pk_bf16_f32 v162, v200, v201
    v_cvt_pk_bf16_f32 v163, v202, v203
    s_nop 3
    v_mfma_f32_32x32x16_bf16 v[188:203], v[56:59], v[144:147], 0
    v_mfma_f32_32x32x16_bf16 v[188:203], v[60:63], v[148:151], v[188:203]
    v_mfma_f32_32x32x16_bf16 v[188:203], v[208:211], v[152:155], v[188:203]
    s_nop 7
    s_nop 3
    v_cvt_pk_bf16_f32 v164, v188, v189
    v_cvt_pk_bf16_f32 v165, v190, v191
    v_cvt_pk_bf16_f32 v166, v192, v193
    v_cvt_pk_bf16_f32 v167, v194, v195
    v_cvt_pk_bf16_f32 v168, v196, v197
    v_cvt_pk_bf16_f32 v169, v198, v199
    v_cvt_pk_bf16_f32 v170, v200, v201
    v_cvt_pk_bf16_f32 v171, v202, v203
    s_nop 3
    v_mfma_f32_32x32x16_bf16 v[188:203], v[64:67], v[144:147], 0
    v_mfma_f32_32x32x16_bf16 v[188:203], v[68:71], v[148:151], v[188:203]
    v_mfma_f32_32x32x16_bf16 v[188:203], v[212:215], v[152:155], v[188:203]
    s_nop 7
    s_nop 3
    v_cvt_pk_bf16_f32 v172, v188, v189
    v_cvt_pk_bf16_f32 v173, v190, v191
    v_cvt_pk_bf16_f32 v174, v192, v193
    v_cvt_pk_bf16_f32 v175, v194, v195
    v_cvt_pk_bf16_f32 v176, v196, v197
    v_cvt_pk_bf16_f32 v177, v198, v199
    v_cvt_pk_bf16_f32 v178, v200, v201
    v_cvt_pk_bf16_f32 v179, v202, v203
    s_nop 3
    v_mfma_f32_32x32x16_bf16 v[188:203], v[72:75], v[144:147], 0
    v_mfma_f32_32x32x16_bf16 v[188:203], v[76:79], v[148:151], v[188:203]
    v_mfma_f32_32x32x16_bf16 v[188:203], v[216:219], v[152:155], v[188:203]
    s_nop 7
    s_nop 3
    v_cvt_pk_bf16_f32 v180, v188, v189
    v_cvt_pk_bf16_f32 v181, v190, v191
    v_cvt_pk_bf16_f32 v182, v192, v193
    v_cvt_pk_bf16_f32 v183, v194, v195
    v_cvt_pk_bf16_f32 v184, v196, v197
    v_cvt_pk_bf16_f32 v185, v198, v199
    v_cvt_pk_bf16_f32 v186, v200, v201
    v_cvt_pk_bf16_f32 v187, v202, v203
    s_nop 3
    s_mul_i32 s57, s47, 36864
    s_add_u32 s57, s57, 73400320
    v_mov_b32 v13, v2
    ds_read_b128 a[0:3], v13 offset:0
    ds_read_b128 a[4:7], v13 offset:1024
    ds_read_b128 a[8:11], v13 offset:2048
    ds_read_b128 a[12:15], v13 offset:3072
    ds_read_b128 a[16:19], v13 offset:4096
    ds_read_b128 a[20:23], v13 offset:5120
    ds_read_b128 a[24:27], v13 offset:6144
    s_waitcnt lgkmcnt(6)
    v_mfma_f32_32x32x16_bf16 v[220:235], a[0:3], v[156:159], 0
    ds_read_b128 a[28:31], v13 offset:7168
    s_waitcnt lgkmcnt(6)
    v_mfma_f32_32x32x16_bf16 v[220:235], a[4:7], v[160:163], v[220:235]
    ds_read_b128 a[0:3], v13 offset:8192
    s_waitcnt lgkmcnt(6)
    v_mfma_f32_32x32x16_bf16 v[220:235], a[8:11], v[164:167], v[220:235]
    ds_read_b128 a[4:7], v13 offset:9216
    s_waitcnt lgkmcnt(6)
    v_mfma_f32_32x32x16_bf16 v[220:235], a[12:15], v[168:171], v[220:235]
    ds_read_b128 a[8:11], v13 offset:10240
    s_waitcnt lgkmcnt(6)
    v_mfma_f32_32x32x16_bf16 v[220:235], a[16:19], v[172:175], v[220:235]
    ds_read_b128 a[12:15], v13 offset:11264
    s_waitcnt lgkmcnt(6)
    v_mfma_f32_32x32x16_bf16 v[220:235], a[20:23], v[176:179], v[220:235]
    ds_read_b128 a[16:19], v13 offset:12288
    s_waitcnt lgkmcnt(6)
    v_mfma_f32_32x32x16_bf16 v[220:235], a[24:27], v[180:183], v[220:235]
    ds_read_b128 a[20:23], v13 offset:13312
    s_waitcnt lgkmcnt(6)
    v_mfma_f32_32x32x16_bf16 v[220:235], a[28:31], v[184:187], v[220:235]
    ds_read_b128 a[24:27], v13 offset:14336
    s_waitcnt lgkmcnt(6)
    v_mfma_f32_32x32x16_bf16 v[236:251], a[0:3], v[156:159], 0
    ds_read_b128 a[28:31], v13 offset:15360
    s_waitcnt lgkmcnt(6)
    v_mfma_f32_32x32x16_bf16 v[236:251], a[4:7], v[160:163], v[236:251]
    ds_read_b128 a[0:3], v13 offset:16384
    s_waitcnt lgkmcnt(6)
    v_mfma_f32_32x32x16_bf16 v[236:251], a[8:11], v[164:167], v[236:251]
    ds_read_b128 a[4:7], v13 offset:17408
    s_waitcnt lgkmcnt(6)
    v_mfma_f32_32x32x16_bf16 v[236:251], a[12:15], v[168:171], v[236:251]
    ds_read_b128 a[8:11], v13 offset:18432
    v_cvt_pk_bf16_f32 v16, v220, v221
    v_cvt_pk_bf16_f32 v17, v222, v223
    v_cvt_pk_bf16_f32 v18, v224, v225
    v_cvt_pk_bf16_f32 v19, v226, v227
    v_cvt_pk_bf16_f32 v20, v228, v229
    v_cvt_pk_bf16_f32 v21, v230, v231
    v_cvt_pk_bf16_f32 v22, v232, v233
    v_cvt_pk_bf16_f32 v23, v234, v235
    buffer_store_dwordx4 v[16:19], v7, s[8:11], s57 offen offset:0 sc1
    buffer_store_dwordx4 v[20:23], v7, s[8:11], s57 offen offset:128 sc1
    s_add_u32 s57, s57, 256
    s_nop 1
    s_waitcnt lgkmcnt(6)
    v_mfma_f32_32x32x16_bf16 v[236:251], a[16:19], v[172:175], v[236:251]
    ds_read_b128 a[12:15], v13 offset:19456
    s_waitcnt lgkmcnt(6)
    v_mfma_f32_32x32x16_bf16 v[236:251], a[20:23], v[176:179], v[236:251]
    ds_read_b128 a[16:19], v13 offset:20480
    s_waitcnt lgkmcnt(6)
    v_mfma_f32_32x32x16_bf16 v[236:251], a[24:27], v[180:183], v[236:251]
    ds_read_b128 a[20:23], v13 offset:21504
    s_waitcnt lgkmcnt(6)
    v_mfma_f32_32x32x16_bf16 v[236:251], a[28:31], v[184:187], v[236:251]
    ds_read_b128 a[24:27], v13 offset:22528
    s_waitcnt lgkmcnt(6)
    v_mfma_f32_32x32x16_bf16 v[220:235], a[0:3], v[156:159], 0
    ds_read_b128 a[28:31], v13 offset:23552
    s_waitcnt lgkmcnt(6)
    v_mfma_f32_32x32x16_bf16 v[220:235], a[4:7], v[160:163], v[220:235]
    ds_read_b128 a[0:3], v13 offset:24576
    s_waitcnt lgkmcnt(6)
    v_mfma_f32_32x32x16_bf16 v[220:235], a[8:11], v[164:167], v[220:235]
    ds_read_b128 a[4:7], v13 offset:25600
    s_waitcnt lgkmcnt(6)
    v_mfma_f32_32x32x16_bf16 v[220:235], a[12:15], v[168:171], v[220:235]
    ds_read_b128 a[8:11], v13 offset:26624
    v_cvt_pk_bf16_f32 v16, v236, v237
    v_cvt_pk_bf16_f32 v17, v238, v239
    v_cvt_pk_bf16_f32 v18, v240, v241
    v_cvt_pk_bf16_f32 v19, v242, v243
    v_cvt_pk_bf16_f32 v20, v244, v245
    v_cvt_pk_bf16_f32 v21, v246, v247
    v_cvt_pk_bf16_f32 v22, v248, v249
    v_cvt_pk_bf16_f32 v23, v250, v251
    buffer_store_dwordx4 v[16:19], v7, s[8:11], s57 offen offset:0 sc1
    buffer_store_dwordx4 v[20:23], v7, s[8:11], s57 offen offset:128 sc1
    s_add_u32 s57, s57, 256
    s_nop 1
    s_waitcnt lgkmcnt(6)
    v_mfma_f32_32x32x16_bf16 v[220:235], a[16:19], v[172:175], v[220:235]
    ds_read_b128 a[12:15], v13 offset:27648
    s_waitcnt lgkmcnt(6)
    v_mfma_f32_32x32x16_bf16 v[220:235], a[20:23], v[176:179], v[220:235]
    ds_read_b128 a[16:19], v13 offset:28672
    s_waitcnt lgkmcnt(6)
    v_mfma_f32_32x32x16_bf16 v[220:235], a[24:27], v[180:183], v[220:235]
    ds_read_b128 a[20:23], v13 offset:29696
    s_waitcnt lgkmcnt(6)
    v_mfma_f32_32x32x16_bf16 v[220:235], a[28:31], v[184:187], v[220:235]
    ds_read_b128 a[24:27], v13 offset:30720
    s_waitcnt lgkmcnt(6)
    v_mfma_f32_32x32x16_bf16 v[236:251], a[0:3], v[156:159], 0
    ds_read_b128 a[28:31], v13 offset:31744
    s_waitcnt lgkmcnt(6)
    v_mfma_f32_32x32x16_bf16 v[236:251], a[4:7], v[160:163], v[236:251]
    ds_read_b128 a[0:3], v13 offset:32768
    s_waitcnt lgkmcnt(6)
    v_mfma_f32_32x32x16_bf16 v[236:251], a[8:11], v[164:167], v[236:251]
    ds_read_b128 a[4:7], v13 offset:33792
    s_waitcnt lgkmcnt(6)
    v_mfma_f32_32x32x16_bf16 v[236:251], a[12:15], v[168:171], v[236:251]
    ds_read_b128 a[8:11], v13 offset:34816
    v_cvt_pk_bf16_f32 v16, v220, v221
    v_cvt_pk_bf16_f32 v17, v222, v223
    v_cvt_pk_bf16_f32 v18, v224, v225
    v_cvt_pk_bf16_f32 v19, v226, v227
    v_cvt_pk_bf16_f32 v20, v228, v229
    v_cvt_pk_bf16_f32 v21, v230, v231
    v_cvt_pk_bf16_f32 v22, v232, v233
    v_cvt_pk_bf16_f32 v23, v234, v235
    buffer_store_dwordx4 v[16:19], v7, s[8:11], s57 offen offset:0 sc1
    buffer_store_dwordx4 v[20:23], v7, s[8:11], s57 offen offset:128 sc1
    s_add_u32 s57, s57, 256
    s_nop 1
    s_waitcnt lgkmcnt(6)
    v_mfma_f32_32x32x16_bf16 v[236:251], a[16:19], v[172:175], v[236:251]
    ds_read_b128 a[12:15], v13 offset:35840
    s_waitcnt lgkmcnt(6)
    v_mfma_f32_32x32x16_bf16 v[236:251], a[20:23], v[176:179], v[236:251]
    ds_read_b128 a[16:19], v13 offset:36864
    s_waitcnt lgkmcnt(6)
    v_mfma_f32_32x32x16_bf16 v[236:251], a[24:27], v[180:183], v[236:251]
    ds_read_b128 a[20:23], v13 offset:37888
    s_waitcnt lgkmcnt(6)
    v_mfma_f32_32x32x16_bf16 v[236:251], a[28:31], v[184:187], v[236:251]
    ds_read_b128 a[24:27], v13 offset:38912
    s_waitcnt lgkmcnt(6)
    v_mfma_f32_32x32x16_bf16 v[220:235], a[0:3], v[156:159], 0
    ds_read_b128 a[28:31], v13 offset:39936
    s_waitcnt lgkmcnt(6)
    v_mfma_f32_32x32x16_bf16 v[220:235], a[4:7], v[160:163], v[220:235]
    ds_read_b128 a[0:3], v13 offset:40960
    s_waitcnt lgkmcnt(6)
    v_mfma_f32_32x32x16_bf16 v[220:235], a[8:11], v[164:167], v[220:235]
    ds_read_b128 a[4:7], v13 offset:41984
    s_waitcnt lgkmcnt(6)
    v_mfma_f32_32x32x16_bf16 v[220:235], a[12:15], v[168:171], v[220:235]
    ds_read_b128 a[8:11], v13 offset:43008
    v_cvt_pk_bf16_f32 v16, v236, v237
    v_cvt_pk_bf16_f32 v17, v238, v239
    v_cvt_pk_bf16_f32 v18, v240, v241
    v_cvt_pk_bf16_f32 v19, v242, v243
    v_cvt_pk_bf16_f32 v20, v244, v245
    v_cvt_pk_bf16_f32 v21, v246, v247
    v_cvt_pk_bf16_f32 v22, v248, v249
    v_cvt_pk_bf16_f32 v23, v250, v251
    buffer_store_dwordx4 v[16:19], v7, s[8:11], s57 offen offset:0 sc1
    buffer_store_dwordx4 v[20:23], v7, s[8:11], s57 offen offset:128 sc1
    s_add_u32 s57, s57, 256
    s_nop 1
    s_waitcnt lgkmcnt(6)
    v_mfma_f32_32x32x16_bf16 v[220:235], a[16:19], v[172:175], v[220:235]
    ds_read_b128 a[12:15], v13 offset:44032
    s_waitcnt lgkmcnt(6)
    v_mfma_f32_32x32x16_bf16 v[220:235], a[20:23], v[176:179], v[220:235]
    ds_read_b128 a[16:19], v13 offset:45056
    s_waitcnt lgkmcnt(6)
    v_mfma_f32_32x32x16_bf16 v[220:235], a[24:27], v[180:183], v[220:235]
    ds_read_b128 a[20:23], v13 offset:46080
    s_waitcnt lgkmcnt(6)
    v_mfma_f32_32x32x16_bf16 v[220:235], a[28:31], v[184:187], v[220:235]
    ds_read_b128 a[24:27], v13 offset:47104
    s_waitcnt lgkmcnt(6)
    v_mfma_f32_32x32x16_bf16 v[236:251], a[0:3], v[156:159], 0
    ds_read_b128 a[28:31], v13 offset:48128
    s_waitcnt lgkmcnt(6)
    v_mfma_f32_32x32x16_bf16 v[236:251], a[4:7], v[160:163], v[236:251]
    ds_read_b128 a[0:3], v13 offset:49152
    s_waitcnt lgkmcnt(6)
    v_mfma_f32_32x32x16_bf16 v[236:251], a[8:11], v[164:167], v[236:251]
    ds_read_b128 a[4:7], v13 offset:50176
    s_waitcnt lgkmcnt(6)
    v_mfma_f32_32x32x16_bf16 v[236:251], a[12:15], v[168:171], v[236:251]
    ds_read_b128 a[8:11], v13 offset:51200
    v_cvt_pk_bf16_f32 v16, v220, v221
    v_cvt_pk_bf16_f32 v17, v222, v223
    v_cvt_pk_bf16_f32 v18, v224, v225
    v_cvt_pk_bf16_f32 v19, v226, v227
    v_cvt_pk_bf16_f32 v20, v228, v229
    v_cvt_pk_bf16_f32 v21, v230, v231
    v_cvt_pk_bf16_f32 v22, v232, v233
    v_cvt_pk_bf16_f32 v23, v234, v235
    buffer_store_dwordx4 v[16:19], v7, s[8:11], s57 offen offset:0 sc1
    buffer_store_dwordx4 v[20:23], v7, s[8:11], s57 offen offset:128 sc1
    s_add_u32 s57, s57, 256
    s_nop 1
    s_waitcnt lgkmcnt(6)
    v_mfma_f32_32x32x16_bf16 v[236:251], a[16:19], v[172:175], v[236:251]
    ds_read_b128 a[12:15], v13 offset:52224
    s_waitcnt lgkmcnt(6)
    v_mfma_f32_32x32x16_bf16 v[236:251], a[20:23], v[176:179], v[236:251]
    ds_read_b128 a[16:19], v13 offset:53248
    s_waitcnt lgkmcnt(6)
    v_mfma_f32_32x32x16_bf16 v[236:251], a[24:27], v[180:183], v[236:251]
    ds_read_b128 a[20:23], v13 offset:54272
    s_waitcnt lgkmcnt(6)
    v_mfma_f32_32x32x16_bf16 v[236:251], a[28:31], v[184:187], v[236:251]
    ds_read_b128 a[24:27], v13 offset:55296
    s_waitcnt lgkmcnt(6)
    v_mfma_f32_32x32x16_bf16 v[220:235], a[0:3], v[156:159], 0
    ds_read_b128 a[28:31], v13 offset:56320
    s_waitcnt lgkmcnt(6)
    v_mfma_f32_32x32x16_bf16 v[220:235], a[4:7], v[160:163], v[220:235]
    ds_read_b128 a[0:3], v13 offset:57344
    s_waitcnt lgkmcnt(6)
    v_mfma_f32_32x32x16_bf16 v[220:235], a[8:11], v[164:167], v[220:235]
    ds_read_b128 a[4:7], v13 offset:58368
    s_waitcnt lgkmcnt(6)
    v_mfma_f32_32x32x16_bf16 v[220:235], a[12:15], v[168:171], v[220:235]
    ds_read_b128 a[8:11], v13 offset:59392
    v_cvt_pk_bf16_f32 v16, v236, v237
    v_cvt_pk_bf16_f32 v17, v238, v239
    v_cvt_pk_bf16_f32 v18, v240, v241
    v_cvt_pk_bf16_f32 v19, v242, v243
    v_cvt_pk_bf16_f32 v20, v244, v245
    v_cvt_pk_bf16_f32 v21, v246, v247
    v_cvt_pk_bf16_f32 v22, v248, v249
    v_cvt_pk_bf16_f32 v23, v250, v251
    buffer_store_dwordx4 v[16:19], v7, s[8:11], s57 offen offset:0 sc1
    buffer_store_dwordx4 v[20:23], v7, s[8:11], s57 offen offset:128 sc1
    s_add_u32 s57, s57, 256
    s_nop 1
    s_waitcnt lgkmcnt(6)
    v_mfma_f32_32x32x16_bf16 v[220:235], a[16:19], v[172:175], v[220:235]
    ds_read_b128 a[12:15], v13 offset:60416
    s_waitcnt lgkmcnt(6)
    v_mfma_f32_32x32x16_bf16 v[220:235], a[20:23], v[176:179], v[220:235]
    ds_read_b128 a[16:19], v13 offset:61440
    s_waitcnt lgkmcnt(6)
    v_mfma_f32_32x32x16_bf16 v[220:235], a[24:27], v[180:183], v[220:235]
    ds_read_b128 a[20:23], v13 offset:62464
    s_waitcnt lgkmcnt(6)
    v_mfma_f32_32x32x16_bf16 v[220:235], a[28:31], v[184:187], v[220:235]
    ds_read_b128 a[24:27], v13 offset:63488
    s_waitcnt lgkmcnt(6)
    v_mfma_f32_32x32x16_bf16 v[236:251], a[0:3], v[156:159], 0
    v_add_u32 v13, 57344, v13
    ds_read_b128 a[28:31], v13 offset:7168
    s_waitcnt lgkmcnt(6)
    v_mfma_f32_32x32x16_bf16 v[236:251], a[4:7], v[160:163], v[236:251]
    ds_read_b128 a[0:3], v13 offset:8192
    s_waitcnt lgkmcnt(6)
    v_mfma_f32_32x32x16_bf16 v[236:251], a[8:11], v[164:167], v[236:251]
    ds_read_b128 a[4:7], v13 offset:9216
    s_waitcnt lgkmcnt(6)
    v_mfma_f32_32x32x16_bf16 v[236:251], a[12:15], v[168:171], v[236:251]
    ds_read_b128 a[8:11], v13 offset:10240
    v_cvt_pk_bf16_f32 v16, v220, v221
    v_cvt_pk_bf16_f32 v17, v222, v223
    v_cvt_pk_bf16_f32 v18, v224, v225
    v_cvt_pk_bf16_f32 v19, v226, v227
    v_cvt_pk_bf16_f32 v20, v228, v229
    v_cvt_pk_bf16_f32 v21, v230, v231
    v_cvt_pk_bf16_f32 v22, v232, v233
    v_cvt_pk_bf16_f32 v23, v234, v235
    buffer_store_dwordx4 v[16:19], v7, s[8:11], s57 offen offset:0 sc1
    buffer_store_dwordx4 v[20:23], v7, s[8:11], s57 offen offset:128 sc1
    s_add_u32 s57, s57, 256
    s_nop 1
    s_waitcnt lgkmcnt(6)
    v_mfma_f32_32x32x16_bf16 v[236:251], a[16:19], v[172:175], v[236:251]
    ds_read_b128 a[12:15], v13 offset:11264
    s_waitcnt lgkmcnt(6)
    v_mfma_f32_32x32x16_bf16 v[236:251], a[20:23], v[176:179], v[236:251]
    ds_read_b128 a[16:19], v13 offset:12288
    s_waitcnt lgkmcnt(6)
    v_mfma_f32_32x32x16_bf16 v[236:251], a[24:27], v[180:183], v[236:251]
    ds_read_b128 a[20:23], v13 offset:13312
    s_waitcnt lgkmcnt(6)
    v_mfma_f32_32x32x16_bf16 v[236:251], a[28:31], v[184:187], v[236:251]
    ds_read_b128 a[24:27], v13 offset:14336
    s_waitcnt lgkmcnt(6)
    v_mfma_f32_32x32x16_bf16 v[220:235], a[0:3], v[156:159], 0
    ds_read_b128 a[28:31], v13 offset:15360
    s_waitcnt lgkmcnt(6)
    v_mfma_f32_32x32x16_bf16 v[220:235], a[4:7], v[160:163], v[220:235]
    ds_read_b128 a[0:3], v13 offset:16384
    s_waitcnt lgkmcnt(6)
    v_mfma_f32_32x32x16_bf16 v[220:235], a[8:11], v[164:167], v[220:235]
    ds_read_b128 a[4:7], v13 offset:17408
    s_waitcnt lgkmcnt(6)
    v_mfma_f32_32x32x16_bf16 v[220:235], a[12:15], v[168:171], v[220:235]
    ds_read_b128 a[8:11], v13 offset:18432
    v_cvt_pk_bf16_f32 v16, v236, v237
    v_cvt_pk_bf16_f32 v17, v238, v239
    v_cvt_pk_bf16_f32 v18, v240, v241
    v_cvt_pk_bf16_f32 v19, v242, v243
    v_cvt_pk_bf16_f32 v20, v244, v245
    v_cvt_pk_bf16_f32 v21, v246, v247
    v_cvt_pk_bf16_f32 v22, v248, v249
    v_cvt_pk_bf16_f32 v23, v250, v251
    buffer_store_dwordx4 v[16:19], v7, s[8:11], s57 offen offset:0 sc1
    buffer_store_dwordx4 v[20:23], v7, s[8:11], s57 offen offset:128 sc1
    s_add_u32 s57, s57, 256
    s_nop 1
    s_waitcnt lgkmcnt(6)
    v_mfma_f32_32x32x16_bf16 v[220:235], a[16:19], v[172:175], v[220:235]
    ds_read_b128 a[12:15], v13 offset:19456
    s_waitcnt lgkmcnt(6)
    v_mfma_f32_32x32x16_bf16 v[220:235], a[20:23], v[176:179], v[220:235]
    ds_read_b128 a[16:19], v13 offset:20480
    s_waitcnt lgkmcnt(6)
    v_mfma_f32_32x32x16_bf16 v[220:235], a[24:27], v[180:183], v[220:235]
    ds_read_b128 a[20:23], v13 offset:21504
    s_waitcnt lgkmcnt(6)
    v_mfma_f32_32x32x16_bf16 v[220:235], a[28:31], v[184:187], v[220:235]
    ds_read_b128 a[24:27], v13 offset:22528
    s_waitcnt lgkmcnt(6)
    v_mfma_f32_32x32x16_bf16 v[236:251], a[0:3], v[156:159], 0
    ds_read_b128 a[28:31], v13 offset:23552
    s_waitcnt lgkmcnt(6)
    v_mfma_f32_32x32x16_bf16 v[236:251], a[4:7], v[160:163], v[236:251]
    ds_read_b128 a[0:3], v13 offset:24576
    s_waitcnt lgkmcnt(6)
    v_mfma_f32_32x32x16_bf16 v[236:251], a[8:11], v[164:167], v[236:251]
    ds_read_b128 a[4:7], v13 offset:25600
    s_waitcnt lgkmcnt(6)
    v_mfma_f32_32x32x16_bf16 v[236:251], a[12:15], v[168:171], v[236:251]
    ds_read_b128 a[8:11], v13 offset:26624
    v_cvt_pk_bf16_f32 v16, v220, v221
    v_cvt_pk_bf16_f32 v17, v222, v223
    v_cvt_pk_bf16_f32 v18, v224, v225
    v_cvt_pk_bf16_f32 v19, v226, v227
    v_cvt_pk_bf16_f32 v20, v228, v229
    v_cvt_pk_bf16_f32 v21, v230, v231
    v_cvt_pk_bf16_f32 v22, v232, v233
    v_cvt_pk_bf16_f32 v23, v234, v235
    buffer_store_dwordx4 v[16:19], v7, s[8:11], s57 offen offset:0 sc1
    buffer_store_dwordx4 v[20:23], v7, s[8:11], s57 offen offset:128 sc1
    s_add_u32 s57, s57, 256
    s_nop 1
    s_waitcnt lgkmcnt(6)
    v_mfma_f32_32x32x16_bf16 v[236:251], a[16:19], v[172:175], v[236:251]
    ds_read_b128 a[12:15], v13 offset:27648
    s_waitcnt lgkmcnt(6)
    v_mfma_f32_32x32x16_bf16 v[236:251], a[20:23], v[176:179], v[236:251]
    ds_read_b128 a[16:19], v13 offset:28672
    s_waitcnt lgkmcnt(6)
    v_mfma_f32_32x32x16_bf16 v[236:251], a[24:27], v[180:183], v[236:251]
    ds_read_b128 a[20:23], v13 offset:29696
    s_waitcnt lgkmcnt(6)
    v_mfma_f32_32x32x16_bf16 v[236:251], a[28:31], v[184:187], v[236:251]
    ds_read_b128 a[24:27], v13 offset:30720
    s_waitcnt lgkmcnt(6)
    v_mfma_f32_32x32x16_bf16 v[220:235], a[0:3], v[156:159], 0
    ds_read_b128 a[28:31], v13 offset:31744
    s_waitcnt lgkmcnt(6)
    v_mfma_f32_32x32x16_bf16 v[220:235], a[4:7], v[160:163], v[220:235]
    ds_read_b128 a[0:3], v13 offset:32768
    s_waitcnt lgkmcnt(6)
    v_mfma_f32_32x32x16_bf16 v[220:235], a[8:11], v[164:167], v[220:235]
    ds_read_b128 a[4:7], v13 offset:33792
    s_waitcnt lgkmcnt(6)
    v_mfma_f32_32x32x16_bf16 v[220:235], a[12:15], v[168:171], v[220:235]
    ds_read_b128 a[8:11], v13 offset:34816
    v_cvt_pk_bf16_f32 v16, v236, v237
    v_cvt_pk_bf16_f32 v17, v238, v239
    v_cvt_pk_bf16_f32 v18, v240, v241
    v_cvt_pk_bf16_f32 v19, v242, v243
    v_cvt_pk_bf16_f32 v20, v244, v245
    v_cvt_pk_bf16_f32 v21, v246, v247
    v_cvt_pk_bf16_f32 v22, v248, v249
    v_cvt_pk_bf16_f32 v23, v250, v251
    buffer_store_dwordx4 v[16:19], v7, s[8:11], s57 offen offset:0 sc1
    buffer_store_dwordx4 v[20:23], v7, s[8:11], s57 offen offset:128 sc1
    s_add_u32 s57, s57, 256
    s_nop 1
    s_waitcnt lgkmcnt(6)
    v_mfma_f32_32x32x16_bf16 v[220:235], a[16:19], v[172:175], v[220:235]
    ds_read_b128 a[12:15], v13 offset:35840
    s_waitcnt lgkmcnt(6)
    v_mfma_f32_32x32x16_bf16 v[220:235], a[20:23], v[176:179], v[220:235]
    ds_read_b128 a[16:19], v13 offset:36864
    s_waitcnt lgkmcnt(6)
    v_mfma_f32_32x32x16_bf16 v[220:235], a[24:27], v[180:183], v[220:235]
    ds_read_b128 a[20:23], v13 offset:37888
    s_waitcnt lgkmcnt(6)
    v_mfma_f32_32x32x16_bf16 v[220:235], a[28:31], v[184:187], v[220:235]
    ds_read_b128 a[24:27], v13 offset:38912
    s_waitcnt lgkmcnt(6)
    v_mfma_f32_32x32x16_bf16 v[236:251], a[0:3], v[156:159], 0
    ds_read_b128 a[28:31], v13 offset:39936
    s_waitcnt lgkmcnt(6)
    v_mfma_f32_32x32x16_bf16 v[236:251], a[4:7], v[160:163], v[236:251]
    ds_read_b128 a[0:3], v13 offset:40960
    s_waitcnt lgkmcnt(6)
    v_mfma_f32_32x32x16_bf16 v[236:251], a[8:11], v[164:167], v[236:251]
    ds_read_b128 a[4:7], v13 offset:41984
    s_waitcnt lgkmcnt(6)
    v_mfma_f32_32x32x16_bf16 v[236:251], a[12:15], v[168:171], v[236:251]
    ds_read_b128 a[8:11], v13 offset:43008
    v_cvt_pk_bf16_f32 v16, v220, v221
    v_cvt_pk_bf16_f32 v17, v222, v223
    v_cvt_pk_bf16_f32 v18, v224, v225
    v_cvt_pk_bf16_f32 v19, v226, v227
    v_cvt_pk_bf16_f32 v20, v228, v229
    v_cvt_pk_bf16_f32 v21, v230, v231
    v_cvt_pk_bf16_f32 v22, v232, v233
    v_cvt_pk_bf16_f32 v23, v234, v235
    buffer_store_dwordx4 v[16:19], v7, s[8:11], s57 offen offset:0 sc1
    buffer_store_dwordx4 v[20:23], v7, s[8:11], s57 offen offset:128 sc1
    s_add_u32 s57, s57, 256
    s_nop 1
    s_waitcnt lgkmcnt(6)
    v_mfma_f32_32x32x16_bf16 v[236:251], a[16:19], v[172:175], v[236:251]
    ds_read_b128 a[12:15], v13 offset:44032
    s_waitcnt lgkmcnt(6)
    v_mfma_f32_32x32x16_bf16 v[236:251], a[20:23], v[176:179], v[236:251]
    ds_read_b128 a[16:19], v13 offset:45056
    s_waitcnt lgkmcnt(6)
    v_mfma_f32_32x32x16_bf16 v[236:251], a[24:27], v[180:183], v[236:251]
    ds_read_b128 a[20:23], v13 offset:46080
    s_waitcnt lgkmcnt(6)
    v_mfma_f32_32x32x16_bf16 v[236:251], a[28:31], v[184:187], v[236:251]
    ds_read_b128 a[24:27], v13 offset:47104
    s_waitcnt lgkmcnt(6)
    v_mfma_f32_32x32x16_bf16 v[220:235], a[0:3], v[156:159], 0
    ds_read_b128 a[28:31], v13 offset:48128
    s_waitcnt lgkmcnt(6)
    v_mfma_f32_32x32x16_bf16 v[220:235], a[4:7], v[160:163], v[220:235]
    ds_read_b128 a[0:3], v13 offset:49152
    s_waitcnt lgkmcnt(6)
    v_mfma_f32_32x32x16_bf16 v[220:235], a[8:11], v[164:167], v[220:235]
    ds_read_b128 a[4:7], v13 offset:50176
    s_waitcnt lgkmcnt(6)
    v_mfma_f32_32x32x16_bf16 v[220:235], a[12:15], v[168:171], v[220:235]
    ds_read_b128 a[8:11], v13 offset:51200
    v_cvt_pk_bf16_f32 v16, v236, v237
    v_cvt_pk_bf16_f32 v17, v238, v239
    v_cvt_pk_bf16_f32 v18, v240, v241
    v_cvt_pk_bf16_f32 v19, v242, v243
    v_cvt_pk_bf16_f32 v20, v244, v245
    v_cvt_pk_bf16_f32 v21, v246, v247
    v_cvt_pk_bf16_f32 v22, v248, v249
    v_cvt_pk_bf16_f32 v23, v250, v251
    buffer_store_dwordx4 v[16:19], v7, s[8:11], s57 offen offset:0 sc1
    buffer_store_dwordx4 v[20:23], v7, s[8:11], s57 offen offset:128 sc1
    s_add_u32 s57, s57, 256
    s_nop 1
    s_waitcnt lgkmcnt(6)
    v_mfma_f32_32x32x16_bf16 v[220:235], a[16:19], v[172:175], v[220:235]
    ds_read_b128 a[12:15], v13 offset:52224
    s_waitcnt lgkmcnt(6)
    v_mfma_f32_32x32x16_bf16 v[220:235], a[20:23], v[176:179], v[220:235]
    ds_read_b128 a[16:19], v13 offset:53248
    s_waitcnt lgkmcnt(6)
    v_mfma_f32_32x32x16_bf16 v[220:235], a[24:27], v[180:183], v[220:235]
    ds_read_b128 a[20:23], v13 offset:54272
    s_waitcnt lgkmcnt(6)
    v_mfma_f32_32x32x16_bf16 v[220:235], a[28:31], v[184:187], v[220:235]
    ds_read_b128 a[24:27], v13 offset:55296
    s_waitcnt lgkmcnt(6)
    v_mfma_f32_32x32x16_bf16 v[236:251], a[0:3], v[156:159], 0
    ds_read_b128 a[28:31], v13 offset:56320
    s_waitcnt lgkmcnt(6)
    v_mfma_f32_32x32x16_bf16 v[236:251], a[4:7], v[160:163], v[236:251]
    ds_read_b128 a[0:3], v13 offset:57344
    s_waitcnt lgkmcnt(6)
    v_mfma_f32_32x32x16_bf16 v[236:251], a[8:11], v[164:167], v[236:251]
    ds_read_b128 a[4:7], v13 offset:58368
    s_waitcnt lgkmcnt(6)
    v_mfma_f32_32x32x16_bf16 v[236:251], a[12:15], v[168:171], v[236:251]
    ds_read_b128 a[8:11], v13 offset:59392
    v_cvt_pk_bf16_f32 v16, v220, v221
    v_cvt_pk_bf16_f32 v17, v222, v223
    v_cvt_pk_bf16_f32 v18, v224, v225
    v_cvt_pk_bf16_f32 v19, v226, v227
    v_cvt_pk_bf16_f32 v20, v228, v229
    v_cvt_pk_bf16_f32 v21, v230, v231
    v_cvt_pk_bf16_f32 v22, v232, v233
    v_cvt_pk_bf16_f32 v23, v234, v235
    buffer_store_dwordx4 v[16:19], v7, s[8:11], s57 offen offset:0 sc1
    buffer_store_dwordx4 v[20:23], v7, s[8:11], s57 offen offset:128 sc1
    s_add_u32 s57, s57, 256
    s_nop 1
    s_waitcnt lgkmcnt(6)
    v_mfma_f32_32x32x16_bf16 v[236:251], a[16:19], v[172:175], v[236:251]
    ds_read_b128 a[12:15], v13 offset:60416
    s_waitcnt lgkmcnt(6)
    v_mfma_f32_32x32x16_bf16 v[236:251], a[20:23], v[176:179], v[236:251]
    ds_read_b128 a[16:19], v13 offset:61440
    s_waitcnt lgkmcnt(6)
    v_mfma_f32_32x32x16_bf16 v[236:251], a[24:27], v[180:183], v[236:251]
    ds_read_b128 a[20:23], v13 offset:62464
    s_waitcnt lgkmcnt(6)
    v_mfma_f32_32x32x16_bf16 v[236:251], a[28:31], v[184:187], v[236:251]
    ds_read_b128 a[24:27], v13 offset:63488
    s_waitcnt lgkmcnt(6)
    v_mfma_f32_32x32x16_bf16 v[220:235], a[0:3], v[156:159], 0
    v_add_u32 v13, 57344, v13
    ds_read_b128 a[28:31], v13 offset:7168
    s_waitcnt lgkmcnt(6)
    v_mfma_f32_32x32x16_bf16 v[220:235], a[4:7], v[160:163], v[220:235]
    ds_read_b128 a[0:3], v13 offset:8192
    s_waitcnt lgkmcnt(6)
    v_mfma_f32_32x32x16_bf16 v[220:235], a[8:11], v[164:167], v[220:235]
    ds_read_b128 a[4:7], v13 offset:9216
    s_waitcnt lgkmcnt(6)
    v_mfma_f32_32x32x16_bf16 v[220:235], a[12:15], v[168:171], v[220:235]
    ds_read_b128 a[8:11], v13 offset:10240
    v_cvt_pk_bf16_f32 v16, v236, v237
    v_cvt_pk_bf16_f32 v17, v238, v239
    v_cvt_pk_bf16_f32 v18, v240, v241
    v_cvt_pk_bf16_f32 v19, v242, v243
    v_cvt_pk_bf16_f32 v20, v244, v245
    v_cvt_pk_bf16_f32 v21, v246, v247
    v_cvt_pk_bf16_f32 v22, v248, v249
    v_cvt_pk_bf16_f32 v23, v250, v251
    buffer_store_dwordx4 v[16:19], v7, s[8:11], s57 offen offset:0 sc1
    buffer_store_dwordx4 v[20:23], v7, s[8:11], s57 offen offset:128 sc1
    s_add_u32 s57, s57, 256
    s_nop 1
    s_waitcnt lgkmcnt(6)
    v_mfma_f32_32x32x16_bf16 v[220:235], a[16:19], v[172:175], v[220:235]
    ds_read_b128 a[12:15], v13 offset:11264
    s_waitcnt lgkmcnt(6)
    v_mfma_f32_32x32x16_bf16 v[220:235], a[20:23], v[176:179], v[220:235]
    ds_read_b128 a[16:19], v13 offset:12288
    s_waitcnt lgkmcnt(6)
    v_mfma_f32_32x32x16_bf16 v[220:235], a[24:27], v[180:183], v[220:235]
    ds_read_b128 a[20:23], v13 offset:13312
    s_waitcnt lgkmcnt(6)
    v_mfma_f32_32x32x16_bf16 v[220:235], a[28:31], v[184:187], v[220:235]
    ds_read_b128 a[24:27], v13 offset:14336
    s_waitcnt lgkmcnt(6)
    v_mfma_f32_32x32x16_bf16 v[236:251], a[0:3], v[156:159], 0
    ds_read_b128 a[28:31], v13 offset:15360
    s_waitcnt lgkmcnt(6)
    v_mfma_f32_32x32x16_bf16 v[236:251], a[4:7], v[160:163], v[236:251]
    ds_read_b128 a[0:3], v13 offset:16384
    s_waitcnt lgkmcnt(6)
    v_mfma_f32_32x32x16_bf16 v[236:251], a[8:11], v[164:167], v[236:251]
    ds_read_b128 a[4:7], v13 offset:17408
    s_waitcnt lgkmcnt(6)
    v_mfma_f32_32x32x16_bf16 v[236:251], a[12:15], v[168:171], v[236:251]
    ds_read_b128 a[8:11], v13 offset:18432
    v_cvt_pk_bf16_f32 v16, v220, v221
    v_cvt_pk_bf16_f32 v17, v222, v223
    v_cvt_pk_bf16_f32 v18, v224, v225
    v_cvt_pk_bf16_f32 v19, v226, v227
    v_cvt_pk_bf16_f32 v20, v228, v229
    v_cvt_pk_bf16_f32 v21, v230, v231
    v_cvt_pk_bf16_f32 v22, v232, v233
    v_cvt_pk_bf16_f32 v23, v234, v235
    buffer_store_dwordx4 v[16:19], v7, s[8:11], s57 offen offset:0 sc1
    buffer_store_dwordx4 v[20:23], v7, s[8:11], s57 offen offset:128 sc1
    s_add_u32 s57, s57, 256
    s_nop 1
    s_waitcnt lgkmcnt(6)
    v_mfma_f32_32x32x16_bf16 v[236:251], a[16:19], v[172:175], v[236:251]
    ds_read_b128 a[12:15], v13 offset:19456
    s_waitcnt lgkmcnt(6)
    v_mfma_f32_32x32x16_bf16 v[236:251], a[20:23], v[176:179], v[236:251]
    ds_read_b128 a[16:19], v13 offset:20480
    s_waitcnt lgkmcnt(6)
    v_mfma_f32_32x32x16_bf16 v[236:251], a[24:27], v[180:183], v[236:251]
    ds_read_b128 a[20:23], v13 offset:21504
    s_waitcnt lgkmcnt(6)
    v_mfma_f32_32x32x16_bf16 v[236:251], a[28:31], v[184:187], v[236:251]
    ds_read_b128 a[24:27], v13 offset:22528
    s_waitcnt lgkmcnt(6)
    v_mfma_f32_32x32x16_bf16 v[220:235], a[0:3], v[156:159], 0
    ds_read_b128 a[28:31], v13 offset:23552
    s_waitcnt lgkmcnt(6)
    v_mfma_f32_32x32x16_bf16 v[220:235], a[4:7], v[160:163], v[220:235]
    ds_read_b128 a[0:3], v13 offset:24576
    s_waitcnt lgkmcnt(6)
    v_mfma_f32_32x32x16_bf16 v[220:235], a[8:11], v[164:167], v[220:235]
    ds_read_b128 a[4:7], v13 offset:25600
    s_waitcnt lgkmcnt(6)
    v_mfma_f32_32x32x16_bf16 v[220:235], a[12:15], v[168:171], v[220:235]
    ds_read_b128 a[8:11], v13 offset:26624
    v_cvt_pk_bf16_f32 v16, v236, v237
    v_cvt_pk_bf16_f32 v17, v238, v239
    v_cvt_pk_bf16_f32 v18, v240, v241
    v_cvt_pk_bf16_f32 v19, v242, v243
    v_cvt_pk_bf16_f32 v20, v244, v245
    v_cvt_pk_bf16_f32 v21, v246, v247
    v_cvt_pk_bf16_f32 v22, v248, v249
    v_cvt_pk_bf16_f32 v23, v250, v251
    buffer_store_dwordx4 v[16:19], v7, s[8:11], s57 offen offset:0 sc1
    buffer_store_dwordx4 v[20:23], v7, s[8:11], s57 offen offset:128 sc1
    s_add_u32 s57, s57, 256
    s_nop 1
    s_waitcnt lgkmcnt(6)
    v_mfma_f32_32x32x16_bf16 v[220:235], a[16:19], v[172:175], v[220:235]
    ds_read_b128 a[12:15], v13 offset:27648
    s_waitcnt lgkmcnt(6)
    v_mfma_f32_32x32x16_bf16 v[220:235], a[20:23], v[176:179], v[220:235]
    ds_read_b128 a[16:19], v13 offset:28672
    s_waitcnt lgkmcnt(6)
    v_mfma_f32_32x32x16_bf16 v[220:235], a[24:27], v[180:183], v[220:235]
    ds_read_b128 a[20:23], v13 offset:29696
    s_waitcnt lgkmcnt(6)
    v_mfma_f32_32x32x16_bf16 v[220:235], a[28:31], v[184:187], v[220:235]
    ds_read_b128 a[24:27], v13 offset:30720
    s_waitcnt lgkmcnt(6)
    v_mfma_f32_32x32x16_bf16 v[236:251], a[0:3], v[156:159], 0
    ds_read_b128 a[28:31], v13 offset:31744
    s_waitcnt lgkmcnt(6)
    v_mfma_f32_32x32x16_bf16 v[236:251], a[4:7], v[160:163], v[236:251]
    s_waitcnt lgkmcnt(5)
    v_mfma_f32_32x32x16_bf16 v[236:251], a[8:11], v[164:167], v[236:251]
    s_waitcnt lgkmcnt(4)
    v_mfma_f32_32x32x16_bf16 v[236:251], a[12:15], v[168:171], v[236:251]
    v_cvt_pk_bf16_f32 v16, v220, v221
    v_cvt_pk_bf16_f32 v17, v222, v223
    v_cvt_pk_bf16_f32 v18, v224, v225
    v_cvt_pk_bf16_f32 v19, v226, v227
    v_cvt_pk_bf16_f32 v20, v228, v229
    v_cvt_pk_bf16_f32 v21, v230, v231
    v_cvt_pk_bf16_f32 v22, v232, v233
    v_cvt_pk_bf16_f32 v23, v234, v235
    buffer_store_dwordx4 v[16:19], v7, s[8:11], s57 offen offset:0 sc1
    buffer_store_dwordx4 v[20:23], v7, s[8:11], s57 offen offset:128 sc1
    s_add_u32 s57, s57, 256
    s_nop 1
    s_waitcnt lgkmcnt(3)
    v_mfma_f32_32x32x16_bf16 v[236:251], a[16:19], v[172:175], v[236:251]
    s_waitcnt lgkmcnt(2)
    v_mfma_f32_32x32x16_bf16 v[236:251], a[20:23], v[176:179], v[236:251]
    s_waitcnt lgkmcnt(1)
    v_mfma_f32_32x32x16_bf16 v[236:251], a[24:27], v[180:183], v[236:251]
    s_waitcnt lgkmcnt(0)
    v_mfma_f32_32x32x16_bf16 v[236:251], a[28:31], v[184:187], v[236:251]
    s_nop 7
    s_nop 3
    v_cvt_pk_bf16_f32 v16, v236, v237
    v_cvt_pk_bf16_f32 v17, v238, v239
    v_cvt_pk_bf16_f32 v18, v240, v241
    v_cvt_pk_bf16_f32 v19, v242, v243
    v_cvt_pk_bf16_f32 v20, v244, v245
    v_cvt_pk_bf16_f32 v21, v246, v247
    v_cvt_pk_bf16_f32 v22, v248, v249
    v_cvt_pk_bf16_f32 v23, v250, v251
    buffer_store_dwordx4 v[16:19], v7, s[8:11], s57 offen offset:0 sc1
    buffer_store_dwordx4 v[20:23], v7, s[8:11], s57 offen offset:128 sc1
    s_add_u32 s57, s57, 256
    s_nop 1
    s_waitcnt vmcnt(0)
    s_mul_i32 s50, s22, 128
    s_add_u32 s50, s50, 6094848
    s_mul_i32 s37, s21, 4
    s_add_u32 s50, s50, s37
    s_mov_b64 exec, 1
    v_mov_b32 v14, 1
    buffer_store_dword v14, off, s[8:11], s50 sc1
    s_mov_b64 exec, -1
    s_add_u32 s22, s22, 4
    s_branch Lal_51
Lal_52:
    s_waitcnt vmcnt(0)
    s_branch L_end
L_ffn:
    s_mov_b32 s23, 0
    s_mov_b64 exec, 1
    v_mov_b32 v250, 44
Lwi_57:
    buffer_load_dword v251, v250, s[16:19], 0 offen sc1
    s_waitcnt vmcnt(0)
    v_readfirstlane_b32 s38, v251
    s_cmp_lg_u32 s38, 0
    s_cbranch_scc1 Lwi_58
    s_add_u32 s23, s23, 1
    s_cmp_gt_u32 s23, 3000000
    s_cbranch_scc1 L_wfail
    s_sleep 1
    s_branch Lwi_57
Lwi_58:
    s_mov_b64 exec, -1
    s_and_b32 s44, s21, 31
    s_lshl_b32 s44, s44, 4
    s_add_u32 s44, s44, 6031872
    s_cmp_lg_u32 s20, 0
    s_cbranch_scc1 Lww_59
    s_mov_b32 exec_lo, 0x7
    s_mov_b32 exec_hi, 0x0
    v_mbcnt_lo_u32_b32 v250, -1, 0
    v_mbcnt_hi_u32_b32 v250, -1, v250
    v_lshlrev_b32 v250, 2, v250
Lwf_60:
    buffer_load_dword v251, v250, s[8:11], s44 offen sc1
    s_waitcnt vmcnt(0)
    v_cmp_eq_u32 vcc, 0, v251
    s_cbranch_vccz Lwf_61
    s_add_u32 s23, s23, 1
    s_cmp_gt_u32 s23, 3000000
    s_cbranch_scc1 L_wfail
    s_sleep 8
    s_branch Lwf_60
Lwf_61:
    s_mov_b64 exec, -1
Lww_59:
    s_barrier
    s_sub_u32 s21, s21, 128
    s_load_dwordx2 s[24:25], s[0:1], 64
    s_waitcnt lgkmcnt(0)
    s_mov_b32 s12, s24
    s_mov_b32 s13, s25
    s_mov_b32 s14, 5308416
    s_mov_b32 s15, 0x20000
    s_lshl_b32 s44, s21, 8
    v_and_b32 v1, 63, v0
    v_lshrrev_b32 v2, 4, v1
    v_and_b32 v3, 15, v1
    v_lshlrev_b32 v4, 2, v2
    v_xor_b32 v3, v3, v4
    v_lshlrev_b32 v3, 4, v3
    v_mul_u32_u24 v4, 9216, v2
    v_add_u32 v3, v3, v4
    s_mul_i32 s28, s20, 36
    s_lshl_b32 s29, s28, 10
    s_add_u32 s29, s29, 0
    s_mul_i32 s30, s28, 36864
    s_add_u32 s30, s30, s44
    s_mov_b32 s31, 0
Lwd_62:
    s_mov_b32 m0, s29
    s_add_u32 s29, s29, 1024
    buffer_load_dwordx4 v3, s[12:15], s30 offen nt lds
    s_add_u32 s30, s30, 36864
    s_add_u32 s31, s31, 1
    s_cmp_lt_u32 s31, 36
    s_cbranch_scc1 Lwd_62
    v_lshrrev_b32 v4, 4, v1
    v_lshrrev_b32 v5, 2, v1
    v_and_b32 v5, 3, v5
    v_and_b32 v6, 3, v1
    v_lshrrev_b32 v7, 1, v4
    v_and_b32 v8, 1, v4
    v_lshlrev_b32 v8, 1, v8
    v_lshrrev_b32 v9, 1, v6
    s_lshl_b32 s28, s20, 2
    v_add3_u32 v8, v8, v9, s28
    v_lshlrev_b32 v9, 2, v5
    v_xor_b32 v8, v8, v9
    v_lshlrev_b32 v8, 4, v8
    v_and_b32 v9, 1, v6
    v_lshlrev_b32 v9, 3, v9
    v_add_u32 v8, v8, v9
    v_lshlrev_b32 v9, 2, v7
    v_add_u32 v9, v9, v5
    v_lshlrev_b32 v9, 8, v9
    v_add_u32 v10, v8, v9
    v_add_u32 v10, 0, v10
    s_waitcnt vmcnt(0)
    s_barrier
    ds_read_b64_tr_b16 v[64:65], v10 offset:0
    ds_read_b64_tr_b16 v[66:67], v10 offset:2048
    ds_read_b64_tr_b16 v[68:69], v10 offset:4096
    ds_read_b64_tr_b16 v[70:71], v10 offset:6144
    ds_read_b64_tr_b16 v[72:73], v10 offset:8192
    ds_read_b64_tr_b16 v[74:75], v10 offset:10240
    ds_read_b64_tr_b16 v[76:77], v10 offset:12288
    ds_read_b64_tr_b16 v[78:79], v10 offset:14336
    s_waitcnt lgkmcnt(4)
    ds_read_b64_tr_b16 v[80:81], v10 offset:16384
    ds_read_b64_tr_b16 v[82:83], v10 offset:18432
    ds_read_b64_tr_b16 v[84:85], v10 offset:20480
    ds_read_b64_tr_b16 v[86:87], v10 offset:22528
    ds_read_b64_tr_b16 v[88:89], v10 offset:24576
    ds_read_b64_tr_b16 v[90:91], v10 offset:26624
    ds_read_b64_tr_b16 v[92:93], v10 offset:28672
    ds_read_b64_tr_b16 v[94:95], v10 offset:30720
    s_waitcnt lgkmcnt(4)
    v_add_u32 v10, 32768, v10
    ds_read_b64_tr_b16 v[96:97], v10 offset:0
    ds_read_b64_tr_b16 v[98:99], v10 offset:2048
    ds_read_b64_tr_b16 v[100:101], v10 offset:4096
    ds_read_b64_tr_b16 v[102:103], v10 offset:6144
    ds_read_b64_tr_b16 v[104:105], v10 offset:8192
    ds_read_b64_tr_b16 v[106:107], v10 offset:10240
    ds_read_b64_tr_b16 v[108:109], v10 offset:12288
    ds_read_b64_tr_b16 v[110:111], v10 offset:14336
    s_waitcnt lgkmcnt(4)
    ds_read_b64_tr_b16 v[112:113], v10 offset:16384
    ds_read_b64_tr_b16 v[114:115], v10 offset:18432
    ds_read_b64_tr_b16 v[116:117], v10 offset:20480
    ds_read_b64_tr_b16 v[118:119], v10 offset:22528
    ds_read_b64_tr_b16 v[120:121], v10 offset:24576
    ds_read_b64_tr_b16 v[122:123], v10 offset:26624
    ds_read_b64_tr_b16 v[124:125], v10 offset:28672
    ds_read_b64_tr_b16 v[126:127], v10 offset:30720
    s_waitcnt lgkmcnt(4)
    v_add_u32 v10, 32768, v10
    ds_read_b64_tr_b16 v[128:129], v10 offset:0
    ds_read_b64_tr_b16 v[130:131], v10 offset:2048
    ds_read_b64_tr_b16 v[132:133], v10 offset:4096
    ds_read_b64_tr_b16 v[134:135], v10 offset:6144
    ds_read_b64_tr_b16 v[136:137], v10 offset:8192
    ds_read_b64_tr_b16 v[138:139], v10 offset:10240
    ds_read_b64_tr_b16 v[140:141], v10 offset:12288
    ds_read_b64_tr_b16 v[142:143], v10 offset:14336
    s_waitcnt lgkmcnt(4)
    ds_read_b64_tr_b16 v[144:145], v10 offset:16384
    ds_read_b64_tr_b16 v[146:147], v10 offset:18432
    ds_read_b64_tr_b16 v[148:149], v10 offset:20480
    ds_read_b64_tr_b16 v[150:151], v10 offset:22528
    ds_read_b64_tr_b16 v[152:153], v10 offset:24576
    ds_read_b64_tr_b16 v[154:155], v10 offset:26624
    ds_read_b64_tr_b16 v[156:157], v10 offset:28672
    ds_read_b64_tr_b16 v[158:159], v10 offset:30720
    s_waitcnt lgkmcnt(4)
    v_add_u32 v10, 32768, v10
    ds_read_b64_tr_b16 v[160:161], v10 offset:0
    ds_read_b64_tr_b16 v[162:163], v10 offset:2048
    ds_read_b64_tr_b16 v[164:165], v10 offset:4096
    ds_read_b64_tr_b16 v[166:167], v10 offset:6144
    ds_read_b64_tr_b16 v[168:169], v10 offset:8192
    ds_read_b64_tr_b16 v[170:171], v10 offset:10240
    ds_read_b64_tr_b16 v[172:173], v10 offset:12288
    ds_read_b64_tr_b16 v[174:175], v10 offset:14336
    s_waitcnt lgkmcnt(4)
    ds_read_b64_tr_b16 v[176:177], v10 offset:16384
    ds_read_b64_tr_b16 v[178:179], v10 offset:18432
    ds_read_b64_tr_b16 v[180:181], v10 offset:20480
    ds_read_b64_tr_b16 v[182:183], v10 offset:22528
    ds_read_b64_tr_b16 v[184:185], v10 offset:24576
    ds_read_b64_tr_b16 v[186:187], v10 offset:26624
    ds_read_b64_tr_b16 v[188:189], v10 offset:28672
    ds_read_b64_tr_b16 v[190:191], v10 offset:30720
    s_waitcnt lgkmcnt(4)
    v_add_u32 v10, 32768, v10
    ds_read_b64_tr_b16 v[192:193], v10 offset:0
    ds_read_b64_tr_b16 v[194:195], v10 offset:2048
    ds_read_b64_tr_b16 v[196:197], v10 offset:4096
    ds_read_b64_tr_b16 v[198:199], v10 offset:6144
    ds_read_b64_tr_b16 v[200:201], v10 offset:8192
    ds_read_b64_tr_b16 v[202:203], v10 offset:10240
    ds_read_b64_tr_b16 v[204:205], v10 offset:12288
    ds_read_b64_tr_b16 v[206:207], v10 offset:14336
    s_waitcnt lgkmcnt(4)
    s_waitcnt lgkmcnt(0)
    s_barrier
    s_load_dwordx2 s[24:25], s[0:1], 72
    s_waitcnt lgkmcnt(0)
    s_mov_b32 s12, s24
    s_mov_b32 s13, s25
    s_mov_b32 s14, 5308416
    s_mov_b32 s15, 0x20000
    s_mul_i32 s44, s21, 147456
    v_and_b32 v1, 63, v0
    v_lshrrev_b32 v2, 2, v1
    v_and_b32 v3, 3, v1
    v_mul_u32_u24 v2, 1152, v2
    v_lshlrev_b32 v3, 4, v3
    v_add_u32 v3, v2, v3
    s_mov_b32 s28, s20
Lti_63:
    s_cmp_ge_u32 s28, 18
    s_cbranch_scc1 Lti_64
    s_mul_i32 s29, s28, 8192
    s_add_u32 s29, s29, 0
    s_mul_i32 s30, s28, 64
    s_add_u32 s30, s30, s44
    s_mov_b32 m0, s29
    s_add_u32 s29, s29, 1024
    s_add_u32 s31, s30, 0
    buffer_load_dwordx4 v3, s[12:15], s31 offen nt lds
    s_mov_b32 m0, s29
    s_add_u32 s29, s29, 1024
    s_add_u32 s31, s30, 18432
    buffer_load_dwordx4 v3, s[12:15], s31 offen nt lds
    s_mov_b32 m0, s29
    s_add_u32 s29, s29, 1024
    s_add_u32 s31, s30, 36864
    buffer_load_dwordx4 v3, s[12:15], s31 offen nt lds
    s_mov_b32 m0, s29
    s_add_u32 s29, s29, 1024
    s_add_u32 s31, s30, 55296
    buffer_load_dwordx4 v3, s[12:15], s31 offen nt lds
    s_mov_b32 m0, s29
    s_add_u32 s29, s29, 1024
    s_add_u32 s31, s30, 73728
    buffer_load_dwordx4 v3, s[12:15], s31 offen nt lds
    s_mov_b32 m0, s29
    s_add_u32 s29, s29, 1024
    s_add_u32 s31, s30, 92160
    buffer_load_dwordx4 v3, s[12:15], s31 offen nt lds
    s_mov_b32 m0, s29
    s_add_u32 s29, s29, 1024
    s_add_u32 s31, s30, 110592
    buffer_load_dwordx4 v3, s[12:15], s31 offen nt lds
    s_mov_b32 m0, s29
    s_add_u32 s29, s29, 1024
    s_add_u32 s31, s30, 129024
    buffer_load_dwordx4 v3, s[12:15], s31 offen nt lds
    s_add_u32 s28, s28, 4
    s_branch Lti_63
Lti_64:
    v_lshrrev_b32 v4, 4, v1
    v_lshrrev_b32 v5, 2, v1
    v_and_b32 v5, 3, v5
    v_and_b32 v6, 3, v1
    v_lshrrev_b32 v7, 1, v4
    v_lshlrev_b32 v7, 2, v7
    v_add_u32 v7, v7, v5
    v_lshlrev_b32 v7, 6, v7
    v_and_b32 v8, 1, v4
    v_lshlrev_b32 v8, 5, v8
    v_lshlrev_b32 v6, 3, v6
    v_add3_u32 v7, v7, v8, v6
    v_lshlrev_b32 v8, 4, v1
    s_waitcnt vmcnt(0)
    s_mov_b32 s28, s20
Lti_65:
    s_cmp_ge_u32 s28, 18
    s_cbranch_scc1 Lti_66
    s_mul_i32 s29, s28, 8192
    s_add_u32 s29, s29, 0
    v_add_u32 v9, s29, v7
    v_add_u32 v10, s29, v8
    ds_read_b64_tr_b16 v[16:17], v9 offset:0
    ds_read_b64_tr_b16 v[18:19], v9 offset:512
    ds_read_b64_tr_b16 v[20:21], v9 offset:1024
    ds_read_b64_tr_b16 v[22:23], v9 offset:1536
    ds_read_b64_tr_b16 v[24:25], v9 offset:2048
    ds_read_b64_tr_b16 v[26:27], v9 offset:2560
    ds_read_b64_tr_b16 v[28:29], v9 offset:3072
    ds_read_b64_tr_b16 v[30:31], v9 offset:3584
    ds_read_b64_tr_b16 v[32:33], v9 offset:4096
    ds_read_b64_tr_b16 v[34:35], v9 offset:4608
    ds_read_b64_tr_b16 v[36:37], v9 offset:5120
    ds_read_b64_tr_b16 v[38:39], v9 offset:5632
    ds_read_b64_tr_b16 v[40:41], v9 offset:6144
    ds_read_b64_tr_b16 v[42:43], v9 offset:6656
    ds_read_b64_tr_b16 v[44:45], v9 offset:7168
    ds_read_b64_tr_b16 v[46:47], v9 offset:7680
    s_waitcnt lgkmcnt(0)
    ds_write_b128 v10, v[16:19] offset:0
    ds_write_b128 v10, v[20:23] offset:1024
    ds_write_b128 v10, v[24:27] offset:2048
    ds_write_b128 v10, v[28:31] offset:3072
    ds_write_b128 v10, v[32:35] offset:4096
    ds_write_b128 v10, v[36:39] offset:5120
    ds_write_b128 v10, v[40:43] offset:6144
    ds_write_b128 v10, v[44:47] offset:7168
    s_waitcnt lgkmcnt(0)
    s_add_u32 s28, s28, 4
    s_branch Lti_65
Lti_66:
    s_barrier
    v_and_b32 v1, 63, v0
    v_lshlrev_b32 v1, 4, v1
    s_lshl_b32 s45, s20, 13
    v_add_u32 v2, s45, v1
    ds_read_b128 a[0:3], v2 offset:0
    ds_read_b128 a[4:7], v2 offset:1024
    ds_read_b128 a[8:11], v2 offset:2048
    ds_read_b128 a[12:15], v2 offset:3072
    ds_read_b128 a[16:19], v2 offset:4096
    ds_read_b128 a[20:23], v2 offset:5120
    ds_read_b128 a[24:27], v2 offset:6144
    ds_read_b128 a[28:31], v2 offset:7168
    s_waitcnt lgkmcnt(0)
    v_add_u32 v2, 32768, v2
    ds_read_b128 a[32:35], v2 offset:0
    ds_read_b128 a[36:39], v2 offset:1024
    ds_read_b128 a[40:43], v2 offset:2048
    ds_read_b128 a[44:47], v2 offset:3072
    ds_read_b128 a[48:51], v2 offset:4096
    ds_read_b128 a[52:55], v2 offset:5120
    ds_read_b128 a[56:59], v2 offset:6144
    ds_read_b128 a[60:63], v2 offset:7168
    s_waitcnt lgkmcnt(0)
    v_add_u32 v2, 32768, v2
    ds_read_b128 a[64:67], v2 offset:0
    ds_read_b128 a[68:71], v2 offset:1024
    ds_read_b128 a[72:75], v2 offset:2048
    ds_read_b128 a[76:79], v2 offset:3072
    ds_read_b128 a[80:83], v2 offset:4096
    ds_read_b128 a[84:87], v2 offset:5120
    ds_read_b128 a[88:91], v2 offset:6144
    ds_read_b128 a[92:95], v2 offset:7168
    s_waitcnt lgkmcnt(0)
    v_add_u32 v2, 32768, v2
    ds_read_b128 a[96:99], v2 offset:0
    ds_read_b128 a[100:103], v2 offset:1024
    ds_read_b128 a[104:107], v2 offset:2048
    ds_read_b128 a[108:111], v2 offset:3072
    ds_read_b128 a[112:115], v2 offset:4096
    ds_read_b128 a[116:119], v2 offset:5120
    ds_read_b128 a[120:123], v2 offset:6144
    ds_read_b128 a[124:127], v2 offset:7168
    s_waitcnt lgkmcnt(0)
    v_add_u32 v2, 32768, v2
    s_cmp_lt_u32 s20, 2
    s_cbranch_scc0 Lff_67
    ds_read_b128 a[128:131], v2 offset:0
    ds_read_b128 a[132:135], v2 offset:1024
    ds_read_b128 a[136:139], v2 offset:2048
    ds_read_b128 a[140:143], v2 offset:3072
    ds_read_b128 a[144:147], v2 offset:4096
    ds_read_b128 a[148:151], v2 offset:5120
    ds_read_b128 a[152:155], v2 offset:6144
    ds_read_b128 a[156:159], v2 offset:7168
    s_waitcnt lgkmcnt(0)
    v_add_u32 v2, 32768, v2
Lff_67:
    s_barrier
    v_and_b32 v3, 63, v0
    v_and_b32 v4, 31, v3
    v_lshrrev_b32 v5, 5, v3
    v_lshrrev_b32 v7, 2, v4
    v_mul_u32_u24 v7, 4608, v7
    v_lshlrev_b32 v8, 6, v5
    v_and_b32 v9, 3, v4
    v_lshlrev_b32 v9, 4, v9
    v_add3_u32 v7, v7, v8, v9
    v_add_u32 v8, 73728, v1
    s_lshl_b32 s45, s20, 11
    v_add_u32 v9, s45, v8
    s_mov_b64 exec, 1
    v_mov_b32 v250, 44
Lwi_68:
    buffer_load_dword v251, v250, s[16:19], 0 offen sc1
    s_waitcnt vmcnt(0)
    v_readfirstlane_b32 s38, v251
    s_cmp_lg_u32 s38, 0
    s_cbranch_scc1 Lwi_69
    s_add_u32 s23, s23, 1
    s_cmp_gt_u32 s23, 3000000
    s_cbranch_scc1 L_wfail
    s_sleep 1
    s_branch Lwi_68
Lwi_69:
    s_mov_b64 exec, -1
    s_mov_b32 s22, 0
    s_mov_b32 s51, 6103040
    s_mov_b32 s55, 0
    s_cmp_lg_u32 s20, 0
    s_cbranch_scc1 Lww_70
    s_mov_b32 exec_lo, 0xff
    s_mov_b32 exec_hi, 0x0
    v_mbcnt_lo_u32_b32 v250, -1, 0
    v_mbcnt_hi_u32_b32 v250, -1, v250
    v_lshlrev_b32 v250, 2, v250
Lwf_71:
    buffer_load_dword v251, v250, s[8:11], s51 offen sc1
    s_waitcnt vmcnt(0)
    v_cmp_eq_u32 vcc, 0, v251
    s_cbranch_vccz Lwf_72
    s_add_u32 s23, s23, 1
    s_cmp_gt_u32 s23, 3000000
    s_cbranch_scc1 L_wfail
    s_sleep 1
    s_branch Lwf_71
Lwf_72:
    s_mov_b64 exec, -1
Lww_70:
    s_barrier
    s_mov_b32 s52, 152043520
    s_mov_b32 s53, 0
    s_mul_i32 s32, s20, 9216
    s_add_u32 s33, s32, s53
    s_add_u32 s32, s32, s52
    s_mov_b32 m0, s33
    s_add_u32 s33, s33, 1024
    buffer_load_dwordx4 v1, s[8:11], s32 offen sc1 lds
    s_add_u32 s32, s32, 1024
    s_mov_b32 m0, s33
    s_add_u32 s33, s33, 1024
    buffer_load_dwordx4 v1, s[8:11], s32 offen sc1 lds
    s_add_u32 s32, s32, 1024
    s_mov_b32 m0, s33
    s_add_u32 s33, s33, 1024
    buffer_load_dwordx4 v1, s[8:11], s32 offen sc1 lds
    s_add_u32 s32, s32, 1024
    s_mov_b32 m0, s33
    s_add_u32 s33, s33, 1024
    buffer_load_dwordx4 v1, s[8:11], s32 offen sc1 lds
    s_add_u32 s32, s32, 1024
    s_mov_b32 m0, s33
    s_add_u32 s33, s33, 1024
    buffer_load_dwordx4 v1, s[8:11], s32 offen sc1 lds
    s_add_u32 s32, s32, 1024
    s_mov_b32 m0, s33
    s_add_u32 s33, s33, 1024
    buffer_load_dwordx4 v1, s[8:11], s32 offen sc1 lds
    s_add_u32 s32, s32, 1024
    s_mov_b32 m0, s33
    s_add_u32 s33, s33, 1024
    buffer_load_dwordx4 v1, s[8:11], s32 offen sc1 lds
    s_add_u32 s32, s32, 1024
    s_mov_b32 m0, s33
    s_add_u32 s33, s33, 1024
    buffer_load_dwordx4 v1, s[8:11], s32 offen sc1 lds
    s_add_u32 s32, s32, 1024
    s_mov_b32 m0, s33
    s_add_u32 s33, s33, 1024
    buffer_load_dwordx4 v1, s[8:11], s32 offen sc1 lds
    s_add_u32 s32, s32, 1024
    s_waitcnt vmcnt(0)
Lff_73:
    s_cmp_ge_u32 s22, 32
    s_cselect_b32 s59, 2, 1
    s_waitcnt vmcnt(8)
    s_barrier
    v_add_u32 v2, s53, v1
    ds_read_b128 v[32:35], v2 offset:0
    ds_read_b128 v[36:39], v2 offset:1024
    ds_read_b128 v[40:43], v2 offset:2048
    ds_read_b128 v[44:47], v2 offset:3072
    ds_read_b128 v[48:51], v2 offset:4096
    ds_read_b128 v[52:55], v2 offset:5120
    ds_read_b128 v[56:59], v2 offset:6144
    ds_read_b128 v[60:63], v2 offset:7168
    s_waitcnt lgkmcnt(7)
    v_mfma_f32_32x32x16_bf16 v[16:31], v[64:67], v[32:35], 0
    s_waitcnt lgkmcnt(6)
    v_mfma_f32_32x32x16_bf16 v[16:31], v[68:71], v[36:39], v[16:31]
    ds_read_b128 v[32:35], v2 offset:8192
    s_waitcnt lgkmcnt(6)
    v_mfma_f32_32x32x16_bf16 v[16:31], v[72:75], v[40:43], v[16:31]
    ds_read_b128 v[36:39], v2 offset:9216
    s_waitcnt lgkmcnt(6)
    v_mfma_f32_32x32x16_bf16 v[16:31], v[76:79], v[44:47], v[16:31]
    ds_read_b128 v[40:43], v2 offset:10240
    s_waitcnt lgkmcnt(6)
    v_mfma_f32_32x32x16_bf16 v[16:31], v[80:83], v[48:51], v[16:31]
    ds_read_b128 v[44:47], v2 offset:11264
    s_waitcnt lgkmcnt(6)
    v_mfma_f32_32x32x16_bf16 v[16:31], v[84:87], v[52:55], v[16:31]
    ds_read_b128 v[48:51], v2 offset:12288
    s_waitcnt lgkmcnt(6)
    v_mfma_f32_32x32x16_bf16 v[16:31], v[88:91], v[56:59], v[16:31]
    ds_read_b128 v[52:55], v2 offset:13312
    s_waitcnt lgkmcnt(6)
    v_mfma_f32_32x32x16_bf16 v[16:31], v[92:95], v[60:63], v[16:31]
    ds_read_b128 v[56:59], v2 offset:14336
    s_waitcnt lgkmcnt(6)
    v_mfma_f32_32x32x16_bf16 v[16:31], v[96:99], v[32:35], v[16:31]
    ds_read_b128 v[60:63], v2 offset:15360
    s_waitcnt lgkmcnt(6)
    v_mfma_f32_32x32x16_bf16 v[16:31], v[100:103], v[36:39], v[16:31]
    ds_read_b128 v[32:35], v2 offset:16384
    s_waitcnt lgkmcnt(6)
    v_mfma_f32_32x32x16_bf16 v[16:31], v[104:107], v[40:43], v[16:31]
    ds_read_b128 v[36:39], v2 offset:17408
    s_waitcnt lgkmcnt(6)
    v_mfma_f32_32x32x16_bf16 v[16:31], v[108:111], v[44:47], v[16:31]
    ds_read_b128 v[40:43], v2 offset:18432
    s_waitcnt lgkmcnt(6)
    v_mfma_f32_32x32x16_bf16 v[16:31], v[112:115], v[48:51], v[16:31]
    ds_read_b128 v[44:47], v2 offset:19456
    s_lshl_b32 s56, s59, 7
    s_add_u32 s56, s56, s51
    s_mov_b64 exec, 0xff
    v_lshrrev_b32 v13, 2, v1
    buffer_load_dword v11, v13, s[8:11], s56 offen sc1
    s_mov_b64 exec, -1
    s_waitcnt lgkmcnt(6)
    v_mfma_f32_32x32x16_bf16 v[16:31], v[116:119], v[52:55], v[16:31]
    ds_read_b128 v[48:51], v2 offset:20480
    s_waitcnt lgkmcnt(6)
    v_mfma_f32_32x32x16_bf16 v[16:31], v[120:123], v[56:59], v[16:31]
    ds_read_b128 v[52:55], v2 offset:21504
    s_waitcnt lgkmcnt(6)
    v_mfma_f32_32x32x16_bf16 v[16:31], v[124:127], v[60:63], v[16:31]
    ds_read_b128 v[56:59], v2 offset:22528
    s_waitcnt lgkmcnt(6)
    v_mfma_f32_32x32x16_bf16 v[16:31], v[128:131], v[32:35], v[16:31]
    ds_read_b128 v[60:63], v2 offset:23552
    s_waitcnt lgkmcnt(6)
    v_mfma_f32_32x32x16_bf16 v[16:31], v[132:135], v[36:39], v[16:31]
    ds_read_b128 v[32:35], v2 offset:24576
    s_waitcnt lgkmcnt(6)
    v_mfma_f32_32x32x16_bf16 v[16:31], v[136:139], v[40:43], v[16:31]
    ds_read_b128 v[36:39], v2 offset:25600
    s_waitcnt lgkmcnt(6)
    v_mfma_f32_32x32x16_bf16 v[16:31], v[140:143], v[44:47], v[16:31]
    ds_read_b128 v[40:43], v2 offset:26624
    s_waitcnt lgkmcnt(6)
    v_mfma_f32_32x32x16_bf16 v[16:31], v[144:147], v[48:51], v[16:31]
    ds_read_b128 v[44:47], v2 offset:27648
    s_waitcnt lgkmcnt(6)
    v_mfma_f32_32x32x16_bf16 v[16:31], v[148:151], v[52:55], v[16:31]
    ds_read_b128 v[48:51], v2 offset:28672
    s_waitcnt lgkmcnt(6)
    v_mfma_f32_32x32x16_bf16 v[16:31], v[152:155], v[56:59], v[16:31]
    ds_read_b128 v[52:55], v2 offset:29696
    s_waitcnt lgkmcnt(6)
    v_mfma_f32_32x32x16_bf16 v[16:31], v[156:159], v[60:63], v[16:31]
    ds_read_b128 v[56:59], v2 offset:30720
    s_waitcnt lgkmcnt(6)
    v_mfma_f32_32x32x16_bf16 v[16:31], v[160:163], v[32:35], v[16:31]
    ds_read_b128 v[60:63], v2 offset:31744
    s_waitcnt lgkmcnt(6)
    v_mfma_f32_32x32x16_bf16 v[16:31], v[164:167], v[36:39], v[16:31]
    ds_read_b128 v[32:35], v2 offset:32768
    s_waitcnt lgkmcnt(6)
    v_mfma_f32_32x32x16_bf16 v[16:31], v[168:171], v[40:43], v[16:31]
    ds_read_b128 v[36:39], v2 offset:33792
    s_waitcnt lgkmcnt(6)
    v_mfma_f32_32x32x16_bf16 v[16:31], v[172:175], v[44:47], v[16:31]
    ds_read_b128 v[40:43], v2 offset:34816
    s_waitcnt lgkmcnt(6)
    v_mfma_f32_32x32x16_bf16 v[16:31], v[176:179], v[48:51], v[16:31]
    ds_read_b128 v[44:47], v2 offset:35840
    s_waitcnt lgkmcnt(6)
    v_mfma_f32_32x32x16_bf16 v[16:31], v[180:183], v[52:55], v[16:31]
    s_waitcnt lgkmcnt(5)
    v_mfma_f32_32x32x16_bf16 v[16:31], v[184:187], v[56:59], v[16:31]
    s_waitcnt lgkmcnt(4)
    v_mfma_f32_32x32x16_bf16 v[16:31], v[188:191], v[60:63], v[16:31]
    s_waitcnt lgkmcnt(3)
    v_mfma_f32_32x32x16_bf16 v[16:31], v[192:195], v[32:35], v[16:31]
    s_waitcnt lgkmcnt(2)
    v_mfma_f32_32x32x16_bf16 v[16:31], v[196:199], v[36:39], v[16:31]
    s_waitcnt lgkmcnt(1)
    v_mfma_f32_32x32x16_bf16 v[16:31], v[200:203], v[40:43], v[16:31]
    s_waitcnt lgkmcnt(0)
    v_mfma_f32_32x32x16_bf16 v[16:31], v[204:207], v[44:47], v[16:31]
    s_nop 7
    s_nop 3
    v_max_f32 v16, 0, v16
    v_max_f32 v17, 0, v17
    v_max_f32 v18, 0, v18
    v_max_f32 v19, 0, v19
    v_max_f32 v20, 0, v20
    v_max_f32 v21, 0, v21
    v_max_f32 v22, 0, v22
    v_max_f32 v23, 0, v23
    v_max_f32 v24, 0, v24
    v_max_f32 v25, 0, v25
    v_max_f32 v26, 0, v26
    v_max_f32 v27, 0, v27
    v_max_f32 v28, 0, v28
    v_max_f32 v29, 0, v29
    v_max_f32 v30, 0, v30
    v_max_f32 v31, 0, v31
    v_cvt_pk_bf16_f32 v32, v16, v17
    v_cvt_pk_bf16_f32 v33, v18, v19
    v_cvt_pk_bf16_f32 v34, v20, v21
    v_cvt_pk_bf16_f32 v35, v22, v23
    v_cvt_pk_bf16_f32 v36, v24, v25
    v_cvt_pk_bf16_f32 v37, v26, v27
    v_cvt_pk_bf16_f32 v38, v28, v29
    v_cvt_pk_bf16_f32 v39, v30, v31
    ds_write_b128 v9, v[32:35]
    ds_write_b128 v9, v[36:39] offset:1024
    s_waitcnt vmcnt(0)
    s_cmp_lg_u32 s20, 0
    s_cbranch_scc1 Lff_74
    s_mov_b64 exec, 0xff
    v_cmp_eq_u32 vcc, 0, v11
    s_mov_b64 exec, -1
    s_cmp_eq_u64 vcc, 0
    s_cselect_b32 s25, 1, 0
    s_add_u32 s26, s22, s59
    s_cmp_lt_u32 s26, 64
    s_cselect_b32 s25, s25, 0
    v_mov_b32 v10, s25
    v_mov_b32 v12, 81920
    ds_write_b32 v12, v10
Lff_74:
    s_waitcnt lgkmcnt(0)
    s_barrier
    ds_read_b128 v[208:211], v8 offset:0
    ds_read_b128 v[212:215], v8 offset:1024
    ds_read_b128 v[216:219], v8 offset:2048
    ds_read_b128 v[220:223], v8 offset:3072
    ds_read_b128 v[224:227], v8 offset:4096
    ds_read_b128 v[228:231], v8 offset:5120
    ds_read_b128 v[232:235], v8 offset:6144
    ds_read_b128 v[236:239], v8 offset:7168
    v_mov_b32 v12, 81920
    ds_read_b32 v10, v12
    s_cmp_lg_u32 s20, 0
    s_cbranch_scc1 Lff_75
    s_cmp_eq_u32 s55, 0
    s_cbranch_scc1 Lff_75
    s_mov_b32 s36, s22
    s_sub_u32 s22, s55, 1
    s_mul_i32 s25, s22, 256
    s_add_u32 s25, s25, 6111232
    s_mul_i32 s37, s21, 4
    s_add_u32 s25, s25, s37
    s_mov_b64 exec, 1
    v_mov_b32 v250, 1
    buffer_store_dword v250, off, s[8:11], s25 sc1
    s_mov_b64 exec, -1
    s_mov_b32 s22, s36
Lff_75:
    s_mov_b32 s55, 0
    s_waitcnt lgkmcnt(0)
    v_readfirstlane_b32 s54, v10
    s_cmp_eq_u32 s54, 0
    s_cbranch_scc1 Lff_76
    s_mul_i32 s56, s59, 36864
    s_add_u32 s52, s52, s56
    s_xor_b32 s56, s53, 36864
    s_mul_i32 s32, s20, 9216
    s_add_u32 s33, s32, s56
    s_add_u32 s32, s32, s52
    s_mov_b32 m0, s33
    s_add_u32 s33, s33, 1024
    buffer_load_dwordx4 v1, s[8:11], s32 offen sc1 lds
    s_add_u32 s32, s32, 1024
    s_mov_b32 m0, s33
    s_add_u32 s33, s33, 1024
    buffer_load_dwordx4 v1, s[8:11], s32 offen sc1 lds
    s_add_u32 s32, s32, 1024
    s_mov_b32 m0, s33
    s_add_u32 s33, s33, 1024
    buffer_load_dwordx4 v1, s[8:11], s32 offen sc1 lds
    s_add_u32 s32, s32, 1024
    s_mov_b32 m0, s33
    s_add_u32 s33, s33, 1024
    buffer_load_dwordx4 v1, s[8:11], s32 offen sc1 lds
    s_add_u32 s32, s32, 1024
    s_mov_b32 m0, s33
    s_add_u32 s33, s33, 1024
    buffer_load_dwordx4 v1, s[8:11], s32 offen sc1 lds
    s_add_u32 s32, s32, 1024
    s_mov_b32 m0, s33
    s_add_u32 s33, s33, 1024
    buffer_load_dwordx4 v1, s[8:11], s32 offen sc1 lds
    s_add_u32 s32, s32, 1024
    s_mov_b32 m0, s33
    s_add_u32 s33, s33, 1024
    buffer_load_dwordx4 v1, s[8:11], s32 offen sc1 lds
    s_add_u32 s32, s32, 1024
    s_mov_b32 m0, s33
    s_add_u32 s33, s33, 1024
    buffer_load_dwordx4 v1, s[8:11], s32 offen sc1 lds
    s_add_u32 s32, s32, 1024
    s_mov_b32 m0, s33
    s_add_u32 s33, s33, 1024
    buffer_load_dwordx4 v1, s[8:11], s32 offen sc1 lds
    s_add_u32 s32, s32, 1024
Lff_76:
    s_mul_i32 s57, s22, 36
    s_add_u32 s57, s57, s21
    s_mul_i32 s57, s57, 36864
    s_add_u32 s57, s57, 155189248
    s_lshl_b32 s58, s20, 8
    s_add_u32 s57, s57, s58
    v_mfma_f32_32x32x16_bf16 v[16:31], a[0:3], v[208:211], 0
    v_mfma_f32_32x32x16_bf16 v[16:31], a[4:7], v[212:215], v[16:31]
    v_mfma_f32_32x32x16_bf16 v[16:31], a[8:11], v[216:219], v[16:31]
    v_mfma_f32_32x32x16_bf16 v[16:31], a[12:15], v[220:223], v[16:31]
    v_mfma_f32_32x32x16_bf16 v[16:31], a[16:19], v[224:227], v[16:31]
    v_mfma_f32_32x32x16_bf16 v[16:31], a[20:23], v[228:231], v[16:31]
    v_mfma_f32_32x32x16_bf16 v[16:31], a[24:27], v[232:235], v[16:31]
    v_mfma_f32_32x32x16_bf16 v[16:31], a[28:31], v[236:239], v[16:31]
    v_mfma_f32_32x32x16_bf16 v[240:255], a[32:35], v[208:211], 0
    v_mfma_f32_32x32x16_bf16 v[240:255], a[36:39], v[212:215], v[240:255]
    v_mfma_f32_32x32x16_bf16 v[240:255], a[40:43], v[216:219], v[240:255]
    v_mfma_f32_32x32x16_bf16 v[240:255], a[44:47], v[220:223], v[240:255]
    v_mfma_f32_32x32x16_bf16 v[240:255], a[48:51], v[224:227], v[240:255]
    v_mfma_f32_32x32x16_bf16 v[240:255], a[52:55], v[228:231], v[240:255]
    v_mfma_f32_32x32x16_bf16 v[240:255], a[56:59], v[232:235], v[240:255]
    v_mfma_f32_32x32x16_bf16 v[240:255], a[60:63], v[236:239], v[240:255]
    v_cvt_pk_bf16_f32 v40, v16, v17
    v_cvt_pk_bf16_f32 v41, v18, v19
    v_cvt_pk_bf16_f32 v42, v20, v21
    v_cvt_pk_bf16_f32 v43, v22, v23
    v_cvt_pk_bf16_f32 v44, v24, v25
    v_cvt_pk_bf16_f32 v45, v26, v27
    v_cvt_pk_bf16_f32 v46, v28, v29
    v_cvt_pk_bf16_f32 v47, v30, v31
    buffer_store_dwordx4 v[40:43], v7, s[8:11], s57 offen offset:0 sc1
    buffer_store_dwordx4 v[44:47], v7, s[8:11], s57 offen offset:128 sc1
    s_add_u32 s57, s57, 1024
    v_mfma_f32_32x32x16_bf16 v[16:31], a[64:67], v[208:211], 0
    v_mfma_f32_32x32x16_bf16 v[16:31], a[68:71], v[212:215], v[16:31]
    v_mfma_f32_32x32x16_bf16 v[16:31], a[72:75], v[216:219], v[16:31]
    v_mfma_f32_32x32x16_bf16 v[16:31], a[76:79], v[220:223], v[16:31]
    v_mfma_f32_32x32x16_bf16 v[16:31], a[80:83], v[224:227], v[16:31]
    v_mfma_f32_32x32x16_bf16 v[16:31], a[84:87], v[228:231], v[16:31]
    v_mfma_f32_32x32x16_bf16 v[16:31], a[88:91], v[232:235], v[16:31]
    v_mfma_f32_32x32x16_bf16 v[16:31], a[92:95], v[236:239], v[16:31]
    v_cvt_pk_bf16_f32 v48, v240, v241
    v_cvt_pk_bf16_f32 v49, v242, v243
    v_cvt_pk_bf16_f32 v50, v244, v245
    v_cvt_pk_bf16_f32 v51, v246, v247
    v_cvt_pk_bf16_f32 v52, v248, v249
    v_cvt_pk_bf16_f32 v53, v250, v251
    v_cvt_pk_bf16_f32 v54, v252, v253
    v_cvt_pk_bf16_f32 v55, v254, v255
    buffer_store_dwordx4 v[48:51], v7, s[8:11], s57 offen offset:0 sc1
    buffer_store_dwordx4 v[52:55], v7, s[8:11], s57 offen offset:128 sc1
    s_add_u32 s57, s57, 1024
    v_mfma_f32_32x32x16_bf16 v[240:255], a[96:99], v[208:211], 0
    v_mfma_f32_32x32x16_bf16 v[240:255], a[100:103], v[212:215], v[240:255]
    v_mfma_f32_32x32x16_bf16 v[240:255], a[104:107], v[216:219], v[240:255]
    v_mfma_f32_32x32x16_bf16 v[240:255], a[108:111], v[220:223], v[240:255]
    v_mfma_f32_32x32x16_bf16 v[240:255], a[112:115], v[224:227], v[240:255]
    v_mfma_f32_32x32x16_bf16 v[240:255], a[116:119], v[228:231], v[240:255]
    v_mfma_f32_32x32x16_bf16 v[240:255], a[120:123], v[232:235], v[240:255]
    v_mfma_f32_32x32x16_bf16 v[240:255], a[124:127], v[236:239], v[240:255]
    v_cvt_pk_bf16_f32 v40, v16, v17
    v_cvt_pk_bf16_f32 v41, v18, v19
    v_cvt_pk_bf16_f32 v42, v20, v21
    v_cvt_pk_bf16_f32 v43, v22, v23
    v_cvt_pk_bf16_f32 v44, v24, v25
    v_cvt_pk_bf16_f32 v45, v26, v27
    v_cvt_pk_bf16_f32 v46, v28, v29
    v_cvt_pk_bf16_f32 v47, v30, v31
    buffer_store_dwordx4 v[40:43], v7, s[8:11], s57 offen offset:0 sc1
    buffer_store_dwordx4 v[44:47], v7, s[8:11], s57 offen offset:128 sc1
    s_add_u32 s57, s57, 1024
    s_cmp_lt_u32 s20, 2
    s_cbranch_scc0 Lff_77
    v_mfma_f32_32x32x16_bf16 v[16:31], a[128:131], v[208:211], 0
    v_mfma_f32_32x32x16_bf16 v[16:31], a[132:135], v[212:215], v[16:31]
    v_mfma_f32_32x32x16_bf16 v[16:31], a[136:139], v[216:219], v[16:31]
    v_mfma_f32_32x32x16_bf16 v[16:31], a[140:143], v[220:223], v[16:31]
    v_mfma_f32_32x32x16_bf16 v[16:31], a[144:147], v[224:227], v[16:31]
    v_mfma_f32_32x32x16_bf16 v[16:31], a[148:151], v[228:231], v[16:31]
    v_mfma_f32_32x32x16_bf16 v[16:31], a[152:155], v[232:235], v[16:31]
    v_mfma_f32_32x32x16_bf16 v[16:31], a[156:159], v[236:239], v[16:31]
    v_cvt_pk_bf16_f32 v48, v240, v241
    v_cvt_pk_bf16_f32 v49, v242, v243
    v_cvt_pk_bf16_f32 v50, v244, v245
    v_cvt_pk_bf16_f32 v51, v246, v247
    v_cvt_pk_bf16_f32 v52, v248, v249
    v_cvt_pk_bf16_f32 v53, v250, v251
    v_cvt_pk_bf16_f32 v54, v252, v253
    v_cvt_pk_bf16_f32 v55, v254, v255
    buffer_store_dwordx4 v[48:51], v7, s[8:11], s57 offen offset:0 sc1
    buffer_store_dwordx4 v[52:55], v7, s[8:11], s57 offen offset:128 sc1
    s_add_u32 s57, s57, 1024
    s_nop 7
    s_nop 3
    v_cvt_pk_bf16_f32 v40, v16, v17
    v_cvt_pk_bf16_f32 v41, v18, v19
    v_cvt_pk_bf16_f32 v42, v20, v21
    v_cvt_pk_bf16_f32 v43, v22, v23
    v_cvt_pk_bf16_f32 v44, v24, v25
    v_cvt_pk_bf16_f32 v45, v26, v27
    v_cvt_pk_bf16_f32 v46, v28, v29
    v_cvt_pk_bf16_f32 v47, v30, v31
    buffer_store_dwordx4 v[40:43], v7, s[8:11], s57 offen offset:0 sc1
    buffer_store_dwordx4 v[44:47], v7, s[8:11], s57 offen offset:128 sc1
    s_add_u32 s57, s57, 1024
    s_branch Lff_78
Lff_77:
    s_nop 7
    s_nop 3
    v_cvt_pk_bf16_f32 v48, v240, v241
    v_cvt_pk_bf16_f32 v49, v242, v243
    v_cvt_pk_bf16_f32 v50, v244, v245
    v_cvt_pk_bf16_f32 v51, v246, v247
    v_cvt_pk_bf16_f32 v52, v248, v249
    v_cvt_pk_bf16_f32 v53, v250, v251
    v_cvt_pk_bf16_f32 v54, v252, v253
    v_cvt_pk_bf16_f32 v55, v254, v255
    buffer_store_dwordx4 v[48:51], v7, s[8:11], s57 offen offset:0 sc1
    buffer_store_dwordx4 v[52:55], v7, s[8:11], s57 offen offset:128 sc1
    s_add_u32 s57, s57, 1024
Lff_78:
    s_cmp_eq_u32 s54, 0
    s_cbranch_scc1 Lff_79
    s_add_u32 s55, s22, 1
    s_add_u32 s22, s22, s59
    s_lshl_b32 s56, s59, 7
    s_add_u32 s51, s51, s56
    s_xor_b32 s53, s53, 36864
    s_branch Lff_73
Lff_79:
    s_waitcnt vmcnt(0)
    s_barrier
    s_cmp_lg_u32 s20, 0
    s_cbranch_scc1 Lff_81
    s_mul_i32 s25, s22, 256
    s_add_u32 s25, s25, 6111232
    s_mul_i32 s37, s21, 4
    s_add_u32 s25, s25, s37
    s_mov_b64 exec, 1
    v_mov_b32 v250, 1
    buffer_store_dword v250, off, s[8:11], s25 sc1
    s_mov_b64 exec, -1
Lff_81:
    s_add_u32 s22, s22, s59
    s_cmp_lt_u32 s22, 64
    s_cbranch_scc0 Lff_80
    s_lshl_b32 s56, s59, 7
    s_add_u32 s51, s51, s56
    s_cmp_lg_u32 s20, 0
    s_cbranch_scc1 Lww_82
    s_mov_b32 exec_lo, 0xff
    s_mov_b32 exec_hi, 0x0
    v_mbcnt_lo_u32_b32 v250, -1, 0
    v_mbcnt_hi_u32_b32 v250, -1, v250
    v_lshlrev_b32 v250, 2, v250
Lwf_83:
    buffer_load_dword v251, v250, s[8:11], s51 offen sc1
    s_waitcnt vmcnt(0)
    v_cmp_eq_u32 vcc, 0, v251
    s_cbranch_vccz Lwf_84
    s_add_u32 s23, s23, 1
    s_cmp_gt_u32 s23, 3000000
    s_cbranch_scc1 L_wfail
    s_sleep 1
    s_branch Lwf_83
Lwf_84:
    s_mov_b64 exec, -1
Lww_82:
    s_barrier
    s_mul_i32 s56, s59, 36864
    s_add_u32 s52, s52, s56
    s_xor_b32 s53, s53, 36864
    s_mul_i32 s32, s20, 9216
    s_add_u32 s33, s32, s53
    s_add_u32 s32, s32, s52
    s_mov_b32 m0, s33
    s_add_u32 s33, s33, 1024
    buffer_load_dwordx4 v1, s[8:11], s32 offen sc1 lds
    s_add_u32 s32, s32, 1024
    s_mov_b32 m0, s33
    s_add_u32 s33, s33, 1024
    buffer_load_dwordx4 v1, s[8:11], s32 offen sc1 lds
    s_add_u32 s32, s32, 1024
    s_mov_b32 m0, s33
    s_add_u32 s33, s33, 1024
    buffer_load_dwordx4 v1, s[8:11], s32 offen sc1 lds
    s_add_u32 s32, s32, 1024
    s_mov_b32 m0, s33
    s_add_u32 s33, s33, 1024
    buffer_load_dwordx4 v1, s[8:11], s32 offen sc1 lds
    s_add_u32 s32, s32, 1024
    s_mov_b32 m0, s33
    s_add_u32 s33, s33, 1024
    buffer_load_dwordx4 v1, s[8:11], s32 offen sc1 lds
    s_add_u32 s32, s32, 1024
    s_mov_b32 m0, s33
    s_add_u32 s33, s33, 1024
    buffer_load_dwordx4 v1, s[8:11], s32 offen sc1 lds
    s_add_u32 s32, s32, 1024
    s_mov_b32 m0, s33
    s_add_u32 s33, s33, 1024
    buffer_load_dwordx4 v1, s[8:11], s32 offen sc1 lds
    s_add_u32 s32, s32, 1024
    s_mov_b32 m0, s33
    s_add_u32 s33, s33, 1024
    buffer_load_dwordx4 v1, s[8:11], s32 offen sc1 lds
    s_add_u32 s32, s32, 1024
    s_mov_b32 m0, s33
    s_add_u32 s33, s33, 1024
    buffer_load_dwordx4 v1, s[8:11], s32 offen sc1 lds
    s_add_u32 s32, s32, 1024
    s_waitcnt vmcnt(0)
    s_branch Lff_73
Lff_80:
    s_waitcnt vmcnt(0)
    s_branch L_end
L_ffn2:
    s_barrier
    s_load_dwordx2 s[24:25], s[0:1], 64
    s_waitcnt lgkmcnt(0)
    s_mov_b32 s12, s24
    s_mov_b32 s13, s25
    s_mov_b32 s14, 5308416
    s_mov_b32 s15, 0x20000
    s_lshl_b32 s44, s21, 8
    v_and_b32 v1, 63, v0
    v_lshrrev_b32 v2, 4, v1
    v_and_b32 v3, 15, v1
    v_lshlrev_b32 v4, 2, v2
    v_xor_b32 v3, v3, v4
    v_lshlrev_b32 v3, 4, v3
    v_mul_u32_u24 v4, 9216, v2
    v_add_u32 v3, v3, v4
    s_mul_i32 s28, s20, 36
    s_lshl_b32 s29, s28, 10
    s_add_u32 s29, s29, 0
    s_mul_i32 s30, s28, 36864
    s_add_u32 s30, s30, s44
    s_mov_b32 s31, 0
Lwd_85:
    s_mov_b32 m0, s29
    s_add_u32 s29, s29, 1024
    buffer_load_dwordx4 v3, s[12:15], s30 offen nt lds
    s_add_u32 s30, s30, 36864
    s_add_u32 s31, s31, 1
    s_cmp_lt_u32 s31, 36
    s_cbranch_scc1 Lwd_85
    v_lshrrev_b32 v4, 4, v1
    v_lshrrev_b32 v5, 2, v1
    v_and_b32 v5, 3, v5
    v_and_b32 v6, 3, v1
    v_lshrrev_b32 v7, 1, v4
    v_and_b32 v8, 1, v4
    v_lshlrev_b32 v8, 1, v8
    v_lshrrev_b32 v9, 1, v6
    s_lshl_b32 s28, s20, 2
    v_add3_u32 v8, v8, v9, s28
    v_lshlrev_b32 v9, 2, v5
    v_xor_b32 v8, v8, v9
    v_lshlrev_b32 v8, 4, v8
    v_and_b32 v9, 1, v6
    v_lshlrev_b32 v9, 3, v9
    v_add_u32 v8, v8, v9
    v_lshlrev_b32 v9, 2, v7
    v_add_u32 v9, v9, v5
    v_lshlrev_b32 v9, 8, v9
    v_add_u32 v10, v8, v9
    v_add_u32 v10, 0, v10
    s_waitcnt vmcnt(0)
    s_barrier
    ds_read_b64_tr_b16 v[64:65], v10 offset:0
    ds_read_b64_tr_b16 v[66:67], v10 offset:2048
    ds_read_b64_tr_b16 v[68:69], v10 offset:4096
    ds_read_b64_tr_b16 v[70:71], v10 offset:6144
    ds_read_b64_tr_b16 v[72:73], v10 offset:8192
    ds_read_b64_tr_b16 v[74:75], v10 offset:10240
    ds_read_b64_tr_b16 v[76:77], v10 offset:12288
    ds_read_b64_tr_b16 v[78:79], v10 offset:14336
    s_waitcnt lgkmcnt(4)
    ds_read_b64_tr_b16 v[80:81], v10 offset:16384
    ds_read_b64_tr_b16 v[82:83], v10 offset:18432
    ds_read_b64_tr_b16 v[84:85], v10 offset:20480
    ds_read_b64_tr_b16 v[86:87], v10 offset:22528
    ds_read_b64_tr_b16 v[88:89], v10 offset:24576
    ds_read_b64_tr_b16 v[90:91], v10 offset:26624
    ds_read_b64_tr_b16 v[92:93], v10 offset:28672
    ds_read_b64_tr_b16 v[94:95], v10 offset:30720
    s_waitcnt lgkmcnt(4)
    v_add_u32 v10, 32768, v10
    ds_read_b64_tr_b16 v[96:97], v10 offset:0
    ds_read_b64_tr_b16 v[98:99], v10 offset:2048
    ds_read_b64_tr_b16 v[100:101], v10 offset:4096
    ds_read_b64_tr_b16 v[102:103], v10 offset:6144
    ds_read_b64_tr_b16 v[104:105], v10 offset:8192
    ds_read_b64_tr_b16 v[106:107], v10 offset:10240
    ds_read_b64_tr_b16 v[108:109], v10 offset:12288
    ds_read_b64_tr_b16 v[110:111], v10 offset:14336
    s_waitcnt lgkmcnt(4)
    ds_read_b64_tr_b16 v[112:113], v10 offset:16384
    ds_read_b64_tr_b16 v[114:115], v10 offset:18432
    ds_read_b64_tr_b16 v[116:117], v10 offset:20480
    ds_read_b64_tr_b16 v[118:119], v10 offset:22528
    ds_read_b64_tr_b16 v[120:121], v10 offset:24576
    ds_read_b64_tr_b16 v[122:123], v10 offset:26624
    ds_read_b64_tr_b16 v[124:125], v10 offset:28672
    ds_read_b64_tr_b16 v[126:127], v10 offset:30720
    s_waitcnt lgkmcnt(4)
    v_add_u32 v10, 32768, v10
    ds_read_b64_tr_b16 v[128:129], v10 offset:0
    ds_read_b64_tr_b16 v[130:131], v10 offset:2048
    ds_read_b64_tr_b16 v[132:133], v10 offset:4096
    ds_read_b64_tr_b16 v[134:135], v10 offset:6144
    ds_read_b64_tr_b16 v[136:137], v10 offset:8192
    ds_read_b64_tr_b16 v[138:139], v10 offset:10240
    ds_read_b64_tr_b16 v[140:141], v10 offset:12288
    ds_read_b64_tr_b16 v[142:143], v10 offset:14336
    s_waitcnt lgkmcnt(4)
    ds_read_b64_tr_b16 v[144:145], v10 offset:16384
    ds_read_b64_tr_b16 v[146:147], v10 offset:18432
    ds_read_b64_tr_b16 v[148:149], v10 offset:20480
    ds_read_b64_tr_b16 v[150:151], v10 offset:22528
    ds_read_b64_tr_b16 v[152:153], v10 offset:24576
    ds_read_b64_tr_b16 v[154:155], v10 offset:26624
    ds_read_b64_tr_b16 v[156:157], v10 offset:28672
    ds_read_b64_tr_b16 v[158:159], v10 offset:30720
    s_waitcnt lgkmcnt(4)
    v_add_u32 v10, 32768, v10
    ds_read_b64_tr_b16 v[160:161], v10 offset:0
    ds_read_b64_tr_b16 v[162:163], v10 offset:2048
    ds_read_b64_tr_b16 v[164:165], v10 offset:4096
    ds_read_b64_tr_b16 v[166:167], v10 offset:6144
    ds_read_b64_tr_b16 v[168:169], v10 offset:8192
    ds_read_b64_tr_b16 v[170:171], v10 offset:10240
    ds_read_b64_tr_b16 v[172:173], v10 offset:12288
    ds_read_b64_tr_b16 v[174:175], v10 offset:14336
    s_waitcnt lgkmcnt(4)
    ds_read_b64_tr_b16 v[176:177], v10 offset:16384
    ds_read_b64_tr_b16 v[178:179], v10 offset:18432
    ds_read_b64_tr_b16 v[180:181], v10 offset:20480
    ds_read_b64_tr_b16 v[182:183], v10 offset:22528
    ds_read_b64_tr_b16 v[184:185], v10 offset:24576
    ds_read_b64_tr_b16 v[186:187], v10 offset:26624
    ds_read_b64_tr_b16 v[188:189], v10 offset:28672
    ds_read_b64_tr_b16 v[190:191], v10 offset:30720
    s_waitcnt lgkmcnt(4)
    v_add_u32 v10, 32768, v10
    ds_read_b64_tr_b16 v[192:193], v10 offset:0
    ds_read_b64_tr_b16 v[194:195], v10 offset:2048
    ds_read_b64_tr_b16 v[196:197], v10 offset:4096
    ds_read_b64_tr_b16 v[198:199], v10 offset:6144
    ds_read_b64_tr_b16 v[200:201], v10 offset:8192
    ds_read_b64_tr_b16 v[202:203], v10 offset:10240
    ds_read_b64_tr_b16 v[204:205], v10 offset:12288
    ds_read_b64_tr_b16 v[206:207], v10 offset:14336
    s_waitcnt lgkmcnt(4)
    s_waitcnt lgkmcnt(0)
    s_barrier
    s_load_dwordx2 s[24:25], s[0:1], 72
    s_waitcnt lgkmcnt(0)
    s_mov_b32 s12, s24
    s_mov_b32 s13, s25
    s_mov_b32 s14, 5308416
    s_mov_b32 s15, 0x20000
    s_mul_i32 s44, s21, 147456
    v_and_b32 v1, 63, v0
    v_lshrrev_b32 v2, 2, v1
    v_and_b32 v3, 3, v1
    v_mul_u32_u24 v2, 1152, v2
    v_lshlrev_b32 v3, 4, v3
    v_add_u32 v3, v2, v3
    s_mov_b32 s28, s20
Lti_86:
    s_cmp_ge_u32 s28, 18
    s_cbranch_scc1 Lti_87
    s_mul_i32 s29, s28, 8192
    s_add_u32 s29, s29, 0
    s_mul_i32 s30, s28, 64
    s_add_u32 s30, s30, s44
    s_mov_b32 m0, s29
    s_add_u32 s29, s29, 1024
    s_add_u32 s31, s30, 0
    buffer_load_dwordx4 v3, s[12:15], s31 offen nt lds
    s_mov_b32 m0, s29
    s_add_u32 s29, s29, 1024
    s_add_u32 s31, s30, 18432
    buffer_load_dwordx4 v3, s[12:15], s31 offen nt lds
    s_mov_b32 m0, s29
    s_add_u32 s29, s29, 1024
    s_add_u32 s31, s30, 36864
    buffer_load_dwordx4 v3, s[12:15], s31 offen nt lds
    s_mov_b32 m0, s29
    s_add_u32 s29, s29, 1024
    s_add_u32 s31, s30, 55296
    buffer_load_dwordx4 v3, s[12:15], s31 offen nt lds
    s_mov_b32 m0, s29
    s_add_u32 s29, s29, 1024
    s_add_u32 s31, s30, 73728
    buffer_load_dwordx4 v3, s[12:15], s31 offen nt lds
    s_mov_b32 m0, s29
    s_add_u32 s29, s29, 1024
    s_add_u32 s31, s30, 92160
    buffer_load_dwordx4 v3, s[12:15], s31 offen nt lds
    s_mov_b32 m0, s29
    s_add_u32 s29, s29, 1024
    s_add_u32 s31, s30, 110592
    buffer_load_dwordx4 v3, s[12:15], s31 offen nt lds
    s_mov_b32 m0, s29
    s_add_u32 s29, s29, 1024
    s_add_u32 s31, s30, 129024
    buffer_load_dwordx4 v3, s[12:15], s31 offen nt lds
    s_add_u32 s28, s28, 4
    s_branch Lti_86
Lti_87:
    v_lshrrev_b32 v4, 4, v1
    v_lshrrev_b32 v5, 2, v1
    v_and_b32 v5, 3, v5
    v_and_b32 v6, 3, v1
    v_lshrrev_b32 v7, 1, v4
    v_lshlrev_b32 v7, 2, v7
    v_add_u32 v7, v7, v5
    v_lshlrev_b32 v7, 6, v7
    v_and_b32 v8, 1, v4
    v_lshlrev_b32 v8, 5, v8
    v_lshlrev_b32 v6, 3, v6
    v_add3_u32 v7, v7, v8, v6
    v_lshlrev_b32 v8, 4, v1
    s_waitcnt vmcnt(0)
    s_mov_b32 s28, s20
Lti_88:
    s_cmp_ge_u32 s28, 18
    s_cbranch_scc1 Lti_89
    s_mul_i32 s29, s28, 8192
    s_add_u32 s29, s29, 0
    v_add_u32 v9, s29, v7
    v_add_u32 v10, s29, v8
    ds_read_b64_tr_b16 v[16:17], v9 offset:0
    ds_read_b64_tr_b16 v[18:19], v9 offset:512
    ds_read_b64_tr_b16 v[20:21], v9 offset:1024
    ds_read_b64_tr_b16 v[22:23], v9 offset:1536
    ds_read_b64_tr_b16 v[24:25], v9 offset:2048
    ds_read_b64_tr_b16 v[26:27], v9 offset:2560
    ds_read_b64_tr_b16 v[28:29], v9 offset:3072
    ds_read_b64_tr_b16 v[30:31], v9 offset:3584
    ds_read_b64_tr_b16 v[32:33], v9 offset:4096
    ds_read_b64_tr_b16 v[34:35], v9 offset:4608
    ds_read_b64_tr_b16 v[36:37], v9 offset:5120
    ds_read_b64_tr_b16 v[38:39], v9 offset:5632
    ds_read_b64_tr_b16 v[40:41], v9 offset:6144
    ds_read_b64_tr_b16 v[42:43], v9 offset:6656
    ds_read_b64_tr_b16 v[44:45], v9 offset:7168
    ds_read_b64_tr_b16 v[46:47], v9 offset:7680
    s_waitcnt lgkmcnt(0)
    ds_write_b128 v10, v[16:19] offset:0
    ds_write_b128 v10, v[20:23] offset:1024
    ds_write_b128 v10, v[24:27] offset:2048
    ds_write_b128 v10, v[28:31] offset:3072
    ds_write_b128 v10, v[32:35] offset:4096
    ds_write_b128 v10, v[36:39] offset:5120
    ds_write_b128 v10, v[40:43] offset:6144
    ds_write_b128 v10, v[44:47] offset:7168
    s_waitcnt lgkmcnt(0)
    s_add_u32 s28, s28, 4
    s_branch Lti_88
Lti_89:
    s_barrier
    v_and_b32 v1, 63, v0
    v_lshlrev_b32 v1, 4, v1
    s_lshl_b32 s45, s20, 13
    v_add_u32 v2, s45, v1
    ds_read_b128 a[0:3], v2 offset:0
    ds_read_b128 a[4:7], v2 offset:1024
    ds_read_b128 a[8:11], v2 offset:2048
    ds_read_b128 a[12:15], v2 offset:3072
    ds_read_b128 a[16:19], v2 offset:4096
    ds_read_b128 a[20:23], v2 offset:5120
    ds_read_b128 a[24:27], v2 offset:6144
    ds_read_b128 a[28:31], v2 offset:7168
    s_waitcnt lgkmcnt(0)
    v_add_u32 v2, 32768, v2
    ds_read_b128 a[32:35], v2 offset:0
    ds_read_b128 a[36:39], v2 offset:1024
    ds_read_b128 a[40:43], v2 offset:2048
    ds_read_b128 a[44:47], v2 offset:3072
    ds_read_b128 a[48:51], v2 offset:4096
    ds_read_b128 a[52:55], v2 offset:5120
    ds_read_b128 a[56:59], v2 offset:6144
    ds_read_b128 a[60:63], v2 offset:7168
    s_waitcnt lgkmcnt(0)
    v_add_u32 v2, 32768, v2
    ds_read_b128 a[64:67], v2 offset:0
    ds_read_b128 a[68:71], v2 offset:1024
    ds_read_b128 a[72:75], v2 offset:2048
    ds_read_b128 a[76:79], v2 offset:3072
    ds_read_b128 a[80:83], v2 offset:4096
    ds_read_b128 a[84:87], v2 offset:5120
    ds_read_b128 a[88:91], v2 offset:6144
    ds_read_b128 a[92:95], v2 offset:7168
    s_waitcnt lgkmcnt(0)
    v_add_u32 v2, 32768, v2
    ds_read_b128 a[96:99], v2 offset:0
    ds_read_b128 a[100:103], v2 offset:1024
    ds_read_b128 a[104:107], v2 offset:2048
    ds_read_b128 a[108:111], v2 offset:3072
    ds_read_b128 a[112:115], v2 offset:4096
    ds_read_b128 a[116:119], v2 offset:5120
    ds_read_b128 a[120:123], v2 offset:6144
    ds_read_b128 a[124:127], v2 offset:7168
    s_waitcnt lgkmcnt(0)
    v_add_u32 v2, 32768, v2
    s_cmp_lt_u32 s20, 2
    s_cbranch_scc0 Lff_90
    ds_read_b128 a[128:131], v2 offset:0
    ds_read_b128 a[132:135], v2 offset:1024
    ds_read_b128 a[136:139], v2 offset:2048
    ds_read_b128 a[140:143], v2 offset:3072
    ds_read_b128 a[144:147], v2 offset:4096
    ds_read_b128 a[148:151], v2 offset:5120
    ds_read_b128 a[152:155], v2 offset:6144
    ds_read_b128 a[156:159], v2 offset:7168
    s_waitcnt lgkmcnt(0)
    v_add_u32 v2, 32768, v2
Lff_90:
    s_barrier
    v_and_b32 v3, 63, v0
    v_and_b32 v4, 31, v3
    v_lshrrev_b32 v5, 5, v3
    v_lshrrev_b32 v7, 2, v4
    v_mul_u32_u24 v7, 4608, v7
    v_lshlrev_b32 v8, 6, v5
    v_and_b32 v9, 3, v4
    v_lshlrev_b32 v9, 4, v9
    v_add3_u32 v7, v7, v8, v9
    v_add_u32 v8, 73728, v1
    s_lshl_b32 s45, s20, 11
    v_add_u32 v9, s45, v8
    s_mov_b64 exec, 1
    v_mov_b32 v250, 44
Lwi_91:
    buffer_load_dword v251, v250, s[16:19], 0 offen sc1
    s_waitcnt vmcnt(0)
    v_readfirstlane_b32 s38, v251
    s_cmp_lg_u32 s38, 0
    s_cbranch_scc1 Lwi_92
    s_add_u32 s23, s23, 1
    s_cmp_gt_u32 s23, 3000000
    s_cbranch_scc1 L_wfail
    s_sleep 1
    s_branch Lwi_91
Lwi_92:
    s_mov_b64 exec, -1
    s_mov_b32 s22, 33
    s_mov_b32 s51, 6107264
    s_mov_b32 s55, 0
    s_cmp_lg_u32 s20, 0
    s_cbranch_scc1 Lww_93
    s_mov_b32 exec_lo, 0xff
    s_mov_b32 exec_hi, 0x0
    v_mbcnt_lo_u32_b32 v250, -1, 0
    v_mbcnt_hi_u32_b32 v250, -1, v250
    v_lshlrev_b32 v250, 2, v250
Lwf_94:
    buffer_load_dword v251, v250, s[8:11], s51 offen sc1
    s_waitcnt vmcnt(0)
    v_cmp_eq_u32 vcc, 0, v251
    s_cbranch_vccz Lwf_95
    s_add_u32 s23, s23, 1
    s_cmp_gt_u32 s23, 3000000
    s_cbranch_scc1 L_wfail
    s_sleep 1
    s_branch Lwf_94
Lwf_95:
    s_mov_b64 exec, -1
Lww_93:
    s_barrier
    s_mov_b32 s52, 153260032
    s_mov_b32 s53, 0
    s_mul_i32 s32, s20, 9216
    s_add_u32 s33, s32, s53
    s_add_u32 s32, s32, s52
    s_mov_b32 m0, s33
    s_add_u32 s33, s33, 1024
    buffer_load_dwordx4 v1, s[8:11], s32 offen sc1 lds
    s_add_u32 s32, s32, 1024
    s_mov_b32 m0, s33
    s_add_u32 s33, s33, 1024
    buffer_load_dwordx4 v1, s[8:11], s32 offen sc1 lds
    s_add_u32 s32, s32, 1024
    s_mov_b32 m0, s33
    s_add_u32 s33, s33, 1024
    buffer_load_dwordx4 v1, s[8:11], s32 offen sc1 lds
    s_add_u32 s32, s32, 1024
    s_mov_b32 m0, s33
    s_add_u32 s33, s33, 1024
    buffer_load_dwordx4 v1, s[8:11], s32 offen sc1 lds
    s_add_u32 s32, s32, 1024
    s_mov_b32 m0, s33
    s_add_u32 s33, s33, 1024
    buffer_load_dwordx4 v1, s[8:11], s32 offen sc1 lds
    s_add_u32 s32, s32, 1024
    s_mov_b32 m0, s33
    s_add_u32 s33, s33, 1024
    buffer_load_dwordx4 v1, s[8:11], s32 offen sc1 lds
    s_add_u32 s32, s32, 1024
    s_mov_b32 m0, s33
    s_add_u32 s33, s33, 1024
    buffer_load_dwordx4 v1, s[8:11], s32 offen sc1 lds
    s_add_u32 s32, s32, 1024
    s_mov_b32 m0, s33
    s_add_u32 s33, s33, 1024
    buffer_load_dwordx4 v1, s[8:11], s32 offen sc1 lds
    s_add_u32 s32, s32, 1024
    s_mov_b32 m0, s33
    s_add_u32 s33, s33, 1024
    buffer_load_dwordx4 v1, s[8:11], s32 offen sc1 lds
    s_add_u32 s32, s32, 1024
    s_waitcnt vmcnt(0)
Lff_96:
    s_cmp_ge_u32 s22, 0
    s_cselect_b32 s59, 2, 1
    s_waitcnt vmcnt(8)
    s_barrier
    v_add_u32 v2, s53, v1
    ds_read_b128 v[32:35], v2 offset:0
    ds_read_b128 v[36:39], v2 offset:1024
    ds_read_b128 v[40:43], v2 offset:2048
    ds_read_b128 v[44:47], v2 offset:3072
    ds_read_b128 v[48:51], v2 offset:4096
    ds_read_b128 v[52:55], v2 offset:5120
    ds_read_b128 v[56:59], v2 offset:6144
    ds_read_b128 v[60:63], v2 offset:7168
    s_waitcnt lgkmcnt(7)
    v_mfma_f32_32x32x16_bf16 v[16:31], v[64:67], v[32:35], 0
    s_waitcnt lgkmcnt(6)
    v_mfma_f32_32x32x16_bf16 v[16:31], v[68:71], v[36:39], v[16:31]
    ds_read_b128 v[32:35], v2 offset:8192
    s_waitcnt lgkmcnt(6)
    v_mfma_f32_32x32x16_bf16 v[16:31], v[72:75], v[40:43], v[16:31]
    ds_read_b128 v[36:39], v2 offset:9216
    s_waitcnt lgkmcnt(6)
    v_mfma_f32_32x32x16_bf16 v[16:31], v[76:79], v[44:47], v[16:31]
    ds_read_b128 v[40:43], v2 offset:10240
    s_waitcnt lgkmcnt(6)
    v_mfma_f32_32x32x16_bf16 v[16:31], v[80:83], v[48:51], v[16:31]
    ds_read_b128 v[44:47], v2 offset:11264
    s_waitcnt lgkmcnt(6)
    v_mfma_f32_32x32x16_bf16 v[16:31], v[84:87], v[52:55], v[16:31]
    ds_read_b128 v[48:51], v2 offset:12288
    s_waitcnt lgkmcnt(6)
    v_mfma_f32_32x32x16_bf16 v[16:31], v[88:91], v[56:59], v[16:31]
    ds_read_b128 v[52:55], v2 offset:13312
    s_waitcnt lgkmcnt(6)
    v_mfma_f32_32x32x16_bf16 v[16:31], v[92:95], v[60:63], v[16:31]
    ds_read_b128 v[56:59], v2 offset:14336
    s_waitcnt lgkmcnt(6)
    v_mfma_f32_32x32x16_bf16 v[16:31], v[96:99], v[32:35], v[16:31]
    ds_read_b128 v[60:63], v2 offset:15360
    s_waitcnt lgkmcnt(6)
    v_mfma_f32_32x32x16_bf16 v[16:31], v[100:103], v[36:39], v[16:31]
    ds_read_b128 v[32:35], v2 offset:16384
    s_waitcnt lgkmcnt(6)
    v_mfma_f32_32x32x16_bf16 v[16:31], v[104:107], v[40:43], v[16:31]
    ds_read_b128 v[36:39], v2 offset:17408
    s_waitcnt lgkmcnt(6)
    v_mfma_f32_32x32x16_bf16 v[16:31], v[108:111], v[44:47], v[16:31]
    ds_read_b128 v[40:43], v2 offset:18432
    s_waitcnt lgkmcnt(6)
    v_mfma_f32_32x32x16_bf16 v[16:31], v[112:115], v[48:51], v[16:31]
    ds_read_b128 v[44:47], v2 offset:19456
    s_lshl_b32 s56, s59, 7
    s_add_u32 s56, s56, s51
    s_mov_b64 exec, 0xff
    v_lshrrev_b32 v13, 2, v1
    buffer_load_dword v11, v13, s[8:11], s56 offen sc1
    s_mov_b64 exec, -1
    s_waitcnt lgkmcnt(6)
    v_mfma_f32_32x32x16_bf16 v[16:31], v[116:119], v[52:55], v[16:31]
    ds_read_b128 v[48:51], v2 offset:20480
    s_waitcnt lgkmcnt(6)
    v_mfma_f32_32x32x16_bf16 v[16:31], v[120:123], v[56:59], v[16:31]
    ds_read_b128 v[52:55], v2 offset:21504
    s_waitcnt lgkmcnt(6)
    v_mfma_f32_32x32x16_bf16 v[16:31], v[124:127], v[60:63], v[16:31]
    ds_read_b128 v[56:59], v2 offset:22528
    s_waitcnt lgkmcnt(6)
    v_mfma_f32_32x32x16_bf16 v[16:31], v[128:131], v[32:35], v[16:31]
    ds_read_b128 v[60:63], v2 offset:23552
    s_waitcnt lgkmcnt(6)
    v_mfma_f32_32x32x16_bf16 v[16:31], v[132:135], v[36:39], v[16:31]
    ds_read_b128 v[32:35], v2 offset:24576
    s_waitcnt lgkmcnt(6)
    v_mfma_f32_32x32x16_bf16 v[16:31], v[136:139], v[40:43], v[16:31]
    ds_read_b128 v[36:39], v2 offset:25600
    s_waitcnt lgkmcnt(6)
    v_mfma_f32_32x32x16_bf16 v[16:31], v[140:143], v[44:47], v[16:31]
    ds_read_b128 v[40:43], v2 offset:26624
    s_waitcnt lgkmcnt(6)
    v_mfma_f32_32x32x16_bf16 v[16:31], v[144:147], v[48:51], v[16:31]
    ds_read_b128 v[44:47], v2 offset:27648
    s_waitcnt lgkmcnt(6)
    v_mfma_f32_32x32x16_bf16 v[16:31], v[148:151], v[52:55], v[16:31]
    ds_read_b128 v[48:51], v2 offset:28672
    s_waitcnt lgkmcnt(6)
    v_mfma_f32_32x32x16_bf16 v[16:31], v[152:155], v[56:59], v[16:31]
    ds_read_b128 v[52:55], v2 offset:29696
    s_waitcnt lgkmcnt(6)
    v_mfma_f32_32x32x16_bf16 v[16:31], v[156:159], v[60:63], v[16:31]
    ds_read_b128 v[56:59], v2 offset:30720
    s_waitcnt lgkmcnt(6)
    v_mfma_f32_32x32x16_bf16 v[16:31], v[160:163], v[32:35], v[16:31]
    ds_read_b128 v[60:63], v2 offset:31744
    s_waitcnt lgkmcnt(6)
    v_mfma_f32_32x32x16_bf16 v[16:31], v[164:167], v[36:39], v[16:31]
    ds_read_b128 v[32:35], v2 offset:32768
    s_waitcnt lgkmcnt(6)
    v_mfma_f32_32x32x16_bf16 v[16:31], v[168:171], v[40:43], v[16:31]
    ds_read_b128 v[36:39], v2 offset:33792
    s_waitcnt lgkmcnt(6)
    v_mfma_f32_32x32x16_bf16 v[16:31], v[172:175], v[44:47], v[16:31]
    ds_read_b128 v[40:43], v2 offset:34816
    s_waitcnt lgkmcnt(6)
    v_mfma_f32_32x32x16_bf16 v[16:31], v[176:179], v[48:51], v[16:31]
    ds_read_b128 v[44:47], v2 offset:35840
    s_waitcnt lgkmcnt(6)
    v_mfma_f32_32x32x16_bf16 v[16:31], v[180:183], v[52:55], v[16:31]
    s_waitcnt lgkmcnt(5)
    v_mfma_f32_32x32x16_bf16 v[16:31], v[184:187], v[56:59], v[16:31]
    s_waitcnt lgkmcnt(4)
    v_mfma_f32_32x32x16_bf16 v[16:31], v[188:191], v[60:63], v[16:31]
    s_waitcnt lgkmcnt(3)
    v_mfma_f32_32x32x16_bf16 v[16:31], v[192:195], v[32:35], v[16:31]
    s_waitcnt lgkmcnt(2)
    v_mfma_f32_32x32x16_bf16 v[16:31], v[196:199], v[36:39], v[16:31]
    s_waitcnt lgkmcnt(1)
    v_mfma_f32_32x32x16_bf16 v[16:31], v[200:203], v[40:43], v[16:31]
    s_waitcnt lgkmcnt(0)
    v_mfma_f32_32x32x16_bf16 v[16:31], v[204:207], v[44:47], v[16:31]
    s_nop 7
    s_nop 3
    v_max_f32 v16, 0, v16
    v_max_f32 v17, 0, v17
    v_max_f32 v18, 0, v18
    v_max_f32 v19, 0, v19
    v_max_f32 v20, 0, v20
    v_max_f32 v21, 0, v21
    v_max_f32 v22, 0, v22
    v_max_f32 v23, 0, v23
    v_max_f32 v24, 0, v24
    v_max_f32 v25, 0, v25
    v_max_f32 v26, 0, v26
    v_max_f32 v27, 0, v27
    v_max_f32 v28, 0, v28
    v_max_f32 v29, 0, v29
    v_max_f32 v30, 0, v30
    v_max_f32 v31, 0, v31
    v_cvt_pk_bf16_f32 v32, v16, v17
    v_cvt_pk_bf16_f32 v33, v18, v19
    v_cvt_pk_bf16_f32 v34, v20, v21
    v_cvt_pk_bf16_f32 v35, v22, v23
    v_cvt_pk_bf16_f32 v36, v24, v25
    v_cvt_pk_bf16_f32 v37, v26, v27
    v_cvt_pk_bf16_f32 v38, v28, v29
    v_cvt_pk_bf16_f32 v39, v30, v31
    ds_write_b128 v9, v[32:35]
    ds_write_b128 v9, v[36:39] offset:1024
    s_waitcnt vmcnt(0)
    s_cmp_lg_u32 s20, 0
    s_cbranch_scc1 Lff_97
    s_mov_b64 exec, 0xff
    v_cmp_eq_u32 vcc, 0, v11
    s_mov_b64 exec, -1
    s_cmp_eq_u64 vcc, 0
    s_cselect_b32 s25, 1, 0
    s_add_u32 s26, s22, s59
    s_cmp_lt_u32 s26, 64
    s_cselect_b32 s25, s25, 0
    v_mov_b32 v10, s25
    v_mov_b32 v12, 81920
    ds_write_b32 v12, v10
Lff_97:
    s_waitcnt lgkmcnt(0)
    s_barrier
    ds_read_b128 v[208:211], v8 offset:0
    ds_read_b128 v[212:215], v8 offset:1024
    ds_read_b128 v[216:219], v8 offset:2048
    ds_read_b128 v[220:223], v8 offset:3072
    ds_read_b128 v[224:227], v8 offset:4096
    ds_read_b128 v[228:231], v8 offset:5120
    ds_read_b128 v[232:235], v8 offset:6144
    ds_read_b128 v[236:239], v8 offset:7168
    v_mov_b32 v12, 81920
    ds_read_b32 v10, v12
    s_cmp_lg_u32 s20, 0
    s_cbranch_scc1 Lff_98
    s_cmp_eq_u32 s55, 0
    s_cbranch_scc1 Lff_98
    s_mov_b32 s36, s22
    s_sub_u32 s22, s55, 1
    s_mul_i32 s25, s22, 256
    s_add_u32 s25, s25, 6111232
    s_mul_i32 s37, s21, 4
    s_add_u32 s25, s25, s37
    s_mov_b64 exec, 1
    v_mov_b32 v250, 1
    buffer_store_dword v250, off, s[8:11], s25 sc1
    s_mov_b64 exec, -1
    s_mov_b32 s22, s36
Lff_98:
    s_mov_b32 s55, 0
    s_waitcnt lgkmcnt(0)
    v_readfirstlane_b32 s54, v10
    s_cmp_eq_u32 s54, 0
    s_cbranch_scc1 Lff_99
    s_mul_i32 s56, s59, 36864
    s_add_u32 s52, s52, s56
    s_xor_b32 s56, s53, 36864
    s_mul_i32 s32, s20, 9216
    s_add_u32 s33, s32, s56
    s_add_u32 s32, s32, s52
    s_mov_b32 m0, s33
    s_add_u32 s33, s33, 1024
    buffer_load_dwordx4 v1, s[8:11], s32 offen sc1 lds
    s_add_u32 s32, s32, 1024
    s_mov_b32 m0, s33
    s_add_u32 s33, s33, 1024
    buffer_load_dwordx4 v1, s[8:11], s32 offen sc1 lds
    s_add_u32 s32, s32, 1024
    s_mov_b32 m0, s33
    s_add_u32 s33, s33, 1024
    buffer_load_dwordx4 v1, s[8:11], s32 offen sc1 lds
    s_add_u32 s32, s32, 1024
    s_mov_b32 m0, s33
    s_add_u32 s33, s33, 1024
    buffer_load_dwordx4 v1, s[8:11], s32 offen sc1 lds
    s_add_u32 s32, s32, 1024
    s_mov_b32 m0, s33
    s_add_u32 s33, s33, 1024
    buffer_load_dwordx4 v1, s[8:11], s32 offen sc1 lds
    s_add_u32 s32, s32, 1024
    s_mov_b32 m0, s33
    s_add_u32 s33, s33, 1024
    buffer_load_dwordx4 v1, s[8:11], s32 offen sc1 lds
    s_add_u32 s32, s32, 1024
    s_mov_b32 m0, s33
    s_add_u32 s33, s33, 1024
    buffer_load_dwordx4 v1, s[8:11], s32 offen sc1 lds
    s_add_u32 s32, s32, 1024
    s_mov_b32 m0, s33
    s_add_u32 s33, s33, 1024
    buffer_load_dwordx4 v1, s[8:11], s32 offen sc1 lds
    s_add_u32 s32, s32, 1024
    s_mov_b32 m0, s33
    s_add_u32 s33, s33, 1024
    buffer_load_dwordx4 v1, s[8:11], s32 offen sc1 lds
    s_add_u32 s32, s32, 1024
Lff_99:
    s_mul_i32 s57, s22, 36
    s_add_u32 s57, s57, s21
    s_mul_i32 s57, s57, 36864
    s_add_u32 s57, s57, 155189248
    s_lshl_b32 s58, s20, 8
    s_add_u32 s57, s57, s58
    v_mfma_f32_32x32x16_bf16 v[16:31], a[0:3], v[208:211], 0
    v_mfma_f32_32x32x16_bf16 v[16:31], a[4:7], v[212:215], v[16:31]
    v_mfma_f32_32x32x16_bf16 v[16:31], a[8:11], v[216:219], v[16:31]
    v_mfma_f32_32x32x16_bf16 v[16:31], a[12:15], v[220:223], v[16:31]
    v_mfma_f32_32x32x16_bf16 v[16:31], a[16:19], v[224:227], v[16:31]
    v_mfma_f32_32x32x16_bf16 v[16:31], a[20:23], v[228:231], v[16:31]
    v_mfma_f32_32x32x16_bf16 v[16:31], a[24:27], v[232:235], v[16:31]
    v_mfma_f32_32x32x16_bf16 v[16:31], a[28:31], v[236:239], v[16:31]
    v_mfma_f32_32x32x16_bf16 v[240:255], a[32:35], v[208:211], 0
    v_mfma_f32_32x32x16_bf16 v[240:255], a[36:39], v[212:215], v[240:255]
    v_mfma_f32_32x32x16_bf16 v[240:255], a[40:43], v[216:219], v[240:255]
    v_mfma_f32_32x32x16_bf16 v[240:255], a[44:47], v[220:223], v[240:255]
    v_mfma_f32_32x32x16_bf16 v[240:255], a[48:51], v[224:227], v[240:255]
    v_mfma_f32_32x32x16_bf16 v[240:255], a[52:55], v[228:231], v[240:255]
    v_mfma_f32_32x32x16_bf16 v[240:255], a[56:59], v[232:235], v[240:255]
    v_mfma_f32_32x32x16_bf16 v[240:255], a[60:63], v[236:239], v[240:255]
    v_cvt_pk_bf16_f32 v40, v16, v17
    v_cvt_pk_bf16_f32 v41, v18, v19
    v_cvt_pk_bf16_f32 v42, v20, v21
    v_cvt_pk_bf16_f32 v43, v22, v23
    v_cvt_pk_bf16_f32 v44, v24, v25
    v_cvt_pk_bf16_f32 v45, v26, v27
    v_cvt_pk_bf16_f32 v46, v28, v29
    v_cvt_pk_bf16_f32 v47, v30, v31
    buffer_store_dwordx4 v[40:43], v7, s[8:11], s57 offen offset:0 sc1
    buffer_store_dwordx4 v[44:47], v7, s[8:11], s57 offen offset:128 sc1
    s_add_u32 s57, s57, 1024
    v_mfma_f32_32x32x16_bf16 v[16:31], a[64:67], v[208:211], 0
    v_mfma_f32_32x32x16_bf16 v[16:31], a[68:71], v[212:215], v[16:31]
    v_mfma_f32_32x32x16_bf16 v[16:31], a[72:75], v[216:219], v[16:31]
    v_mfma_f32_32x32x16_bf16 v[16:31], a[76:79], v[220:223], v[16:31]
    v_mfma_f32_32x32x16_bf16 v[16:31], a[80:83], v[224:227], v[16:31]
    v_mfma_f32_32x32x16_bf16 v[16:31], a[84:87], v[228:231], v[16:31]
    v_mfma_f32_32x32x16_bf16 v[16:31], a[88:91], v[232:235], v[16:31]
    v_mfma_f32_32x32x16_bf16 v[16:31], a[92:95], v[236:239], v[16:31]
    v_cvt_pk_bf16_f32 v48, v240, v241
    v_cvt_pk_bf16_f32 v49, v242, v243
    v_cvt_pk_bf16_f32 v50, v244, v245
    v_cvt_pk_bf16_f32 v51, v246, v247
    v_cvt_pk_bf16_f32 v52, v248, v249
    v_cvt_pk_bf16_f32 v53, v250, v251
    v_cvt_pk_bf16_f32 v54, v252, v253
    v_cvt_pk_bf16_f32 v55, v254, v255
    buffer_store_dwordx4 v[48:51], v7, s[8:11], s57 offen offset:0 sc1
    buffer_store_dwordx4 v[52:55], v7, s[8:11], s57 offen offset:128 sc1
    s_add_u32 s57, s57, 1024
    v_mfma_f32_32x32x16_bf16 v[240:255], a[96:99], v[208:211], 0
    v_mfma_f32_32x32x16_bf16 v[240:255], a[100:103], v[212:215], v[240:255]
    v_mfma_f32_32x32x16_bf16 v[240:255], a[104:107], v[216:219], v[240:255]
    v_mfma_f32_32x32x16_bf16 v[240:255], a[108:111], v[220:223], v[240:255]
    v_mfma_f32_32x32x16_bf16 v[240:255], a[112:115], v[224:227], v[240:255]
    v_mfma_f32_32x32x16_bf16 v[240:255], a[116:119], v[228:231], v[240:255]
    v_mfma_f32_32x32x16_bf16 v[240:255], a[120:123], v[232:235], v[240:255]
    v_mfma_f32_32x32x16_bf16 v[240:255], a[124:127], v[236:239], v[240:255]
    v_cvt_pk_bf16_f32 v40, v16, v17
    v_cvt_pk_bf16_f32 v41, v18, v19
    v_cvt_pk_bf16_f32 v42, v20, v21
    v_cvt_pk_bf16_f32 v43, v22, v23
    v_cvt_pk_bf16_f32 v44, v24, v25
    v_cvt_pk_bf16_f32 v45, v26, v27
    v_cvt_pk_bf16_f32 v46, v28, v29
    v_cvt_pk_bf16_f32 v47, v30, v31
    buffer_store_dwordx4 v[40:43], v7, s[8:11], s57 offen offset:0 sc1
    buffer_store_dwordx4 v[44:47], v7, s[8:11], s57 offen offset:128 sc1
    s_add_u32 s57, s57, 1024
    s_cmp_lt_u32 s20, 2
    s_cbranch_scc0 Lff_100
    v_mfma_f32_32x32x16_bf16 v[16:31], a[128:131], v[208:211], 0
    v_mfma_f32_32x32x16_bf16 v[16:31], a[132:135], v[212:215], v[16:31]
    v_mfma_f32_32x32x16_bf16 v[16:31], a[136:139], v[216:219], v[16:31]
    v_mfma_f32_32x32x16_bf16 v[16:31], a[140:143], v[220:223], v[16:31]
    v_mfma_f32_32x32x16_bf16 v[16:31], a[144:147], v[224:227], v[16:31]
    v_mfma_f32_32x32x16_bf16 v[16:31], a[148:151], v[228:231], v[16:31]
    v_mfma_f32_32x32x16_bf16 v[16:31], a[152:155], v[232:235], v[16:31]
    v_mfma_f32_32x32x16_bf16 v[16:31], a[156:159], v[236:239], v[16:31]
    v_cvt_pk_bf16_f32 v48, v240, v241
    v_cvt_pk_bf16_f32 v49, v242, v243
    v_cvt_pk_bf16_f32 v50, v244, v245
    v_cvt_pk_bf16_f32 v51, v246, v247
    v_cvt_pk_bf16_f32 v52, v248, v249
    v_cvt_pk_bf16_f32 v53, v250, v251
    v_cvt_pk_bf16_f32 v54, v252, v253
    v_cvt_pk_bf16_f32 v55, v254, v255
    buffer_store_dwordx4 v[48:51], v7, s[8:11], s57 offen offset:0 sc1
    buffer_store_dwordx4 v[52:55], v7, s[8:11], s57 offen offset:128 sc1
    s_add_u32 s57, s57, 1024
    s_nop 7
    s_nop 3
    v_cvt_pk_bf16_f32 v40, v16, v17
    v_cvt_pk_bf16_f32 v41, v18, v19
    v_cvt_pk_bf16_f32 v42, v20, v21
    v_cvt_pk_bf16_f32 v43, v22, v23
    v_cvt_pk_bf16_f32 v44, v24, v25
    v_cvt_pk_bf16_f32 v45, v26, v27
    v_cvt_pk_bf16_f32 v46, v28, v29
    v_cvt_pk_bf16_f32 v47, v30, v31
    buffer_store_dwordx4 v[40:43], v7, s[8:11], s57 offen offset:0 sc1
    buffer_store_dwordx4 v[44:47], v7, s[8:11], s57 offen offset:128 sc1
    s_add_u32 s57, s57, 1024
    s_branch Lff_101
Lff_100:
    s_nop 7
    s_nop 3
    v_cvt_pk_bf16_f32 v48, v240, v241
    v_cvt_pk_bf16_f32 v49, v242, v243
    v_cvt_pk_bf16_f32 v50, v244, v245
    v_cvt_pk_bf16_f32 v51, v246, v247
    v_cvt_pk_bf16_f32 v52, v248, v249
    v_cvt_pk_bf16_f32 v53, v250, v251
    v_cvt_pk_bf16_f32 v54, v252, v253
    v_cvt_pk_bf16_f32 v55, v254, v255
    buffer_store_dwordx4 v[48:51], v7, s[8:11], s57 offen offset:0 sc1
    buffer_store_dwordx4 v[52:55], v7, s[8:11], s57 offen offset:128 sc1
    s_add_u32 s57, s57, 1024
Lff_101:
    s_cmp_eq_u32 s54, 0
    s_cbranch_scc1 Lff_102
    s_add_u32 s55, s22, 1
    s_add_u32 s22, s22, s59
    s_lshl_b32 s56, s59, 7
    s_add_u32 s51, s51, s56
    s_xor_b32 s53, s53, 36864
    s_branch Lff_96
Lff_102:
    s_waitcnt vmcnt(0)
    s_barrier
    s_cmp_lg_u32 s20, 0
    s_cbranch_scc1 Lff_104
    s_mul_i32 s25, s22, 256
    s_add_u32 s25, s25, 6111232
    s_mul_i32 s37, s21, 4
    s_add_u32 s25, s25, s37
    s_mov_b64 exec, 1
    v_mov_b32 v250, 1
    buffer_store_dword v250, off, s[8:11], s25 sc1
    s_mov_b64 exec, -1
Lff_104:
    s_add_u32 s22, s22, s59
    s_cmp_lt_u32 s22, 64
    s_cbranch_scc0 Lff_103
    s_lshl_b32 s56, s59, 7
    s_add_u32 s51, s51, s56
    s_cmp_lg_u32 s20, 0
    s_cbranch_scc1 Lww_105
    s_mov_b32 exec_lo, 0xff
    s_mov_b32 exec_hi, 0x0
    v_mbcnt_lo_u32_b32 v250, -1, 0
    v_mbcnt_hi_u32_b32 v250, -1, v250
    v_lshlrev_b32 v250, 2, v250
Lwf_106:
    buffer_load_dword v251, v250, s[8:11], s51 offen sc1
    s_waitcnt vmcnt(0)
    v_cmp_eq_u32 vcc, 0, v251
    s_cbranch_vccz Lwf_107
    s_add_u32 s23, s23, 1
    s_cmp_gt_u32 s23, 3000000
    s_cbranch_scc1 L_wfail
    s_sleep 1
    s_branch Lwf_106
Lwf_107:
    s_mov_b64 exec, -1
Lww_105:
    s_barrier
    s_mul_i32 s56, s59, 36864
    s_add_u32 s52, s52, s56
    s_xor_b32 s53, s53, 36864
    s_mul_i32 s32, s20, 9216
    s_add_u32 s33, s32, s53
    s_add_u32 s32, s32, s52
    s_mov_b32 m0, s33
    s_add_u32 s33, s33, 1024
    buffer_load_dwordx4 v1, s[8:11], s32 offen sc1 lds
    s_add_u32 s32, s32, 1024
    s_mov_b32 m0, s33
    s_add_u32 s33, s33, 1024
    buffer_load_dwordx4 v1, s[8:11], s32 offen sc1 lds
    s_add_u32 s32, s32, 1024
    s_mov_b32 m0, s33
    s_add_u32 s33, s33, 1024
    buffer_load_dwordx4 v1, s[8:11], s32 offen sc1 lds
    s_add_u32 s32, s32, 1024
    s_mov_b32 m0, s33
    s_add_u32 s33, s33, 1024
    buffer_load_dwordx4 v1, s[8:11], s32 offen sc1 lds
    s_add_u32 s32, s32, 1024
    s_mov_b32 m0, s33
    s_add_u32 s33, s33, 1024
    buffer_load_dwordx4 v1, s[8:11], s32 offen sc1 lds
    s_add_u32 s32, s32, 1024
    s_mov_b32 m0, s33
    s_add_u32 s33, s33, 1024
    buffer_load_dwordx4 v1, s[8:11], s32 offen sc1 lds
    s_add_u32 s32, s32, 1024
    s_mov_b32 m0, s33
    s_add_u32 s33, s33, 1024
    buffer_load_dwordx4 v1, s[8:11], s32 offen sc1 lds
    s_add_u32 s32, s32, 1024
    s_mov_b32 m0, s33
    s_add_u32 s33, s33, 1024
    buffer_load_dwordx4 v1, s[8:11], s32 offen sc1 lds
    s_add_u32 s32, s32, 1024
    s_mov_b32 m0, s33
    s_add_u32 s33, s33, 1024
    buffer_load_dwordx4 v1, s[8:11], s32 offen sc1 lds
    s_add_u32 s32, s32, 1024
    s_waitcnt vmcnt(0)
    s_branch Lff_96
Lff_103:
    s_waitcnt vmcnt(0)
    s_branch L_end
L_b0:
    s_sub_u32 s21, s21, 164
    s_and_b32 s44, s21, 7
    s_lshr_b32 s45, s21, 3
    v_and_b32 v1, 63, v0
    v_and_b32 v2, 15, v1
    v_lshrrev_b32 v3, 4, v1
    v_mul_u32_u24 v4, 36864, v3
    v_lshlrev_b32 v5, 4, v2
    s_mul_i32 s46, s44, 4608
    v_add3_u32 v4, v4, v5, s46
    v_add_u32 v6, s46, v5
    v_lshrrev_b32 v7, 1, v2
    v_and_b32 v8, 1, v2
    v_mov_b32 v9, 0x3f80
    v_mov_b32 v10, 0x3f800000
    v_cmp_eq_u32 vcc, 1, v8
    s_nop 1
    v_cndmask_b32 v9, v9, v10, vcc
    v_cmp_eq_u32 vcc, 0, v7
    s_nop 1
    v_cndmask_b32 v16, 0, v9, vcc
    v_cmp_eq_u32 vcc, 1, v7
    s_nop 1
    v_cndmask_b32 v17, 0, v9, vcc
    v_cmp_eq_u32 vcc, 2, v7
    s_nop 1
    v_cndmask_b32 v18, 0, v9, vcc
    v_cmp_eq_u32 vcc, 3, v7
    s_nop 1
    v_cndmask_b32 v19, 0, v9, vcc
    v_and_b32 v7, 3, v2
    v_bfe_u32 v8, v2, 2, 1
    v_lshrrev_b32 v9, 3, v2
    v_lshlrev_b32 v10, 3, v3
    v_add_u32 v11, v6, v10
    v_lshlrev_b32 v12, 10, v9
    v_lshlrev_b32 v13, 9, v8
    v_add3_u32 v12, v12, v13, v10
    v_lshlrev_b32 v13, 4, v7
    s_lshl_b32 s47, s44, 6
    v_add3_u32 v12, v12, v13, s47
    s_lshl_b32 s47, s44, 2
    v_add_u32 v13, s47, v7
    v_mul_u32_u24 v13, 1152, v13
    v_lshlrev_b32 v14, 5, v9
    v_lshlrev_b32 v15, 4, v3
    v_add3_u32 v13, v13, v14, v15
    v_lshlrev_b32 v14, 3, v8
    v_add_u32 v13, v13, v14
    s_mov_b64 exec, 1
    v_mov_b32 v250, 44
Lwi_108:
    buffer_load_dword v251, v250, s[16:19], 0 offen sc1
    s_waitcnt vmcnt(0)
    v_readfirstlane_b32 s38, v251
    s_cmp_lg_u32 s38, 0
    s_cbranch_scc1 Lwi_109
    s_add_u32 s23, s23, 1
    s_cmp_gt_u32 s23, 3000000
    s_cbranch_scc1 L_wfail
    s_sleep 1
    s_branch Lwi_108
Lwi_109:
    s_mov_b64 exec, -1
    s_mov_b32 s22, s45
Lrd_110:
    s_cmp_ge_u32 s22, 64
    s_cbranch_scc1 Lrd_111
    s_cmp_lg_u32 s20, 0
    s_cbranch_scc1 Lrd_112
    s_mul_i32 s48, s22, 64
    s_add_u32 s48, s48, 6127616
    s_mov_b32 exec_lo, 0x1
    s_mov_b32 exec_hi, 0x0
    v_mbcnt_lo_u32_b32 v250, -1, 0
    v_mbcnt_hi_u32_b32 v250, -1, v250
    v_lshlrev_b32 v250, 2, v250
Lwf_113:
    buffer_load_dword v251, v250, s[8:11], s48 offen sc1
    s_waitcnt vmcnt(0)
    v_cmp_eq_u32 vcc, 0, v251
    s_cbranch_vccz Lwf_114
    s_add_u32 s23, s23, 1
    s_cmp_gt_u32 s23, 3000000
    s_cbranch_scc1 L_wfail
    s_sleep 2
    s_branch Lwf_113
Lwf_114:
    s_mov_b64 exec, -1
    s_mul_i32 s48, s22, 128
    s_add_u32 s48, s48, 6094848
    s_mov_b32 exec_lo, 0xffffffff
    s_mov_b32 exec_hi, 0x0
    v_mbcnt_lo_u32_b32 v250, -1, 0
    v_mbcnt_hi_u32_b32 v250, -1, v250
    v_lshlrev_b32 v250, 2, v250
Lwf_115:
    buffer_load_dword v251, v250, s[8:11], s48 offen sc1
    s_waitcnt vmcnt(0)
    v_cmp_eq_u32 vcc, 0, v251
    s_cbranch_vccz Lwf_116
    s_add_u32 s23, s23, 1
    s_cmp_gt_u32 s23, 3000000
    s_cbranch_scc1 L_wfail
    s_sleep 1
    s_branch Lwf_115
Lwf_116:
    s_mov_b64 exec, -1
Lrd_112:
    s_barrier
    s_mul_i32 s49, s22, 1179648
    s_add_u32 s49, s49, 73400320
    s_mul_i32 s50, s22, 36864
    s_add_u32 s51, s50, 3670016
    s_lshl_b32 s52, s20, 8
    s_add_u32 s49, s49, s52
    s_add_u32 s51, s51, s52
    v_mov_b32 v48, 0
    v_mov_b32 v49, 0
    v_mov_b32 v50, 0
    v_mov_b32 v51, 0
    s_mov_b64 exec, 0xffff
    s_add_u32 s53, s51, 0
    buffer_load_dwordx4 v[48:51], v6, s[8:11], s53 offen sc1
    s_mov_b64 exec, -1
    s_add_u32 s53, s49, 0
    buffer_load_dwordx4 v[52:55], v4, s[8:11], s53 offen sc1
    s_add_u32 s53, s53, 147456
    buffer_load_dwordx4 v[56:59], v4, s[8:11], s53 offen sc1
    s_add_u32 s53, s53, 147456
    buffer_load_dwordx4 v[60:63], v4, s[8:11], s53 offen sc1
    s_add_u32 s53, s53, 147456
    buffer_load_dwordx4 v[64:67], v4, s[8:11], s53 offen sc1
    s_add_u32 s53, s53, 147456
    buffer_load_dwordx4 v[68:71], v4, s[8:11], s53 offen sc1
    s_add_u32 s53, s53, 147456
    buffer_load_dwordx4 v[72:75], v4, s[8:11], s53 offen sc1
    s_add_u32 s53, s53, 147456
    buffer_load_dwordx4 v[76:79], v4, s[8:11], s53 offen sc1
    s_add_u32 s53, s53, 147456
    buffer_load_dwordx4 v[80:83], v4, s[8:11], s53 offen sc1
    v_mov_b32 v92, 0
    v_mov_b32 v93, 0
    v_mov_b32 v94, 0
    v_mov_b32 v95, 0
    s_mov_b64 exec, 0xffff
    s_add_u32 s53, s51, 1024
    buffer_load_dwordx4 v[92:95], v6, s[8:11], s53 offen sc1
    s_mov_b64 exec, -1
    s_add_u32 s53, s49, 1024
    buffer_load_dwordx4 v[96:99], v4, s[8:11], s53 offen sc1
    s_add_u32 s53, s53, 147456
    buffer_load_dwordx4 v[100:103], v4, s[8:11], s53 offen sc1
    s_add_u32 s53, s53, 147456
    buffer_load_dwordx4 v[104:107], v4, s[8:11], s53 offen sc1
    s_add_u32 s53, s53, 147456
    buffer_load_dwordx4 v[108:111], v4, s[8:11], s53 offen sc1
    s_add_u32 s53, s53, 147456
    buffer_load_dwordx4 v[112:115], v4, s[8:11], s53 offen sc1
    s_add_u32 s53, s53, 147456
    buffer_load_dwordx4 v[116:119], v4, s[8:11], s53 offen sc1
    s_add_u32 s53, s53, 147456
    buffer_load_dwordx4 v[120:123], v4, s[8:11], s53 offen sc1
    s_add_u32 s53, s53, 147456
    buffer_load_dwordx4 v[124:127], v4, s[8:11], s53 offen sc1
    s_waitcnt vmcnt(17)
    v_mfma_f32_16x16x32_bf16 v[24:27], v[16:19], v[48:51], 0
    s_waitcnt vmcnt(16)
    v_mfma_f32_16x16x32_bf16 v[24:27], v[16:19], v[52:55], v[24:27]
    s_waitcnt vmcnt(15)
    v_mfma_f32_16x16x32_bf16 v[24:27], v[16:19], v[56:59], v[24:27]
    s_waitcnt vmcnt(14)
    v_mfma_f32_16x16x32_bf16 v[24:27], v[16:19], v[60:63], v[24:27]
    s_waitcnt vmcnt(13)
    v_mfma_f32_16x16x32_bf16 v[24:27], v[16:19], v[64:67], v[24:27]
    s_waitcnt vmcnt(12)
    v_mfma_f32_16x16x32_bf16 v[24:27], v[16:19], v[68:71], v[24:27]
    s_waitcnt vmcnt(11)
    v_mfma_f32_16x16x32_bf16 v[24:27], v[16:19], v[72:75], v[24:27]
    s_waitcnt vmcnt(10)
    v_mfma_f32_16x16x32_bf16 v[24:27], v[16:19], v[76:79], v[24:27]
    s_waitcnt vmcnt(9)
    v_mfma_f32_16x16x32_bf16 v[24:27], v[16:19], v[80:83], v[24:27]
    v_mov_b32 v48, 0
    v_mov_b32 v49, 0
    v_mov_b32 v50, 0
    v_mov_b32 v51, 0
    s_mov_b64 exec, 0xffff
    s_add_u32 s53, s51, 2048
    buffer_load_dwordx4 v[48:51], v6, s[8:11], s53 offen sc1
    s_mov_b64 exec, -1
    s_add_u32 s53, s49, 2048
    buffer_load_dwordx4 v[52:55], v4, s[8:11], s53 offen sc1
    s_add_u32 s53, s53, 147456
    buffer_load_dwordx4 v[56:59], v4, s[8:11], s53 offen sc1
    s_add_u32 s53, s53, 147456
    buffer_load_dwordx4 v[60:63], v4, s[8:11], s53 offen sc1
    s_add_u32 s53, s53, 147456
    buffer_load_dwordx4 v[64:67], v4, s[8:11], s53 offen sc1
    s_add_u32 s53, s53, 147456
    buffer_load_dwordx4 v[68:71], v4, s[8:11], s53 offen sc1
    s_add_u32 s53, s53, 147456
    buffer_load_dwordx4 v[72:75], v4, s[8:11], s53 offen sc1
    s_add_u32 s53, s53, 147456
    buffer_load_dwordx4 v[76:79], v4, s[8:11], s53 offen sc1
    s_add_u32 s53, s53, 147456
    buffer_load_dwordx4 v[80:83], v4, s[8:11], s53 offen sc1
    s_waitcnt vmcnt(17)
    v_mfma_f32_16x16x32_bf16 v[28:31], v[16:19], v[92:95], 0
    s_waitcnt vmcnt(16)
    v_mfma_f32_16x16x32_bf16 v[28:31], v[16:19], v[96:99], v[28:31]
    s_waitcnt vmcnt(15)
    v_mfma_f32_16x16x32_bf16 v[28:31], v[16:19], v[100:103], v[28:31]
    s_waitcnt vmcnt(14)
    v_mfma_f32_16x16x32_bf16 v[28:31], v[16:19], v[104:107], v[28:31]
    s_waitcnt vmcnt(13)
    v_mfma_f32_16x16x32_bf16 v[28:31], v[16:19], v[108:111], v[28:31]
    s_waitcnt vmcnt(12)
    v_mfma_f32_16x16x32_bf16 v[28:31], v[16:19], v[112:115], v[28:31]
    s_waitcnt vmcnt(11)
    v_mfma_f32_16x16x32_bf16 v[28:31], v[16:19], v[116:119], v[28:31]
    s_waitcnt vmcnt(10)
    v_mfma_f32_16x16x32_bf16 v[28:31], v[16:19], v[120:123], v[28:31]
    s_waitcnt vmcnt(9)
    v_mfma_f32_16x16x32_bf16 v[28:31], v[16:19], v[124:127], v[28:31]
    v_mov_b32 v92, 0
    v_mov_b32 v93, 0
    v_mov_b32 v94, 0
    v_mov_b32 v95, 0
    s_mov_b64 exec, 0xffff
    s_add_u32 s53, s51, 3072
    buffer_load_dwordx4 v[92:95], v6, s[8:11], s53 offen sc1
    s_mov_b64 exec, -1
    s_add_u32 s53, s49, 3072
    buffer_load_dwordx4 v[96:99], v4, s[8:11], s53 offen sc1
    s_add_u32 s53, s53, 147456
    buffer_load_dwordx4 v[100:103], v4, s[8:11], s53 offen sc1
    s_add_u32 s53, s53, 147456
    buffer_load_dwordx4 v[104:107], v4, s[8:11], s53 offen sc1
    s_add_u32 s53, s53, 147456
    buffer_load_dwordx4 v[108:111], v4, s[8:11], s53 offen sc1
    s_add_u32 s53, s53, 147456
    buffer_load_dwordx4 v[112:115], v4, s[8:11], s53 offen sc1
    s_add_u32 s53, s53, 147456
    buffer_load_dwordx4 v[116:119], v4, s[8:11], s53 offen sc1
    s_add_u32 s53, s53, 147456
    buffer_load_dwordx4 v[120:123], v4, s[8:11], s53 offen sc1
    s_add_u32 s53, s53, 147456
    buffer_load_dwordx4 v[124:127], v4, s[8:11], s53 offen sc1
    s_waitcnt vmcnt(17)
    v_mfma_f32_16x16x32_bf16 v[32:35], v[16:19], v[48:51], 0
    s_waitcnt vmcnt(16)
    v_mfma_f32_16x16x32_bf16 v[32:35], v[16:19], v[52:55], v[32:35]
    s_waitcnt vmcnt(15)
    v_mfma_f32_16x16x32_bf16 v[32:35], v[16:19], v[56:59], v[32:35]
    s_waitcnt vmcnt(14)
    v_mfma_f32_16x16x32_bf16 v[32:35], v[16:19], v[60:63], v[32:35]
    s_waitcnt vmcnt(13)
    v_mfma_f32_16x16x32_bf16 v[32:35], v[16:19], v[64:67], v[32:35]
    s_waitcnt vmcnt(12)
    v_mfma_f32_16x16x32_bf16 v[32:35], v[16:19], v[68:71], v[32:35]
    s_waitcnt vmcnt(11)
    v_mfma_f32_16x16x32_bf16 v[32:35], v[16:19], v[72:75], v[32:35]
    s_waitcnt vmcnt(10)
    v_mfma_f32_16x16x32_bf16 v[32:35], v[16:19], v[76:79], v[32:35]
    s_waitcnt vmcnt(9)
    v_mfma_f32_16x16x32_bf16 v[32:35], v[16:19], v[80:83], v[32:35]
    s_cmp_lt_u32 s20, 2
    s_cbranch_scc0 Lrd_117
    v_mov_b32 v48, 0
    v_mov_b32 v49, 0
    v_mov_b32 v50, 0
    v_mov_b32 v51, 0
    s_mov_b64 exec, 0xffff
    s_add_u32 s53, s51, 4096
    buffer_load_dwordx4 v[48:51], v6, s[8:11], s53 offen sc1
    s_mov_b64 exec, -1
    s_add_u32 s53, s49, 4096
    buffer_load_dwordx4 v[52:55], v4, s[8:11], s53 offen sc1
    s_add_u32 s53, s53, 147456
    buffer_load_dwordx4 v[56:59], v4, s[8:11], s53 offen sc1
    s_add_u32 s53, s53, 147456
    buffer_load_dwordx4 v[60:63], v4, s[8:11], s53 offen sc1
    s_add_u32 s53, s53, 147456
    buffer_load_dwordx4 v[64:67], v4, s[8:11], s53 offen sc1
    s_add_u32 s53, s53, 147456
    buffer_load_dwordx4 v[68:71], v4, s[8:11], s53 offen sc1
    s_add_u32 s53, s53, 147456
    buffer_load_dwordx4 v[72:75], v4, s[8:11], s53 offen sc1
    s_add_u32 s53, s53, 147456
    buffer_load_dwordx4 v[76:79], v4, s[8:11], s53 offen sc1
    s_add_u32 s53, s53, 147456
    buffer_load_dwordx4 v[80:83], v4, s[8:11], s53 offen sc1
    s_waitcnt vmcnt(17)
    v_mfma_f32_16x16x32_bf16 v[36:39], v[16:19], v[92:95], 0
    s_waitcnt vmcnt(16)
    v_mfma_f32_16x16x32_bf16 v[36:39], v[16:19], v[96:99], v[36:39]
    s_waitcnt vmcnt(15)
    v_mfma_f32_16x16x32_bf16 v[36:39], v[16:19], v[100:103], v[36:39]
    s_waitcnt vmcnt(14)
    v_mfma_f32_16x16x32_bf16 v[36:39], v[16:19], v[104:107], v[36:39]
    s_waitcnt vmcnt(13)
    v_mfma_f32_16x16x32_bf16 v[36:39], v[16:19], v[108:111], v[36:39]
    s_waitcnt vmcnt(12)
    v_mfma_f32_16x16x32_bf16 v[36:39], v[16:19], v[112:115], v[36:39]
    s_waitcnt vmcnt(11)
    v_mfma_f32_16x16x32_bf16 v[36:39], v[16:19], v[116:119], v[36:39]
    s_waitcnt vmcnt(10)
    v_mfma_f32_16x16x32_bf16 v[36:39], v[16:19], v[120:123], v[36:39]
    s_waitcnt vmcnt(9)
    v_mfma_f32_16x16x32_bf16 v[36:39], v[16:19], v[124:127], v[36:39]
    s_waitcnt vmcnt(8)
    v_mfma_f32_16x16x32_bf16 v[40:43], v[16:19], v[48:51], 0
    s_waitcnt vmcnt(7)
    v_mfma_f32_16x16x32_bf16 v[40:43], v[16:19], v[52:55], v[40:43]
    s_waitcnt vmcnt(6)
    v_mfma_f32_16x16x32_bf16 v[40:43], v[16:19], v[56:59], v[40:43]
    s_waitcnt vmcnt(5)
    v_mfma_f32_16x16x32_bf16 v[40:43], v[16:19], v[60:63], v[40:43]
    s_waitcnt vmcnt(4)
    v_mfma_f32_16x16x32_bf16 v[40:43], v[16:19], v[64:67], v[40:43]
    s_waitcnt vmcnt(3)
    v_mfma_f32_16x16x32_bf16 v[40:43], v[16:19], v[68:71], v[40:43]
    s_waitcnt vmcnt(2)
    v_mfma_f32_16x16x32_bf16 v[40:43], v[16:19], v[72:75], v[40:43]
    s_waitcnt vmcnt(1)
    v_mfma_f32_16x16x32_bf16 v[40:43], v[16:19], v[76:79], v[40:43]
    s_waitcnt vmcnt(0)
    v_mfma_f32_16x16x32_bf16 v[40:43], v[16:19], v[80:83], v[40:43]
    s_branch Lrd_118
Lrd_117:
    s_waitcnt vmcnt(8)
    v_mfma_f32_16x16x32_bf16 v[36:39], v[16:19], v[92:95], 0
    s_waitcnt vmcnt(7)
    v_mfma_f32_16x16x32_bf16 v[36:39], v[16:19], v[96:99], v[36:39]
    s_waitcnt vmcnt(6)
    v_mfma_f32_16x16x32_bf16 v[36:39], v[16:19], v[100:103], v[36:39]
    s_waitcnt vmcnt(5)
    v_mfma_f32_16x16x32_bf16 v[36:39], v[16:19], v[104:107], v[36:39]
    s_waitcnt vmcnt(4)
    v_mfma_f32_16x16x32_bf16 v[36:39], v[16:19], v[108:111], v[36:39]
    s_waitcnt vmcnt(3)
    v_mfma_f32_16x16x32_bf16 v[36:39], v[16:19], v[112:115], v[36:39]
    s_waitcnt vmcnt(2)
    v_mfma_f32_16x16x32_bf16 v[36:39], v[16:19], v[116:119], v[36:39]
    s_waitcnt vmcnt(1)
    v_mfma_f32_16x16x32_bf16 v[36:39], v[16:19], v[120:123], v[36:39]
    s_waitcnt vmcnt(0)
    v_mfma_f32_16x16x32_bf16 v[36:39], v[16:19], v[124:127], v[36:39]
    v_mov_b32 v40, 0
    v_mov_b32 v41, 0
    v_mov_b32 v42, 0
    v_mov_b32 v43, 0
Lrd_118:
    s_nop 7
    v_cvt_pk_bf16_f32 v48, v24, v25
    v_cvt_pk_bf16_f32 v49, v26, v27
    v_cvt_pk_bf16_f32 v50, v28, v29
    v_cvt_pk_bf16_f32 v51, v30, v31
    v_cvt_pk_bf16_f32 v52, v32, v33
    v_cvt_pk_bf16_f32 v53, v34, v35
    v_cvt_pk_bf16_f32 v54, v36, v37
    v_cvt_pk_bf16_f32 v55, v38, v39
    v_cvt_pk_bf16_f32 v56, v40, v41
    v_cvt_pk_bf16_f32 v57, v42, v43
    s_add_u32 s54, s50, 148897792
    s_add_u32 s54, s54, s52
    s_mov_b32 exec_hi, 0
    buffer_store_dwordx2 v[48:49], v11, s[8:11], s54 offen offset:0 sc1
    buffer_store_dwordx2 v[50:51], v11, s[8:11], s54 offen offset:1024 sc1
    buffer_store_dwordx2 v[52:53], v11, s[8:11], s54 offen offset:2048 sc1
    buffer_store_dwordx2 v[54:55], v11, s[8:11], s54 offen offset:3072 sc1
    s_cmp_lt_u32 s20, 2
    s_cbranch_scc0 Lrd_119
    s_add_u32 s55, s54, 4096
    buffer_store_dwordx2 v[56:57], v11, s[8:11], s55 offen sc1
Lrd_119:
    s_mov_b64 exec, -1
    v_lshlrev_b32 v24, 16, v48
    v_and_b32 v25, 0xffff0000, v48
    v_lshlrev_b32 v26, 16, v49
    v_and_b32 v27, 0xffff0000, v49
    v_lshlrev_b32 v28, 16, v50
    v_and_b32 v29, 0xffff0000, v50
    v_lshlrev_b32 v30, 16, v51
    v_and_b32 v31, 0xffff0000, v51
    v_lshlrev_b32 v32, 16, v52
    v_and_b32 v33, 0xffff0000, v52
    v_lshlrev_b32 v34, 16, v53
    v_and_b32 v35, 0xffff0000, v53
    v_lshlrev_b32 v36, 16, v54
    v_and_b32 v37, 0xffff0000, v54
    v_lshlrev_b32 v38, 16, v55
    v_and_b32 v39, 0xffff0000, v55
    v_lshlrev_b32 v40, 16, v56
    v_and_b32 v41, 0xffff0000, v56
    v_lshlrev_b32 v42, 16, v57
    v_and_b32 v43, 0xffff0000, v57
    v_and_b32 v20, 3, v1
    v_lshlrev_b32 v20, 2, v20
    s_lshl_b32 s55, s20, 4
    v_add_u32 v21, s55, v20
    v_add_f32 v22, v24, v25
    v_add_f32 v22, v22, v26
    v_add_f32 v22, v22, v27
    v_add_f32 v22, v22, v28
    v_add_f32 v22, v22, v29
    v_add_f32 v22, v22, v30
    v_add_f32 v22, v22, v31
    v_add_f32 v22, v22, v32
    v_add_f32 v22, v22, v33
    v_add_f32 v22, v22, v34
    v_add_f32 v22, v22, v35
    v_add_f32 v22, v22, v36
    v_add_f32 v22, v22, v37
    v_add_f32 v22, v22, v38
    v_add_f32 v22, v22, v39
    v_add_f32 v22, v22, v40
    v_add_f32 v22, v22, v41
    v_add_f32 v22, v22, v42
    v_add_f32 v22, v22, v43
    s_nop 1
    v_add_f32_dpp v22, v22, v22 row_ror:4 row_mask:0xf bank_mask:0xf
    s_nop 1
    v_add_f32_dpp v22, v22, v22 row_ror:8 row_mask:0xf bank_mask:0xf
    v_mov_b32 v23, v22
    s_nop 1
    v_permlane16_swap_b32 v22, v23
    v_add_f32 v22, v22, v23
    s_mov_b64 exec, 0xf
    ds_write_b32 v21, v22
    s_mov_b64 exec, -1
    s_waitcnt lgkmcnt(0)
    s_barrier
    ds_read_b32 v44, v20 offset:0
    ds_read_b32 v45, v20 offset:16
    ds_read_b32 v46, v20 offset:32
    ds_read_b32 v47, v20 offset:48
    s_waitcnt lgkmcnt(0)
    v_add_f32 v44, v44, v45
    v_add_f32 v46, v46, v47
    v_add_f32 v44, v44, v46
    v_mul_f32 v44, 0x3ae38e39, v44
    v_mov_b32 v22, 0
    v_sub_f32 v23, v24, v44
    v_fmac_f32 v22, v23, v23
    v_sub_f32 v23, v25, v44
    v_fmac_f32 v22, v23, v23
    v_sub_f32 v23, v26, v44
    v_fmac_f32 v22, v23, v23
    v_sub_f32 v23, v27, v44
    v_fmac_f32 v22, v23, v23
    v_sub_f32 v23, v28, v44
    v_fmac_f32 v22, v23, v23
    v_sub_f32 v23, v29, v44
    v_fmac_f32 v22, v23, v23
    v_sub_f32 v23, v30, v44
    v_fmac_f32 v22, v23, v23
    v_sub_f32 v23, v31, v44
    v_fmac_f32 v22, v23, v23
    v_sub_f32 v23, v32, v44
    v_fmac_f32 v22, v23, v23
    v_sub_f32 v23, v33, v44
    v_fmac_f32 v22, v23, v23
    v_sub_f32 v23, v34, v44
    v_fmac_f32 v22, v23, v23
    v_sub_f32 v23, v35, v44
    v_fmac_f32 v22, v23, v23
    v_sub_f32 v23, v36, v44
    v_fmac_f32 v22, v23, v23
    v_sub_f32 v23, v37, v44
    v_fmac_f32 v22, v23, v23
    v_sub_f32 v23, v38, v44
    v_fmac_f32 v22, v23, v23
    v_sub_f32 v23, v39, v44
    v_fmac_f32 v22, v23, v23
    s_cmp_lt_u32 s20, 2
    s_cbranch_scc0 Lrd_120
    v_sub_f32 v23, v40, v44
    v_fmac_f32 v22, v23, v23
    v_sub_f32 v23, v41, v44
    v_fmac_f32 v22, v23, v23
    v_sub_f32 v23, v42, v44
    v_fmac_f32 v22, v23, v23
    v_sub_f32 v23, v43, v44
    v_fmac_f32 v22, v23, v23
Lrd_120:
    s_nop 1
    v_add_f32_dpp v22, v22, v22 row_ror:4 row_mask:0xf bank_mask:0xf
    s_nop 1
    v_add_f32_dpp v22, v22, v22 row_ror:8 row_mask:0xf bank_mask:0xf
    v_mov_b32 v23, v22
    s_nop 1
    v_permlane16_swap_b32 v22, v23
    v_add_f32 v22, v22, v23
    s_mov_b64 exec, 0xf
    ds_write_b32 v21, v22 offset:64
    s_mov_b64 exec, -1
    s_waitcnt lgkmcnt(0)
    s_barrier
    ds_read_b32 v45, v20 offset:64
    ds_read_b32 v46, v20 offset:80
    ds_read_b32 v47, v20 offset:96
    ds_read_b32 v48, v20 offset:112
    s_waitcnt lgkmcnt(0)
    v_add_f32 v45, v45, v46
    v_add_f32 v47, v47, v48
    v_add_f32 v45, v45, v47
    v_mul_f32 v45, 0x3ae38e39, v45
    v_cvt_pk_bf16_f32 v46, v45, v45
    v_lshlrev_b32 v45, 16, v46
    v_add_f32 v45, 0x3727c5ac, v45
    v_cvt_pk_bf16_f32 v46, v45, v45
    v_lshlrev_b32 v45, 16, v46
    v_sqrt_f32 v45, v45
    s_nop 0
    v_cvt_pk_bf16_f32 v46, v45, v45
    v_lshlrev_b32 v45, 16, v46
    v_rcp_f32 v45, v45
    v_cvt_pk_bf16_f32 v46, v44, v44
    v_lshlrev_b32 v44, 16, v46
    v_sub_f32 v46, v24, v44
    v_sub_f32 v47, v25, v44
    v_cvt_pk_bf16_f32 v46, v46, v47
    v_and_b32 v47, 0xffff0000, v46
    v_lshlrev_b32 v46, 16, v46
    v_mul_f32 v46, v46, v45
    v_mul_f32 v47, v47, v45
    v_cvt_pk_bf16_f32 v64, v46, v47
    v_sub_f32 v46, v26, v44
    v_sub_f32 v47, v27, v44
    v_cvt_pk_bf16_f32 v46, v46, v47
    v_and_b32 v47, 0xffff0000, v46
    v_lshlrev_b32 v46, 16, v46
    v_mul_f32 v46, v46, v45
    v_mul_f32 v47, v47, v45
    v_cvt_pk_bf16_f32 v65, v46, v47
    v_sub_f32 v46, v28, v44
    v_sub_f32 v47, v29, v44
    v_cvt_pk_bf16_f32 v46, v46, v47
    v_and_b32 v47, 0xffff0000, v46
    v_lshlrev_b32 v46, 16, v46
    v_mul_f32 v46, v46, v45
    v_mul_f32 v47, v47, v45
    v_cvt_pk_bf16_f32 v66, v46, v47
    v_sub_f32 v46, v30, v44
    v_sub_f32 v47, v31, v44
    v_cvt_pk_bf16_f32 v46, v46, v47
    v_and_b32 v47, 0xffff0000, v46
    v_lshlrev_b32 v46, 16, v46
    v_mul_f32 v46, v46, v45
    v_mul_f32 v47, v47, v45
    v_cvt_pk_bf16_f32 v67, v46, v47
    v_sub_f32 v46, v32, v44
    v_sub_f32 v47, v33, v44
    v_cvt_pk_bf16_f32 v46, v46, v47
    v_and_b32 v47, 0xffff0000, v46
    v_lshlrev_b32 v46, 16, v46
    v_mul_f32 v46, v46, v45
    v_mul_f32 v47, v47, v45
    v_cvt_pk_bf16_f32 v68, v46, v47
    v_sub_f32 v46, v34, v44
    v_sub_f32 v47, v35, v44
    v_cvt_pk_bf16_f32 v46, v46, v47
    v_and_b32 v47, 0xffff0000, v46
    v_lshlrev_b32 v46, 16, v46
    v_mul_f32 v46, v46, v45
    v_mul_f32 v47, v47, v45
    v_cvt_pk_bf16_f32 v69, v46, v47
    v_sub_f32 v46, v36, v44
    v_sub_f32 v47, v37, v44
    v_cvt_pk_bf16_f32 v46, v46, v47
    v_and_b32 v47, 0xffff0000, v46
    v_lshlrev_b32 v46, 16, v46
    v_mul_f32 v46, v46, v45
    v_mul_f32 v47, v47, v45
    v_cvt_pk_bf16_f32 v70, v46, v47
    v_sub_f32 v46, v38, v44
    v_sub_f32 v47, v39, v44
    v_cvt_pk_bf16_f32 v46, v46, v47
    v_and_b32 v47, 0xffff0000, v46
    v_lshlrev_b32 v46, 16, v46
    v_mul_f32 v46, v46, v45
    v_mul_f32 v47, v47, v45
    v_cvt_pk_bf16_f32 v71, v46, v47
    v_sub_f32 v46, v40, v44
    v_sub_f32 v47, v41, v44
    v_cvt_pk_bf16_f32 v46, v46, v47
    v_and_b32 v47, 0xffff0000, v46
    v_lshlrev_b32 v46, 16, v46
    v_mul_f32 v46, v46, v45
    v_mul_f32 v47, v47, v45
    v_cvt_pk_bf16_f32 v72, v46, v47
    v_sub_f32 v46, v42, v44
    v_sub_f32 v47, v43, v44
    v_cvt_pk_bf16_f32 v46, v46, v47
    v_and_b32 v47, 0xffff0000, v46
    v_lshlrev_b32 v46, 16, v46
    v_mul_f32 v46, v46, v45
    v_mul_f32 v47, v47, v45
    v_cvt_pk_bf16_f32 v73, v46, v47
    s_add_u32 s54, s50, 152043520
    s_lshl_b32 s55, s20, 11
    s_add_u32 s54, s54, s55
    s_mov_b32 exec_hi, 0
    buffer_store_dwordx2 v[64:65], v12, s[8:11], s54 offen sc1
    s_add_u32 s54, s54, 8192
    buffer_store_dwordx2 v[66:67], v12, s[8:11], s54 offen sc1
    s_add_u32 s54, s54, 8192
    buffer_store_dwordx2 v[68:69], v12, s[8:11], s54 offen sc1
    s_add_u32 s54, s54, 8192
    buffer_store_dwordx2 v[70:71], v12, s[8:11], s54 offen sc1
    s_add_u32 s54, s54, 8192
    s_cmp_lt_u32 s20, 2
    s_cbranch_scc0 Lrd_121
    buffer_store_dwordx2 v[72:73], v12, s[8:11], s54 offen sc1
Lrd_121:
    s_mov_b64 exec, -1
    s_waitcnt vmcnt(0)
    s_barrier
    s_cmp_lg_u32 s20, 0
    s_cbranch_scc1 Lrd_122
    s_mul_i32 s48, s22, 128
    s_add_u32 s48, s48, 6103040
    s_mul_i32 s37, s44, 4
    s_add_u32 s48, s48, s37
    s_mov_b64 exec, 1
    v_mov_b32 v250, 1
    buffer_store_dword v250, off, s[8:11], s48 sc1
    s_mov_b64 exec, -1
Lrd_122:
    s_add_u32 s22, s22, 4
    s_branch Lrd_110
Lrd_111:
    s_waitcnt vmcnt(0)
    s_branch L_end
L_gamma:
    s_sub_u32 s21, s21, 196
    s_load_dwordx2 s[24:25], s[0:1], 80
    s_waitcnt lgkmcnt(0)
    s_mov_b32 s40, s24
    s_mov_b32 s41, s25
    s_mov_b32 s42, 2359296
    s_mov_b32 s43, 0x20000
    s_and_b32 s44, s21, 7
    s_lshr_b32 s45, s21, 3
    v_and_b32 v1, 63, v0
    v_and_b32 v2, 15, v1
    v_lshrrev_b32 v3, 4, v1
    v_mul_u32_u24 v4, 36864, v3
    v_lshlrev_b32 v5, 4, v2
    s_mul_i32 s46, s44, 4608
    v_add3_u32 v4, v4, v5, s46
    v_add_u32 v6, s46, v5
    v_lshrrev_b32 v7, 1, v2
    v_and_b32 v8, 1, v2
    v_mov_b32 v9, 0x3f80
    v_mov_b32 v10, 0x3f800000
    v_cmp_eq_u32 vcc, 1, v8
    s_nop 1
    v_cndmask_b32 v9, v9, v10, vcc
    v_cmp_eq_u32 vcc, 0, v7
    s_nop 1
    v_cndmask_b32 v16, 0, v9, vcc
    v_cmp_eq_u32 vcc, 1, v7
    s_nop 1
    v_cndmask_b32 v17, 0, v9, vcc
    v_cmp_eq_u32 vcc, 2, v7
    s_nop 1
    v_cndmask_b32 v18, 0, v9, vcc
    v_cmp_eq_u32 vcc, 3, v7
    s_nop 1
    v_cndmask_b32 v19, 0, v9, vcc
    v_and_b32 v7, 3, v2
    v_bfe_u32 v8, v2, 2, 1
    v_lshrrev_b32 v9, 3, v2
    v_lshlrev_b32 v10, 3, v3
    v_add_u32 v11, v6, v10
    v_lshlrev_b32 v12, 10, v9
    v_lshlrev_b32 v13, 9, v8
    v_add3_u32 v12, v12, v13, v10
    v_lshlrev_b32 v13, 4, v7
    s_lshl_b32 s47, s44, 6
    v_add3_u32 v12, v12, v13, s47
    s_lshl_b32 s47, s44, 2
    v_add_u32 v13, s47, v7
    v_mul_u32_u24 v13, 1152, v13
    v_lshlrev_b32 v14, 5, v9
    v_lshlrev_b32 v15, 4, v3
    v_add3_u32 v13, v13, v14, v15
    v_lshlrev_b32 v14, 3, v8
    v_add_u32 v13, v13, v14
    s_mov_b64 exec, 1
    v_mov_b32 v250, 44
Lwi_123:
    buffer_load_dword v251, v250, s[16:19], 0 offen sc1
    s_waitcnt vmcnt(0)
    v_readfirstlane_b32 s38, v251
    s_cmp_lg_u32 s38, 0
    s_cbranch_scc1 Lwi_124
    s_add_u32 s23, s23, 1
    s_cmp_gt_u32 s23, 3000000
    s_cbranch_scc1 L_wfail
    s_sleep 1
    s_branch Lwi_123
Lwi_124:
    s_mov_b64 exec, -1
    s_mov_b32 s22, s45
Lrd_125:
    s_cmp_ge_u32 s22, 64
    s_cbranch_scc1 Lrd_126
    s_cmp_lg_u32 s20, 0
    s_cbranch_scc1 Lrd_127
    s_mul_i32 s48, s22, 128
    s_add_u32 s48, s48, 6103040
    s_mov_b32 exec_lo, 0xff
    s_mov_b32 exec_hi, 0x0
    v_mbcnt_lo_u32_b32 v250, -1, 0
    v_mbcnt_hi_u32_b32 v250, -1, v250
    v_lshlrev_b32 v250, 2, v250
Lwf_128:
    buffer_load_dword v251, v250, s[8:11], s48 offen sc1
    s_waitcnt vmcnt(0)
    v_cmp_eq_u32 vcc, 0, v251
    s_cbranch_vccz Lwf_129
    s_add_u32 s23, s23, 1
    s_cmp_gt_u32 s23, 3000000
    s_cbranch_scc1 L_wfail
    s_sleep 2
    s_branch Lwf_128
Lwf_129:
    s_mov_b64 exec, -1
    s_mul_i32 s48, s22, 256
    s_add_u32 s48, s48, 6111232
    s_mov_b32 exec_lo, 0xffffffff
    s_mov_b32 exec_hi, 0xf
    v_mbcnt_lo_u32_b32 v250, -1, 0
    v_mbcnt_hi_u32_b32 v250, -1, v250
    v_lshlrev_b32 v250, 2, v250
Lwf_130:
    buffer_load_dword v251, v250, s[8:11], s48 offen sc1
    s_waitcnt vmcnt(0)
    v_cmp_eq_u32 vcc, 0, v251
    s_cbranch_vccz Lwf_131
    s_add_u32 s23, s23, 1
    s_cmp_gt_u32 s23, 3000000
    s_cbranch_scc1 L_wfail
    s_sleep 1
    s_branch Lwf_130
Lwf_131:
    s_mov_b64 exec, -1
Lrd_127:
    s_barrier
    s_mul_i32 s49, s22, 1327104
    s_add_u32 s49, s49, 155189248
    s_mul_i32 s50, s22, 36864
    s_add_u32 s51, s50, 148897792
    s_lshl_b32 s52, s20, 8
    s_add_u32 s49, s49, s52
    s_add_u32 s51, s51, s52
    v_mov_b32 v48, 0
    v_mov_b32 v49, 0
    v_mov_b32 v50, 0
    v_mov_b32 v51, 0
    s_mov_b64 exec, 0xffff
    s_add_u32 s53, s51, 0
    buffer_load_dwordx4 v[48:51], v6, s[8:11], s53 offen sc1
    s_mov_b64 exec, -1
    s_add_u32 s53, s49, 0
    buffer_load_dwordx4 v[52:55], v4, s[8:11], s53 offen sc1
    s_add_u32 s53, s53, 147456
    buffer_load_dwordx4 v[56:59], v4, s[8:11], s53 offen sc1
    s_add_u32 s53, s53, 147456
    buffer_load_dwordx4 v[60:63], v4, s[8:11], s53 offen sc1
    s_add_u32 s53, s53, 147456
    buffer_load_dwordx4 v[64:67], v4, s[8:11], s53 offen sc1
    s_add_u32 s53, s53, 147456
    buffer_load_dwordx4 v[68:71], v4, s[8:11], s53 offen sc1
    s_add_u32 s53, s53, 147456
    buffer_load_dwordx4 v[72:75], v4, s[8:11], s53 offen sc1
    s_add_u32 s53, s53, 147456
    buffer_load_dwordx4 v[76:79], v4, s[8:11], s53 offen sc1
    s_add_u32 s53, s53, 147456
    buffer_load_dwordx4 v[80:83], v4, s[8:11], s53 offen sc1
    s_add_u32 s53, s53, 147456
    buffer_load_dwordx4 v[84:87], v4, s[8:11], s53 offen sc1
    v_mov_b32 v92, 0
    v_mov_b32 v93, 0
    v_mov_b32 v94, 0
    v_mov_b32 v95, 0
    s_mov_b64 exec, 0xffff
    s_add_u32 s53, s51, 1024
    buffer_load_dwordx4 v[92:95], v6, s[8:11], s53 offen sc1
    s_mov_b64 exec, -1
    s_add_u32 s53, s49, 1024
    buffer_load_dwordx4 v[96:99], v4, s[8:11], s53 offen sc1
    s_add_u32 s53, s53, 147456
    buffer_load_dwordx4 v[100:103], v4, s[8:11], s53 offen sc1
    s_add_u32 s53, s53, 147456
    buffer_load_dwordx4 v[104:107], v4, s[8:11], s53 offen sc1
    s_add_u32 s53, s53, 147456
    buffer_load_dwordx4 v[108:111], v4, s[8:11], s53 offen sc1
    s_add_u32 s53, s53, 147456
    buffer_load_dwordx4 v[112:115], v4, s[8:11], s53 offen sc1
    s_add_u32 s53, s53, 147456
    buffer_load_dwordx4 v[116:119], v4, s[8:11], s53 offen sc1
    s_add_u32 s53, s53, 147456
    buffer_load_dwordx4 v[120:123], v4, s[8:11], s53 offen sc1
    s_add_u32 s53, s53, 147456
    buffer_load_dwordx4 v[124:127], v4, s[8:11], s53 offen sc1
    s_add_u32 s53, s53, 147456
    buffer_load_dwordx4 v[128:131], v4, s[8:11], s53 offen sc1
    s_waitcnt vmcnt(19)
    v_mfma_f32_16x16x32_bf16 v[24:27], v[16:19], v[48:51], 0
    s_waitcnt vmcnt(18)
    v_mfma_f32_16x16x32_bf16 v[24:27], v[16:19], v[52:55], v[24:27]
    s_waitcnt vmcnt(17)
    v_mfma_f32_16x16x32_bf16 v[24:27], v[16:19], v[56:59], v[24:27]
    s_waitcnt vmcnt(16)
    v_mfma_f32_16x16x32_bf16 v[24:27], v[16:19], v[60:63], v[24:27]
    s_waitcnt vmcnt(15)
    v_mfma_f32_16x16x32_bf16 v[24:27], v[16:19], v[64:67], v[24:27]
    s_waitcnt vmcnt(14)
    v_mfma_f32_16x16x32_bf16 v[24:27], v[16:19], v[68:71], v[24:27]
    s_waitcnt vmcnt(13)
    v_mfma_f32_16x16x32_bf16 v[24:27], v[16:19], v[72:75], v[24:27]
    s_waitcnt vmcnt(12)
    v_mfma_f32_16x16x32_bf16 v[24:27], v[16:19], v[76:79], v[24:27]
    s_waitcnt vmcnt(11)
    v_mfma_f32_16x16x32_bf16 v[24:27], v[16:19], v[80:83], v[24:27]
    s_waitcnt vmcnt(10)
    v_mfma_f32_16x16x32_bf16 v[24:27], v[16:19], v[84:87], v[24:27]
    v_mov_b32 v48, 0
    v_mov_b32 v49, 0
    v_mov_b32 v50, 0
    v_mov_b32 v51, 0
    s_mov_b64 exec, 0xffff
    s_add_u32 s53, s51, 2048
    buffer_load_dwordx4 v[48:51], v6, s[8:11], s53 offen sc1
    s_mov_b64 exec, -1
    s_add_u32 s53, s49, 2048
    buffer_load_dwordx4 v[52:55], v4, s[8:11], s53 offen sc1
    s_add_u32 s53, s53, 147456
    buffer_load_dwordx4 v[56:59], v4, s[8:11], s53 offen sc1
    s_add_u32 s53, s53, 147456
    buffer_load_dwordx4 v[60:63], v4, s[8:11], s53 offen sc1
    s_add_u32 s53, s53, 147456
    buffer_load_dwordx4 v[64:67], v4, s[8:11], s53 offen sc1
    s_add_u32 s53, s53, 147456
    buffer_load_dwordx4 v[68:71], v4, s[8:11], s53 offen sc1
    s_add_u32 s53, s53, 147456
    buffer_load_dwordx4 v[72:75], v4, s[8:11], s53 offen sc1
    s_add_u32 s53, s53, 147456
    buffer_load_dwordx4 v[76:79], v4, s[8:11], s53 offen sc1
    s_add_u32 s53, s53, 147456
    buffer_load_dwordx4 v[80:83], v4, s[8:11], s53 offen sc1
    s_add_u32 s53, s53, 147456
    buffer_load_dwordx4 v[84:87], v4, s[8:11], s53 offen sc1
    s_waitcnt vmcnt(19)
    v_mfma_f32_16x16x32_bf16 v[28:31], v[16:19], v[92:95], 0
    s_waitcnt vmcnt(18)
    v_mfma_f32_16x16x32_bf16 v[28:31], v[16:19], v[96:99], v[28:31]
    s_waitcnt vmcnt(17)
    v_mfma_f32_16x16x32_bf16 v[28:31], v[16:19], v[100:103], v[28:31]
    s_waitcnt vmcnt(16)
    v_mfma_f32_16x16x32_bf16 v[28:31], v[16:19], v[104:107], v[28:31]
    s_waitcnt vmcnt(15)
    v_mfma_f32_16x16x32_bf16 v[28:31], v[16:19], v[108:111], v[28:31]
    s_waitcnt vmcnt(14)
    v_mfma_f32_16x16x32_bf16 v[28:31], v[16:19], v[112:115], v[28:31]
    s_waitcnt vmcnt(13)
    v_mfma_f32_16x16x32_bf16 v[28:31], v[16:19], v[116:119], v[28:31]
    s_waitcnt vmcnt(12)
    v_mfma_f32_16x16x32_bf16 v[28:31], v[16:19], v[120:123], v[28:31]
    s_waitcnt vmcnt(11)
    v_mfma_f32_16x16x32_bf16 v[28:31], v[16:19], v[124:127], v[28:31]
    s_waitcnt vmcnt(10)
    v_mfma_f32_16x16x32_bf16 v[28:31], v[16:19], v[128:131], v[28:31]
    v_mov_b32 v92, 0
    v_mov_b32 v93, 0
    v_mov_b32 v94, 0
    v_mov_b32 v95, 0
    s_mov_b64 exec, 0xffff
    s_add_u32 s53, s51, 3072
    buffer_load_dwordx4 v[92:95], v6, s[8:11], s53 offen sc1
    s_mov_b64 exec, -1
    s_add_u32 s53, s49, 3072
    buffer_load_dwordx4 v[96:99], v4, s[8:11], s53 offen sc1
    s_add_u32 s53, s53, 147456
    buffer_load_dwordx4 v[100:103], v4, s[8:11], s53 offen sc1
    s_add_u32 s53, s53, 147456
    buffer_load_dwordx4 v[104:107], v4, s[8:11], s53 offen sc1
    s_add_u32 s53, s53, 147456
    buffer_load_dwordx4 v[108:111], v4, s[8:11], s53 offen sc1
    s_add_u32 s53, s53, 147456
    buffer_load_dwordx4 v[112:115], v4, s[8:11], s53 offen sc1
    s_add_u32 s53, s53, 147456
    buffer_load_dwordx4 v[116:119], v4, s[8:11], s53 offen sc1
    s_add_u32 s53, s53, 147456
    buffer_load_dwordx4 v[120:123], v4, s[8:11], s53 offen sc1
    s_add_u32 s53, s53, 147456
    buffer_load_dwordx4 v[124:127], v4, s[8:11], s53 offen sc1
    s_add_u32 s53, s53, 147456
    buffer_load_dwordx4 v[128:131], v4, s[8:11], s53 offen sc1
    s_waitcnt vmcnt(19)
    v_mfma_f32_16x16x32_bf16 v[32:35], v[16:19], v[48:51], 0
    s_waitcnt vmcnt(18)
    v_mfma_f32_16x16x32_bf16 v[32:35], v[16:19], v[52:55], v[32:35]
    s_waitcnt vmcnt(17)
    v_mfma_f32_16x16x32_bf16 v[32:35], v[16:19], v[56:59], v[32:35]
    s_waitcnt vmcnt(16)
    v_mfma_f32_16x16x32_bf16 v[32:35], v[16:19], v[60:63], v[32:35]
    s_waitcnt vmcnt(15)
    v_mfma_f32_16x16x32_bf16 v[32:35], v[16:19], v[64:67], v[32:35]
    s_waitcnt vmcnt(14)
    v_mfma_f32_16x16x32_bf16 v[32:35], v[16:19], v[68:71], v[32:35]
    s_waitcnt vmcnt(13)
    v_mfma_f32_16x16x32_bf16 v[32:35], v[16:19], v[72:75], v[32:35]
    s_waitcnt vmcnt(12)
    v_mfma_f32_16x16x32_bf16 v[32:35], v[16:19], v[76:79], v[32:35]
    s_waitcnt vmcnt(11)
    v_mfma_f32_16x16x32_bf16 v[32:35], v[16:19], v[80:83], v[32:35]
    s_waitcnt vmcnt(10)
    v_mfma_f32_16x16x32_bf16 v[32:35], v[16:19], v[84:87], v[32:35]
    s_cmp_lt_u32 s20, 2
    s_cbranch_scc0 Lrd_132
    v_mov_b32 v48, 0
    v_mov_b32 v49, 0
    v_mov_b32 v50, 0
    v_mov_b32 v51, 0
    s_mov_b64 exec, 0xffff
    s_add_u32 s53, s51, 4096
    buffer_load_dwordx4 v[48:51], v6, s[8:11], s53 offen sc1
    s_mov_b64 exec, -1
    s_add_u32 s53, s49, 4096
    buffer_load_dwordx4 v[52:55], v4, s[8:11], s53 offen sc1
    s_add_u32 s53, s53, 147456
    buffer_load_dwordx4 v[56:59], v4, s[8:11], s53 offen sc1
    s_add_u32 s53, s53, 147456
    buffer_load_dwordx4 v[60:63], v4, s[8:11], s53 offen sc1
    s_add_u32 s53, s53, 147456
    buffer_load_dwordx4 v[64:67], v4, s[8:11], s53 offen sc1
    s_add_u32 s53, s53, 147456
    buffer_load_dwordx4 v[68:71], v4, s[8:11], s53 offen sc1
    s_add_u32 s53, s53, 147456
    buffer_load_dwordx4 v[72:75], v4, s[8:11], s53 offen sc1
    s_add_u32 s53, s53, 147456
    buffer_load_dwordx4 v[76:79], v4, s[8:11], s53 offen sc1
    s_add_u32 s53, s53, 147456
    buffer_load_dwordx4 v[80:83], v4, s[8:11], s53 offen sc1
    s_add_u32 s53, s53, 147456
    buffer_load_dwordx4 v[84:87], v4, s[8:11], s53 offen sc1
    s_waitcnt vmcnt(19)
    v_mfma_f32_16x16x32_bf16 v[36:39], v[16:19], v[92:95], 0
    s_waitcnt vmcnt(18)
    v_mfma_f32_16x16x32_bf16 v[36:39], v[16:19], v[96:99], v[36:39]
    s_waitcnt vmcnt(17)
    v_mfma_f32_16x16x32_bf16 v[36:39], v[16:19], v[100:103], v[36:39]
    s_waitcnt vmcnt(16)
    v_mfma_f32_16x16x32_bf16 v[36:39], v[16:19], v[104:107], v[36:39]
    s_waitcnt vmcnt(15)
    v_mfma_f32_16x16x32_bf16 v[36:39], v[16:19], v[108:111], v[36:39]
    s_waitcnt vmcnt(14)
    v_mfma_f32_16x16x32_bf16 v[36:39], v[16:19], v[112:115], v[36:39]
    s_waitcnt vmcnt(13)
    v_mfma_f32_16x16x32_bf16 v[36:39], v[16:19], v[116:119], v[36:39]
    s_waitcnt vmcnt(12)
    v_mfma_f32_16x16x32_bf16 v[36:39], v[16:19], v[120:123], v[36:39]
    s_waitcnt vmcnt(11)
    v_mfma_f32_16x16x32_bf16 v[36:39], v[16:19], v[124:127], v[36:39]
    s_waitcnt vmcnt(10)
    v_mfma_f32_16x16x32_bf16 v[36:39], v[16:19], v[128:131], v[36:39]
    s_waitcnt vmcnt(9)
    v_mfma_f32_16x16x32_bf16 v[40:43], v[16:19], v[48:51], 0
    s_waitcnt vmcnt(8)
    v_mfma_f32_16x16x32_bf16 v[40:43], v[16:19], v[52:55], v[40:43]
    s_waitcnt vmcnt(7)
    v_mfma_f32_16x16x32_bf16 v[40:43], v[16:19], v[56:59], v[40:43]
    s_waitcnt vmcnt(6)
    v_mfma_f32_16x16x32_bf16 v[40:43], v[16:19], v[60:63], v[40:43]
    s_waitcnt vmcnt(5)
    v_mfma_f32_16x16x32_bf16 v[40:43], v[16:19], v[64:67], v[40:43]
    s_waitcnt vmcnt(4)
    v_mfma_f32_16x16x32_bf16 v[40:43], v[16:19], v[68:71], v[40:43]
    s_waitcnt vmcnt(3)
    v_mfma_f32_16x16x32_bf16 v[40:43], v[16:19], v[72:75], v[40:43]
    s_waitcnt vmcnt(2)
    v_mfma_f32_16x16x32_bf16 v[40:43], v[16:19], v[76:79], v[40:43]
    s_waitcnt vmcnt(1)
    v_mfma_f32_16x16x32_bf16 v[40:43], v[16:19], v[80:83], v[40:43]
    s_waitcnt vmcnt(0)
    v_mfma_f32_16x16x32_bf16 v[40:43], v[16:19], v[84:87], v[40:43]
    s_branch Lrd_133
Lrd_132:
    s_waitcnt vmcnt(9)
    v_mfma_f32_16x16x32_bf16 v[36:39], v[16:19], v[92:95], 0
    s_waitcnt vmcnt(8)
    v_mfma_f32_16x16x32_bf16 v[36:39], v[16:19], v[96:99], v[36:39]
    s_waitcnt vmcnt(7)
    v_mfma_f32_16x16x32_bf16 v[36:39], v[16:19], v[100:103], v[36:39]
    s_waitcnt vmcnt(6)
    v_mfma_f32_16x16x32_bf16 v[36:39], v[16:19], v[104:107], v[36:39]
    s_waitcnt vmcnt(5)
    v_mfma_f32_16x16x32_bf16 v[36:39], v[16:19], v[108:111], v[36:39]
    s_waitcnt vmcnt(4)
    v_mfma_f32_16x16x32_bf16 v[36:39], v[16:19], v[112:115], v[36:39]
    s_waitcnt vmcnt(3)
    v_mfma_f32_16x16x32_bf16 v[36:39], v[16:19], v[116:119], v[36:39]
    s_waitcnt vmcnt(2)
    v_mfma_f32_16x16x32_bf16 v[36:39], v[16:19], v[120:123], v[36:39]
    s_waitcnt vmcnt(1)
    v_mfma_f32_16x16x32_bf16 v[36:39], v[16:19], v[124:127], v[36:39]
    s_waitcnt vmcnt(0)
    v_mfma_f32_16x16x32_bf16 v[36:39], v[16:19], v[128:131], v[36:39]
    v_mov_b32 v40, 0
    v_mov_b32 v41, 0
    v_mov_b32 v42, 0
    v_mov_b32 v43, 0
Lrd_133:
    s_nop 7
    v_cvt_pk_bf16_f32 v48, v24, v25
    v_cvt_pk_bf16_f32 v49, v26, v27
    v_cvt_pk_bf16_f32 v50, v28, v29
    v_cvt_pk_bf16_f32 v51, v30, v31
    v_cvt_pk_bf16_f32 v52, v32, v33
    v_cvt_pk_bf16_f32 v53, v34, v35
    v_cvt_pk_bf16_f32 v54, v36, v37
    v_cvt_pk_bf16_f32 v55, v38, v39
    v_cvt_pk_bf16_f32 v56, v40, v41
    v_cvt_pk_bf16_f32 v57, v42, v43
    s_mul_i32 s54, s22, 36864
    s_lshl_b32 s55, s20, 6
    s_add_u32 s54, s54, s55
    s_mov_b32 exec_hi, 0
    buffer_store_dwordx2 v[48:49], v13, s[40:43], s54 offen offset:0
    buffer_store_dwordx2 v[50:51], v13, s[40:43], s54 offen offset:256
    buffer_store_dwordx2 v[52:53], v13, s[40:43], s54 offen offset:512
    buffer_store_dwordx2 v[54:55], v13, s[40:43], s54 offen offset:768
    s_cmp_lt_u32 s20, 2
    s_cbranch_scc0 Lrd_134
    buffer_store_dwordx2 v[56:57], v13, s[40:43], s54 offen offset:1024
Lrd_134:
    s_mov_b64 exec, -1
    s_add_u32 s22, s22, 3
    s_branch Lrd_125
Lrd_126:
    s_waitcnt vmcnt(0)
    s_branch L_end
L_wfail:
    s_branch L_end
L_spare:
    s_branch L_ffn2
L_team:
    s_and_b32 s36, s20, 1
    s_lshl_b32 s36, s36, 5
    s_add_u32 s24, s21, s36
    s_cmp_lt_u32 s24, 36
    s_cselect_b32 s37, 1, 0
    s_cmp_lt_u32 s20, 2
    s_cselect_b32 s23, s37, 0
    s_cselect_b32 s25, 0, s37
    s_min_u32 s24, s24, 35
    s_lshr_b32 s36, s24, 2
    s_and_b32 s37, s36, 1
    s_cmp_eq_u32 s37, 0
    s_cselect_b32 s7, 1, 0
    s_cmp_eq_u32 s36, 8
    s_cselect_b32 s7, 1, s7
    v_and_b32 v0, 63, v0
    v_lshlrev_b32 v1, 4, v0
    v_and_b32 v21, 15, v0
    v_lshrrev_b32 v22, 4, v0
    v_mov_b32 v2, 0x4444
    v_mov_b32 v23, 0xeeee
    v_and_b32 v24, 2, v21
    v_cmp_eq_u32 vcc, 2, v24
    s_nop 1
    v_cndmask_b32 v2, v2, v23, vcc
    v_lshlrev_b32 v24, 4, v21
    v_and_b32 v25, 1, v22
    v_lshlrev_b32 v26, 3, v25
    v_lshrrev_b32 v27, 1, v22
    v_lshlrev_b32 v3, 13, v22
    s_lshl_b32 s36, s21, 8
    v_add3_u32 v3, v3, v24, s36
    s_lshl_b32 s36, s24, 13
    v_add_u32 v4, s36, v1
    v_lshrrev_b32 v28, 1, v21
    v_lshlrev_b32 v28, 2, v28
    v_and_b32 v29, 1, v21
    v_lshlrev_b32 v30, 1, v27
    v_add3_u32 v28, v28, v29, v30
    v_lshlrev_b32 v28, 4, v28
    s_lshl_b32 s36, s24, 8
    v_add3_u32 v5, v28, v26, s36
    s_mul_i32 s36, s20, 2304
    s_add_u32 s36, s36, 147456
    v_lshrrev_b32 v28, 2, v21
    v_lshlrev_b32 v28, 8, v28
    v_lshlrev_b32 v29, 6, v22
    v_and_b32 v31, 3, v21
    v_lshlrev_b32 v31, 4, v31
    v_add3_u32 v28, v28, v29, v31
    v_add_u32 v12, s36, v28
    s_lshr_b32 s36, s20, 1
    s_lshl_b32 s36, s36, 10
    s_and_b32 s37, s20, 1
    s_lshl_b32 s37, s37, 9
    s_add_u32 s36, s36, s37
    s_add_u32 s36, s36, 147456
    v_lshrrev_b32 v28, 1, v21
    v_lshlrev_b32 v28, 2, v28
    v_and_b32 v29, 1, v21
    v_add3_u32 v28, v28, v29, v30
    v_lshlrev_b32 v28, 4, v28
    v_add3_u32 v11, v28, v26, s36
    s_mul_i32 s36, s20, 1280
    s_add_u32 s36, s36, 156672
    v_mul_u32_u24 v28, 40, v21
    v_lshlrev_b32 v29, 2, v22
    v_add3_u32 v6, v28, v29, s36
    v_lshrrev_b32 v28, 2, v21
    v_and_b32 v29, 3, v21
    v_lshlrev_b32 v30, 4, v27
    v_lshlrev_b32 v31, 2, v25
    v_add3_u32 v30, v30, v31, v28
    v_mul_u32_u24 v30, 40, v30
    v_lshlrev_b32 v29, 3, v29
    v_add3_u32 v7, v30, v29, s36
    v_add_u32 v8, s36, v1
    v_and_b32 v28, 7, v21
    v_lshlrev_b32 v28, 5, v28
    v_lshlrev_b32 v29, 3, v22
    v_add_u32 v10, v28, v29
    v_add_u32 v10, 157696, v10
    s_sub_u32 s37, s36, 156704
    v_add3_u32 v9, v10, v29, s37
    s_lshl_b32 s36, s20, 11
    v_lshlrev_b32 v28, 10, v27
    v_lshlrev_b32 v29, 9, v25
    v_add3_u32 v13, v28, v29, v24
    v_add_u32 v13, s36, v13
    v_lshlrev_b32 v14, 7, v0
    s_mul_i32 s36, s20, 36864
    v_add_u32 v18, s36, v1
    v_add_u32 v19, 147456, v1
    s_mov_b32 s30, 0x00ff00ff
    s_mov_b32 s31, 0x00ff00ff
    s_mov_b32 s34, 0
    s_mov_b32 s35, 0x00ff00ff
    s_mov_b32 s54, 0x3e0293ee
    s_mov_b32 s55, 0x3e0293ee
    s_cmp_eq_u32 s20, 3
    s_cselect_b32 s2, -1, 0
    s_cselect_b32 s3, -1, 0
    s_cmp_ge_u32 s20, 2
    s_cbranch_scc1 Lsel_135
    v_and_b32 v29, 1, v21
    v_mov_b32 v30, 0x3f80
    v_mov_b32 v31, 0x3f800000
    v_cmp_eq_u32 vcc, 1, v29
    s_nop 1
    v_cndmask_b32 v30, v30, v31, vcc
    v_lshrrev_b32 v28, 1, v21
    v_cmp_eq_u32 vcc, 0, v28
    s_nop 1
    v_cndmask_b32 v14, 0, v30, vcc
    v_cmp_eq_u32 vcc, 1, v28
    s_nop 1
    v_cndmask_b32 v15, 0, v30, vcc
    v_cmp_eq_u32 vcc, 2, v28
    s_nop 1
    v_cndmask_b32 v16, 0, v30, vcc
    v_cmp_eq_u32 vcc, 3, v28
    s_nop 1
    v_cndmask_b32 v17, 0, v30, vcc
Lsel_135:
    v_lshrrev_b32 v24, 4, v0
    v_and_b32 v25, 15, v0
    v_and_b32 v26, 1, v24
    v_lshlrev_b32 v26, 1, v26
    v_xor_b32 v25, v25, v26
    v_lshlrev_b32 v25, 4, v25
    v_lshlrev_b32 v24, 13, v24
    v_add_u32 v24, v24, v25
    s_lshl_b32 s36, s21, 8
    v_add_u32 v24, s36, v24
    v_xor_b32 v25, 64, v24
    v_xor_b32 v26, 128, v24
    v_xor_b32 v27, 192, v24
    v_lshrrev_b32 v28, 4, v0
    v_lshrrev_b32 v29, 2, v0
    v_and_b32 v29, 3, v29
    v_and_b32 v30, 3, v0
    v_lshrrev_b32 v31, 1, v28
    v_and_b32 v32, 1, v28
    v_and_b32 v33, 1, v29
    v_lshrrev_b32 v34, 1, v29
    v_lshlrev_b32 v35, 4, v31
    v_lshlrev_b32 v36, 2, v32
    v_add3_u32 v35, v35, v36, v33
    v_lshlrev_b32 v36, 3, v34
    v_add_u32 v35, v35, v36
    v_lshlrev_b32 v35, 8, v35
    v_lshrrev_b32 v36, 1, v30
    s_lshl_b32 s36, s20, 2
    v_add_u32 v36, s36, v36
    v_lshlrev_b32 v37, 1, v33
    v_lshlrev_b32 v38, 2, v32
    v_lshlrev_b32 v39, 3, v34
    v_or_b32 v37, v37, v38
    v_or_b32 v37, v37, v39
    v_xor_b32 v36, v36, v37
    v_lshlrev_b32 v36, 4, v36
    v_and_b32 v37, 1, v30
    v_lshlrev_b32 v37, 3, v37
    v_add3_u32 v40, v35, v36, v37
    v_xor_b32 v41, 32, v40
    s_load_dwordx2 s[64:65], s[0:1], 16
    s_load_dwordx2 s[68:69], s[0:1], 24
    s_load_dwordx2 s[72:73], s[0:1], 32
    s_load_dwordx2 s[76:77], s[0:1], 40
    s_waitcnt lgkmcnt(0)
    s_mov_b32 s66, 4718592
    s_mov_b32 s67, 0x20000
    s_mov_b32 s70, 4718592
    s_mov_b32 s71, 0x20000
    s_mov_b32 s74, 4718592
    s_mov_b32 s75, 0x20000
    s_mov_b32 s78, 4718592
    s_mov_b32 s79, 0x20000
    s_lshl_b32 s38, s20, 12
    s_add_u32 s39, s38, 0
    s_lshl_b32 s40, s20, 17
    s_add_u32 s40, s40, 0
    s_mov_b32 m0, s39
    s_add_u32 s39, s39, 1024
    buffer_load_dwordx4 v24, s[64:67], s40 offen  lds
    s_add_u32 s40, s40, 32768
    s_mov_b32 m0, s39
    s_add_u32 s39, s39, 1024
    buffer_load_dwordx4 v25, s[64:67], s40 offen  lds
    s_add_u32 s40, s40, 32768
    s_mov_b32 m0, s39
    s_add_u32 s39, s39, 1024
    buffer_load_dwordx4 v26, s[64:67], s40 offen  lds
    s_add_u32 s40, s40, 32768
    s_mov_b32 m0, s39
    s_add_u32 s39, s39, 1024
    buffer_load_dwordx4 v27, s[64:67], s40 offen  lds
    s_add_u32 s40, s40, 32768
    s_lshl_b32 s38, s20, 12
    s_add_u32 s39, s38, 16384
    s_lshl_b32 s40, s20, 17
    s_add_u32 s40, s40, 524288
    s_mov_b32 m0, s39
    s_add_u32 s39, s39, 1024
    buffer_load_dwordx4 v24, s[64:67], s40 offen  lds
    s_add_u32 s40, s40, 32768
    s_mov_b32 m0, s39
    s_add_u32 s39, s39, 1024
    buffer_load_dwordx4 v25, s[64:67], s40 offen  lds
    s_add_u32 s40, s40, 32768
    s_mov_b32 m0, s39
    s_add_u32 s39, s39, 1024
    buffer_load_dwordx4 v26, s[64:67], s40 offen  lds
    s_add_u32 s40, s40, 32768
    s_mov_b32 m0, s39
    s_add_u32 s39, s39, 1024
    buffer_load_dwordx4 v27, s[64:67], s40 offen  lds
    s_add_u32 s40, s40, 32768
    s_lshl_b32 s38, s20, 12
    s_add_u32 s39, s38, 32768
    s_lshl_b32 s40, s20, 17
    s_add_u32 s40, s40, 1048576
    s_mov_b32 m0, s39
    s_add_u32 s39, s39, 1024
    buffer_load_dwordx4 v24, s[64:67], s40 offen  lds
    s_add_u32 s40, s40, 32768
    s_mov_b32 m0, s39
    s_add_u32 s39, s39, 1024
    buffer_load_dwordx4 v25, s[64:67], s40 offen  lds
    s_add_u32 s40, s40, 32768
    s_mov_b32 m0, s39
    s_add_u32 s39, s39, 1024
    buffer_load_dwordx4 v26, s[64:67], s40 offen  lds
    s_add_u32 s40, s40, 32768
    s_mov_b32 m0, s39
    s_add_u32 s39, s39, 1024
    buffer_load_dwordx4 v27, s[64:67], s40 offen  lds
    s_add_u32 s40, s40, 32768
    s_lshl_b32 s38, s20, 12
    s_add_u32 s39, s38, 49152
    s_lshl_b32 s40, s20, 17
    s_add_u32 s40, s40, 1572864
    s_mov_b32 m0, s39
    s_add_u32 s39, s39, 1024
    buffer_load_dwordx4 v24, s[64:67], s40 offen  lds
    s_add_u32 s40, s40, 32768
    s_mov_b32 m0, s39
    s_add_u32 s39, s39, 1024
    buffer_load_dwordx4 v25, s[64:67], s40 offen  lds
    s_add_u32 s40, s40, 32768
    s_mov_b32 m0, s39
    s_add_u32 s39, s39, 1024
    buffer_load_dwordx4 v26, s[64:67], s40 offen  lds
    s_add_u32 s40, s40, 32768
    s_mov_b32 m0, s39
    s_add_u32 s39, s39, 1024
    buffer_load_dwordx4 v27, s[64:67], s40 offen  lds
    s_add_u32 s40, s40, 32768
    s_lshl_b32 s38, s20, 12
    s_add_u32 s39, s38, 65536
    s_lshl_b32 s40, s20, 17
    s_add_u32 s40, s40, 2097152
    s_mov_b32 m0, s39
    s_add_u32 s39, s39, 1024
    buffer_load_dwordx4 v24, s[64:67], s40 offen  lds
    s_add_u32 s40, s40, 32768
    s_mov_b32 m0, s39
    s_add_u32 s39, s39, 1024
    buffer_load_dwordx4 v25, s[64:67], s40 offen  lds
    s_add_u32 s40, s40, 32768
    s_mov_b32 m0, s39
    s_add_u32 s39, s39, 1024
    buffer_load_dwordx4 v26, s[64:67], s40 offen  lds
    s_add_u32 s40, s40, 32768
    s_mov_b32 m0, s39
    s_add_u32 s39, s39, 1024
    buffer_load_dwordx4 v27, s[64:67], s40 offen  lds
    s_add_u32 s40, s40, 32768
    s_lshl_b32 s38, s20, 12
    s_add_u32 s39, s38, 81920
    s_lshl_b32 s40, s20, 17
    s_add_u32 s40, s40, 2621440
    s_mov_b32 m0, s39
    s_add_u32 s39, s39, 1024
    buffer_load_dwordx4 v24, s[64:67], s40 offen  lds
    s_add_u32 s40, s40, 32768
    s_mov_b32 m0, s39
    s_add_u32 s39, s39, 1024
    buffer_load_dwordx4 v25, s[64:67], s40 offen  lds
    s_add_u32 s40, s40, 32768
    s_mov_b32 m0, s39
    s_add_u32 s39, s39, 1024
    buffer_load_dwordx4 v26, s[64:67], s40 offen  lds
    s_add_u32 s40, s40, 32768
    s_mov_b32 m0, s39
    s_add_u32 s39, s39, 1024
    buffer_load_dwordx4 v27, s[64:67], s40 offen  lds
    s_add_u32 s40, s40, 32768
    s_lshl_b32 s38, s20, 12
    s_add_u32 s39, s38, 98304
    s_lshl_b32 s40, s20, 17
    s_add_u32 s40, s40, 3145728
    s_mov_b32 m0, s39
    s_add_u32 s39, s39, 1024
    buffer_load_dwordx4 v24, s[64:67], s40 offen  lds
    s_add_u32 s40, s40, 32768
    s_mov_b32 m0, s39
    s_add_u32 s39, s39, 1024
    buffer_load_dwordx4 v25, s[64:67], s40 offen  lds
    s_add_u32 s40, s40, 32768
    s_mov_b32 m0, s39
    s_add_u32 s39, s39, 1024
    buffer_load_dwordx4 v26, s[64:67], s40 offen  lds
    s_add_u32 s40, s40, 32768
    s_mov_b32 m0, s39
    s_add_u32 s39, s39, 1024
    buffer_load_dwordx4 v27, s[64:67], s40 offen  lds
    s_add_u32 s40, s40, 32768
    s_lshl_b32 s38, s20, 12
    s_add_u32 s39, s38, 114688
    s_lshl_b32 s40, s20, 17
    s_add_u32 s40, s40, 3670016
    s_mov_b32 m0, s39
    s_add_u32 s39, s39, 1024
    buffer_load_dwordx4 v24, s[64:67], s40 offen  lds
    s_add_u32 s40, s40, 32768
    s_mov_b32 m0, s39
    s_add_u32 s39, s39, 1024
    buffer_load_dwordx4 v25, s[64:67], s40 offen  lds
    s_add_u32 s40, s40, 32768
    s_mov_b32 m0, s39
    s_add_u32 s39, s39, 1024
    buffer_load_dwordx4 v26, s[64:67], s40 offen  lds
    s_add_u32 s40, s40, 32768
    s_mov_b32 m0, s39
    s_add_u32 s39, s39, 1024
    buffer_load_dwordx4 v27, s[64:67], s40 offen  lds
    s_add_u32 s40, s40, 32768
    v_mov_b32 v60, v24
    v_mov_b32 v61, v25
    v_mov_b32 v62, v26
    v_mov_b32 v63, v27
    s_cmp_eq_u32 s23, 0
    s_cbranch_scc1 Lim_136
    v_mov_b32 v24, -1
    v_mov_b32 v25, -1
    v_mov_b32 v26, -1
    v_mov_b32 v27, -1
    s_mov_b32 s36, 0
    buffer_store_dwordx4 v[24:27], v4, s[8:11], s36 offen offset:0 sc1
    s_mov_b32 s36, 0
    buffer_store_dwordx4 v[24:27], v4, s[8:11], s36 offen offset:1024 sc1
    s_mov_b32 s36, 0
    buffer_store_dwordx4 v[24:27], v4, s[8:11], s36 offen offset:2048 sc1
    s_mov_b32 s36, 0
    buffer_store_dwordx4 v[24:27], v4, s[8:11], s36 offen offset:3072 sc1
    s_mov_b32 s36, 4096
    buffer_store_dwordx4 v[24:27], v4, s[8:11], s36 offen offset:0 sc1
    s_mov_b32 s36, 4096
    buffer_store_dwordx4 v[24:27], v4, s[8:11], s36 offen offset:1024 sc1
    s_mov_b32 s36, 4096
    buffer_store_dwordx4 v[24:27], v4, s[8:11], s36 offen offset:2048 sc1
    s_mov_b32 s36, 4096
    buffer_store_dwordx4 v[24:27], v4, s[8:11], s36 offen offset:3072 sc1
    s_mov_b32 s36, 294912
    buffer_store_dwordx4 v[24:27], v4, s[8:11], s36 offen offset:0 sc1
    s_mov_b32 s36, 294912
    buffer_store_dwordx4 v[24:27], v4, s[8:11], s36 offen offset:1024 sc1
    s_mov_b32 s36, 294912
    buffer_store_dwordx4 v[24:27], v4, s[8:11], s36 offen offset:2048 sc1
    s_mov_b32 s36, 294912
    buffer_store_dwordx4 v[24:27], v4, s[8:11], s36 offen offset:3072 sc1
    s_mov_b32 s36, 299008
    buffer_store_dwordx4 v[24:27], v4, s[8:11], s36 offen offset:0 sc1
    s_mov_b32 s36, 299008
    buffer_store_dwordx4 v[24:27], v4, s[8:11], s36 offen offset:1024 sc1
    s_mov_b32 s36, 299008
    buffer_store_dwordx4 v[24:27], v4, s[8:11], s36 offen offset:2048 sc1
    s_mov_b32 s36, 299008
    buffer_store_dwordx4 v[24:27], v4, s[8:11], s36 offen offset:3072 sc1
    s_mov_b32 s36, 589824
    buffer_store_dwordx4 v[24:27], v4, s[8:11], s36 offen offset:0 sc1
    s_mov_b32 s36, 589824
    buffer_store_dwordx4 v[24:27], v4, s[8:11], s36 offen offset:1024 sc1
    s_mov_b32 s36, 589824
    buffer_store_dwordx4 v[24:27], v4, s[8:11], s36 offen offset:2048 sc1
    s_mov_b32 s36, 589824
    buffer_store_dwordx4 v[24:27], v4, s[8:11], s36 offen offset:3072 sc1
    s_mov_b32 s36, 593920
    buffer_store_dwordx4 v[24:27], v4, s[8:11], s36 offen offset:0 sc1
    s_mov_b32 s36, 593920
    buffer_store_dwordx4 v[24:27], v4, s[8:11], s36 offen offset:1024 sc1
    s_mov_b32 s36, 593920
    buffer_store_dwordx4 v[24:27], v4, s[8:11], s36 offen offset:2048 sc1
    s_mov_b32 s36, 593920
    buffer_store_dwordx4 v[24:27], v4, s[8:11], s36 offen offset:3072 sc1
    s_mov_b64 exec, s[30:31]
    s_mov_b32 s36, 893952
    buffer_store_dwordx2 v[24:25], v5, s[8:11], s36 offen sc1
    s_mov_b32 s36, 903168
    buffer_store_dwordx2 v[24:25], v5, s[8:11], s36 offen sc1
    s_load_dwordx2 s[36:37], s[0:1], 8
    s_waitcnt lgkmcnt(0)
    s_mov_b32 s12, s36
    s_mov_b32 s13, s37
    s_mov_b32 s14, 9216
    s_mov_b32 s15, 0x20000
    s_lshr_b32 s36, s24, 2
    s_and_b32 s37, s24, 3
    s_lshr_b32 s38, s36, 1
    s_mul_i32 s38, s38, 9
    s_and_b32 s39, s36, 1
    s_lshl_b32 s39, s39, 2
    s_add_u32 s38, s38, s39
    s_mul_i32 s39, s37, 9
    s_add_u32 s39, s39, 8
    v_and_b32 v28, 15, v0
    v_lshrrev_b32 v29, 1, v28
    v_add_u32 v29, s38, v29
    v_and_b32 v32, 1, v28
    s_lshl_b32 s37, s37, 1
    v_add_u32 v32, s37, v32
    s_cmp_eq_u32 s36, 8
    s_cbranch_scc0 Lm0_77
    v_mov_b32 v29, s39
    v_mov_b32 v32, v28
Lm0_77:
    v_lshlrev_b32 v28, 5, v29
    v_lshrrev_b32 v29, 4, v0
    v_lshlrev_b32 v29, 3, v29
    v_add_u32 v28, v28, v29
    v_mul_u32_u24 v29, 1152, v32
    v_add_u32 v28, v28, v29
    buffer_load_dwordx2 v[30:31], v28, s[12:15], 0 offen
    s_waitcnt vmcnt(0)
    v_min_u32 v30, -2, v30
    v_min_u32 v31, -2, v31
    s_mov_b32 s36, 884736
    buffer_store_dwordx2 v[30:31], v5, s[8:11], s36 offen sc1
    s_mov_b64 exec, -1
Lim_136:
    s_waitcnt vmcnt(0)
    s_barrier
    s_cmp_lg_u32 s20, 0
    s_cbranch_scc1 Lar_137
    s_mov_b64 exec, 1
    v_mov_b32 v28, 36
    v_mov_b32 v29, 1
    buffer_atomic_add v29, v28, s[16:19], 0 offen sc1
    s_waitcnt vmcnt(0)
    s_mov_b64 exec, -1
Lar_137:
    v_mov_b32 v24, v60
    v_mov_b32 v25, v61
    v_mov_b32 v26, v62
    v_mov_b32 v27, v63
    s_waitcnt vmcnt(28) lgkmcnt(0)
    s_barrier
    s_lshl_b32 s38, s20, 12
    s_add_u32 s39, s38, 131072
    s_lshl_b32 s40, s20, 17
    s_add_u32 s40, s40, 4194304
    s_mov_b32 m0, s39
    s_add_u32 s39, s39, 1024
    buffer_load_dwordx4 v24, s[64:67], s40 offen  lds
    s_add_u32 s40, s40, 32768
    s_mov_b32 m0, s39
    s_add_u32 s39, s39, 1024
    buffer_load_dwordx4 v25, s[64:67], s40 offen  lds
    s_add_u32 s40, s40, 32768
    s_mov_b32 m0, s39
    s_add_u32 s39, s39, 1024
    buffer_load_dwordx4 v26, s[64:67], s40 offen  lds
    s_add_u32 s40, s40, 32768
    s_mov_b32 m0, s39
    s_add_u32 s39, s39, 1024
    buffer_load_dwordx4 v27, s[64:67], s40 offen  lds
    s_add_u32 s40, s40, 32768
    v_add_u32 v42, 0, v40
    v_add_u32 v43, 0, v41
    ds_read_b64_tr_b16 a[0:1], v42 offset:0
    ds_read_b64_tr_b16 a[2:3], v42 offset:512
    ds_read_b64_tr_b16 a[4:5], v42 offset:8192
    ds_read_b64_tr_b16 a[6:7], v42 offset:8704
    ds_read_b64_tr_b16 a[8:9], v43 offset:0
    ds_read_b64_tr_b16 a[10:11], v43 offset:512
    ds_read_b64_tr_b16 a[12:13], v43 offset:8192
    ds_read_b64_tr_b16 a[14:15], v43 offset:8704
    s_waitcnt vmcnt(28) lgkmcnt(0)
    s_barrier
    s_lshl_b32 s38, s20, 12
    s_add_u32 s39, s38, 0
    s_lshl_b32 s40, s20, 17
    s_add_u32 s40, s40, 0
    s_mov_b32 m0, s39
    s_add_u32 s39, s39, 1024
    buffer_load_dwordx4 v24, s[68:71], s40 offen  lds
    s_add_u32 s40, s40, 32768
    s_mov_b32 m0, s39
    s_add_u32 s39, s39, 1024
    buffer_load_dwordx4 v25, s[68:71], s40 offen  lds
    s_add_u32 s40, s40, 32768
    s_mov_b32 m0, s39
    s_add_u32 s39, s39, 1024
    buffer_load_dwordx4 v26, s[68:71], s40 offen  lds
    s_add_u32 s40, s40, 32768
    s_mov_b32 m0, s39
    s_add_u32 s39, s39, 1024
    buffer_load_dwordx4 v27, s[68:71], s40 offen  lds
    s_add_u32 s40, s40, 32768
    v_add_u32 v42, 16384, v40
    v_add_u32 v43, 16384, v41
    ds_read_b64_tr_b16 a[16:17], v42 offset:0
    ds_read_b64_tr_b16 a[18:19], v42 offset:512
    ds_read_b64_tr_b16 a[20:21], v42 offset:8192
    ds_read_b64_tr_b16 a[22:23], v42 offset:8704
    ds_read_b64_tr_b16 a[24:25], v43 offset:0
    ds_read_b64_tr_b16 a[26:27], v43 offset:512
    ds_read_b64_tr_b16 a[28:29], v43 offset:8192
    ds_read_b64_tr_b16 a[30:31], v43 offset:8704
    s_waitcnt vmcnt(28) lgkmcnt(0)
    s_barrier
    s_lshl_b32 s38, s20, 12
    s_add_u32 s39, s38, 16384
    s_lshl_b32 s40, s20, 17
    s_add_u32 s40, s40, 524288
    s_mov_b32 m0, s39
    s_add_u32 s39, s39, 1024
    buffer_load_dwordx4 v24, s[68:71], s40 offen  lds
    s_add_u32 s40, s40, 32768
    s_mov_b32 m0, s39
    s_add_u32 s39, s39, 1024
    buffer_load_dwordx4 v25, s[68:71], s40 offen  lds
    s_add_u32 s40, s40, 32768
    s_mov_b32 m0, s39
    s_add_u32 s39, s39, 1024
    buffer_load_dwordx4 v26, s[68:71], s40 offen  lds
    s_add_u32 s40, s40, 32768
    s_mov_b32 m0, s39
    s_add_u32 s39, s39, 1024
    buffer_load_dwordx4 v27, s[68:71], s40 offen  lds
    s_add_u32 s40, s40, 32768
    v_add_u32 v42, 32768, v40
    v_add_u32 v43, 32768, v41
    ds_read_b64_tr_b16 a[32:33], v42 offset:0
    ds_read_b64_tr_b16 a[34:35], v42 offset:512
    ds_read_b64_tr_b16 a[36:37], v42 offset:8192
    ds_read_b64_tr_b16 a[38:39], v42 offset:8704
    ds_read_b64_tr_b16 a[40:41], v43 offset:0
    ds_read_b64_tr_b16 a[42:43], v43 offset:512
    ds_read_b64_tr_b16 a[44:45], v43 offset:8192
    ds_read_b64_tr_b16 a[46:47], v43 offset:8704
    s_waitcnt vmcnt(28) lgkmcnt(0)
    s_barrier
    s_lshl_b32 s38, s20, 12
    s_add_u32 s39, s38, 32768
    s_lshl_b32 s40, s20, 17
    s_add_u32 s40, s40, 1048576
    s_mov_b32 m0, s39
    s_add_u32 s39, s39, 1024
    buffer_load_dwordx4 v24, s[68:71], s40 offen  lds
    s_add_u32 s40, s40, 32768
    s_mov_b32 m0, s39
    s_add_u32 s39, s39, 1024
    buffer_load_dwordx4 v25, s[68:71], s40 offen  lds
    s_add_u32 s40, s40, 32768
    s_mov_b32 m0, s39
    s_add_u32 s39, s39, 1024
    buffer_load_dwordx4 v26, s[68:71], s40 offen  lds
    s_add_u32 s40, s40, 32768
    s_mov_b32 m0, s39
    s_add_u32 s39, s39, 1024
    buffer_load_dwordx4 v27, s[68:71], s40 offen  lds
    s_add_u32 s40, s40, 32768
    v_add_u32 v42, 49152, v40
    v_add_u32 v43, 49152, v41
    ds_read_b64_tr_b16 a[48:49], v42 offset:0
    ds_read_b64_tr_b16 a[50:51], v42 offset:512
    ds_read_b64_tr_b16 a[52:53], v42 offset:8192
    ds_read_b64_tr_b16 a[54:55], v42 offset:8704
    ds_read_b64_tr_b16 a[56:57], v43 offset:0
    ds_read_b64_tr_b16 a[58:59], v43 offset:512
    ds_read_b64_tr_b16 a[60:61], v43 offset:8192
    ds_read_b64_tr_b16 a[62:63], v43 offset:8704
    s_waitcnt vmcnt(28) lgkmcnt(0)
    s_barrier
    s_lshl_b32 s38, s20, 12
    s_add_u32 s39, s38, 49152
    s_lshl_b32 s40, s20, 17
    s_add_u32 s40, s40, 1572864
    s_mov_b32 m0, s39
    s_add_u32 s39, s39, 1024
    buffer_load_dwordx4 v24, s[68:71], s40 offen  lds
    s_add_u32 s40, s40, 32768
    s_mov_b32 m0, s39
    s_add_u32 s39, s39, 1024
    buffer_load_dwordx4 v25, s[68:71], s40 offen  lds
    s_add_u32 s40, s40, 32768
    s_mov_b32 m0, s39
    s_add_u32 s39, s39, 1024
    buffer_load_dwordx4 v26, s[68:71], s40 offen  lds
    s_add_u32 s40, s40, 32768
    s_mov_b32 m0, s39
    s_add_u32 s39, s39, 1024
    buffer_load_dwordx4 v27, s[68:71], s40 offen  lds
    s_add_u32 s40, s40, 32768
    v_add_u32 v42, 65536, v40
    v_add_u32 v43, 65536, v41
    ds_read_b64_tr_b16 a[64:65], v42 offset:0
    ds_read_b64_tr_b16 a[66:67], v42 offset:512
    ds_read_b64_tr_b16 a[68:69], v42 offset:8192
    ds_read_b64_tr_b16 a[70:71], v42 offset:8704
    ds_read_b64_tr_b16 a[72:73], v43 offset:0
    ds_read_b64_tr_b16 a[74:75], v43 offset:512
    ds_read_b64_tr_b16 a[76:77], v43 offset:8192
    ds_read_b64_tr_b16 a[78:79], v43 offset:8704
    s_waitcnt vmcnt(28) lgkmcnt(0)
    s_barrier
    s_lshl_b32 s38, s20, 12
    s_add_u32 s39, s38, 65536
    s_lshl_b32 s40, s20, 17
    s_add_u32 s40, s40, 2097152
    s_mov_b32 m0, s39
    s_add_u32 s39, s39, 1024
    buffer_load_dwordx4 v24, s[68:71], s40 offen  lds
    s_add_u32 s40, s40, 32768
    s_mov_b32 m0, s39
    s_add_u32 s39, s39, 1024
    buffer_load_dwordx4 v25, s[68:71], s40 offen  lds
    s_add_u32 s40, s40, 32768
    s_mov_b32 m0, s39
    s_add_u32 s39, s39, 1024
    buffer_load_dwordx4 v26, s[68:71], s40 offen  lds
    s_add_u32 s40, s40, 32768
    s_mov_b32 m0, s39
    s_add_u32 s39, s39, 1024
    buffer_load_dwordx4 v27, s[68:71], s40 offen  lds
    s_add_u32 s40, s40, 32768
    v_add_u32 v42, 81920, v40
    v_add_u32 v43, 81920, v41
    ds_read_b64_tr_b16 a[80:81], v42 offset:0
    ds_read_b64_tr_b16 a[82:83], v42 offset:512
    ds_read_b64_tr_b16 a[84:85], v42 offset:8192
    ds_read_b64_tr_b16 a[86:87], v42 offset:8704
    ds_read_b64_tr_b16 a[88:89], v43 offset:0
    ds_read_b64_tr_b16 a[90:91], v43 offset:512
    ds_read_b64_tr_b16 a[92:93], v43 offset:8192
    ds_read_b64_tr_b16 a[94:95], v43 offset:8704
    s_waitcnt vmcnt(28) lgkmcnt(0)
    s_barrier
    s_lshl_b32 s38, s20, 12
    s_add_u32 s39, s38, 81920
    s_lshl_b32 s40, s20, 17
    s_add_u32 s40, s40, 2621440
    s_mov_b32 m0, s39
    s_add_u32 s39, s39, 1024
    buffer_load_dwordx4 v24, s[68:71], s40 offen  lds
    s_add_u32 s40, s40, 32768
    s_mov_b32 m0, s39
    s_add_u32 s39, s39, 1024
    buffer_load_dwordx4 v25, s[68:71], s40 offen  lds
    s_add_u32 s40, s40, 32768
    s_mov_b32 m0, s39
    s_add_u32 s39, s39, 1024
    buffer_load_dwordx4 v26, s[68:71], s40 offen  lds
    s_add_u32 s40, s40, 32768
    s_mov_b32 m0, s39
    s_add_u32 s39, s39, 1024
    buffer_load_dwordx4 v27, s[68:71], s40 offen  lds
    s_add_u32 s40, s40, 32768
    v_add_u32 v42, 98304, v40
    v_add_u32 v43, 98304, v41
    ds_read_b64_tr_b16 a[96:97], v42 offset:0
    ds_read_b64_tr_b16 a[98:99], v42 offset:512
    ds_read_b64_tr_b16 a[100:101], v42 offset:8192
    ds_read_b64_tr_b16 a[102:103], v42 offset:8704
    ds_read_b64_tr_b16 a[104:105], v43 offset:0
    ds_read_b64_tr_b16 a[106:107], v43 offset:512
    ds_read_b64_tr_b16 a[108:109], v43 offset:8192
    ds_read_b64_tr_b16 a[110:111], v43 offset:8704
    s_waitcnt vmcnt(28) lgkmcnt(0)
    s_barrier
    s_lshl_b32 s38, s20, 12
    s_add_u32 s39, s38, 98304
    s_lshl_b32 s40, s20, 17
    s_add_u32 s40, s40, 3145728
    s_mov_b32 m0, s39
    s_add_u32 s39, s39, 1024
    buffer_load_dwordx4 v24, s[68:71], s40 offen  lds
    s_add_u32 s40, s40, 32768
    s_mov_b32 m0, s39
    s_add_u32 s39, s39, 1024
    buffer_load_dwordx4 v25, s[68:71], s40 offen  lds
    s_add_u32 s40, s40, 32768
    s_mov_b32 m0, s39
    s_add_u32 s39, s39, 1024
    buffer_load_dwordx4 v26, s[68:71], s40 offen  lds
    s_add_u32 s40, s40, 32768
    s_mov_b32 m0, s39
    s_add_u32 s39, s39, 1024
    buffer_load_dwordx4 v27, s[68:71], s40 offen  lds
    s_add_u32 s40, s40, 32768
    v_add_u32 v42, 114688, v40
    v_add_u32 v43, 114688, v41
    ds_read_b64_tr_b16 a[112:113], v42 offset:0
    ds_read_b64_tr_b16 a[114:115], v42 offset:512
    ds_read_b64_tr_b16 a[116:117], v42 offset:8192
    ds_read_b64_tr_b16 a[118:119], v42 offset:8704
    ds_read_b64_tr_b16 a[120:121], v43 offset:0
    ds_read_b64_tr_b16 a[122:123], v43 offset:512
    ds_read_b64_tr_b16 a[124:125], v43 offset:8192
    ds_read_b64_tr_b16 a[126:127], v43 offset:8704
    s_waitcnt vmcnt(28) lgkmcnt(0)
    s_barrier
    s_lshl_b32 s38, s20, 12
    s_add_u32 s39, s38, 114688
    s_lshl_b32 s40, s20, 17
    s_add_u32 s40, s40, 3670016
    s_mov_b32 m0, s39
    s_add_u32 s39, s39, 1024
    buffer_load_dwordx4 v24, s[68:71], s40 offen  lds
    s_add_u32 s40, s40, 32768
    s_mov_b32 m0, s39
    s_add_u32 s39, s39, 1024
    buffer_load_dwordx4 v25, s[68:71], s40 offen  lds
    s_add_u32 s40, s40, 32768
    s_mov_b32 m0, s39
    s_add_u32 s39, s39, 1024
    buffer_load_dwordx4 v26, s[68:71], s40 offen  lds
    s_add_u32 s40, s40, 32768
    s_mov_b32 m0, s39
    s_add_u32 s39, s39, 1024
    buffer_load_dwordx4 v27, s[68:71], s40 offen  lds
    s_add_u32 s40, s40, 32768
    v_add_u32 v42, 131072, v40
    v_add_u32 v43, 131072, v41
    ds_read_b64_tr_b16 a[128:129], v42 offset:0
    ds_read_b64_tr_b16 a[130:131], v42 offset:512
    ds_read_b64_tr_b16 a[132:133], v42 offset:8192
    ds_read_b64_tr_b16 a[134:135], v42 offset:8704
    ds_read_b64_tr_b16 a[136:137], v43 offset:0
    ds_read_b64_tr_b16 a[138:139], v43 offset:512
    ds_read_b64_tr_b16 a[140:141], v43 offset:8192
    ds_read_b64_tr_b16 a[142:143], v43 offset:8704
    s_waitcnt vmcnt(28) lgkmcnt(0)
    s_barrier
    s_lshl_b32 s38, s20, 12
    s_add_u32 s39, s38, 131072
    s_lshl_b32 s40, s20, 17
    s_add_u32 s40, s40, 4194304
    s_mov_b32 m0, s39
    s_add_u32 s39, s39, 1024
    buffer_load_dwordx4 v24, s[68:71], s40 offen  lds
    s_add_u32 s40, s40, 32768
    s_mov_b32 m0, s39
    s_add_u32 s39, s39, 1024
    buffer_load_dwordx4 v25, s[68:71], s40 offen  lds
    s_add_u32 s40, s40, 32768
    s_mov_b32 m0, s39
    s_add_u32 s39, s39, 1024
    buffer_load_dwordx4 v26, s[68:71], s40 offen  lds
    s_add_u32 s40, s40, 32768
    s_mov_b32 m0, s39
    s_add_u32 s39, s39, 1024
    buffer_load_dwordx4 v27, s[68:71], s40 offen  lds
    s_add_u32 s40, s40, 32768
    v_add_u32 v42, 0, v40
    v_add_u32 v43, 0, v41
    ds_read_b64_tr_b16 a[144:145], v42 offset:0
    ds_read_b64_tr_b16 a[146:147], v42 offset:512
    ds_read_b64_tr_b16 a[148:149], v42 offset:8192
    ds_read_b64_tr_b16 a[150:151], v42 offset:8704
    ds_read_b64_tr_b16 a[152:153], v43 offset:0
    ds_read_b64_tr_b16 a[154:155], v43 offset:512
    ds_read_b64_tr_b16 a[156:157], v43 offset:8192
    ds_read_b64_tr_b16 a[158:159], v43 offset:8704
    s_waitcnt vmcnt(28) lgkmcnt(0)
    s_barrier
    s_lshl_b32 s38, s20, 12
    s_add_u32 s39, s38, 0
    s_lshl_b32 s40, s20, 17
    s_add_u32 s40, s40, 0
    s_mov_b32 m0, s39
    s_add_u32 s39, s39, 1024
    buffer_load_dwordx4 v24, s[72:75], s40 offen  lds
    s_add_u32 s40, s40, 32768
    s_mov_b32 m0, s39
    s_add_u32 s39, s39, 1024
    buffer_load_dwordx4 v25, s[72:75], s40 offen  lds
    s_add_u32 s40, s40, 32768
    s_mov_b32 m0, s39
    s_add_u32 s39, s39, 1024
    buffer_load_dwordx4 v26, s[72:75], s40 offen  lds
    s_add_u32 s40, s40, 32768
    s_mov_b32 m0, s39
    s_add_u32 s39, s39, 1024
    buffer_load_dwordx4 v27, s[72:75], s40 offen  lds
    s_add_u32 s40, s40, 32768
    v_add_u32 v42, 16384, v40
    v_add_u32 v43, 16384, v41
    ds_read_b64_tr_b16 a[160:161], v42 offset:0
    ds_read_b64_tr_b16 a[162:163], v42 offset:512
    ds_read_b64_tr_b16 a[164:165], v42 offset:8192
    ds_read_b64_tr_b16 a[166:167], v42 offset:8704
    ds_read_b64_tr_b16 a[168:169], v43 offset:0
    ds_read_b64_tr_b16 a[170:171], v43 offset:512
    ds_read_b64_tr_b16 a[172:173], v43 offset:8192
    ds_read_b64_tr_b16 a[174:175], v43 offset:8704
    s_waitcnt vmcnt(28) lgkmcnt(0)
    s_barrier
    s_lshl_b32 s38, s20, 12
    s_add_u32 s39, s38, 16384
    s_lshl_b32 s40, s20, 17
    s_add_u32 s40, s40, 524288
    s_mov_b32 m0, s39
    s_add_u32 s39, s39, 1024
    buffer_load_dwordx4 v24, s[72:75], s40 offen  lds
    s_add_u32 s40, s40, 32768
    s_mov_b32 m0, s39
    s_add_u32 s39, s39, 1024
    buffer_load_dwordx4 v25, s[72:75], s40 offen  lds
    s_add_u32 s40, s40, 32768
    s_mov_b32 m0, s39
    s_add_u32 s39, s39, 1024
    buffer_load_dwordx4 v26, s[72:75], s40 offen  lds
    s_add_u32 s40, s40, 32768
    s_mov_b32 m0, s39
    s_add_u32 s39, s39, 1024
    buffer_load_dwordx4 v27, s[72:75], s40 offen  lds
    s_add_u32 s40, s40, 32768
    v_add_u32 v42, 32768, v40
    v_add_u32 v43, 32768, v41
    ds_read_b64_tr_b16 a[176:177], v42 offset:0
    ds_read_b64_tr_b16 a[178:179], v42 offset:512
    ds_read_b64_tr_b16 a[180:181], v42 offset:8192
    ds_read_b64_tr_b16 a[182:183], v42 offset:8704
    ds_read_b64_tr_b16 a[184:185], v43 offset:0
    ds_read_b64_tr_b16 a[186:187], v43 offset:512
    ds_read_b64_tr_b16 a[188:189], v43 offset:8192
    ds_read_b64_tr_b16 a[190:191], v43 offset:8704
    s_waitcnt vmcnt(28) lgkmcnt(0)
    s_barrier
    s_lshl_b32 s38, s20, 12
    s_add_u32 s39, s38, 32768
    s_lshl_b32 s40, s20, 17
    s_add_u32 s40, s40, 1048576
    s_mov_b32 m0, s39
    s_add_u32 s39, s39, 1024
    buffer_load_dwordx4 v24, s[72:75], s40 offen  lds
    s_add_u32 s40, s40, 32768
    s_mov_b32 m0, s39
    s_add_u32 s39, s39, 1024
    buffer_load_dwordx4 v25, s[72:75], s40 offen  lds
    s_add_u32 s40, s40, 32768
    s_mov_b32 m0, s39
    s_add_u32 s39, s39, 1024
    buffer_load_dwordx4 v26, s[72:75], s40 offen  lds
    s_add_u32 s40, s40, 32768
    s_mov_b32 m0, s39
    s_add_u32 s39, s39, 1024
    buffer_load_dwordx4 v27, s[72:75], s40 offen  lds
    s_add_u32 s40, s40, 32768
    v_add_u32 v42, 49152, v40
    v_add_u32 v43, 49152, v41
    ds_read_b64_tr_b16 a[192:193], v42 offset:0
    ds_read_b64_tr_b16 a[194:195], v42 offset:512
    ds_read_b64_tr_b16 a[196:197], v42 offset:8192
    ds_read_b64_tr_b16 a[198:199], v42 offset:8704
    ds_read_b64_tr_b16 a[200:201], v43 offset:0
    ds_read_b64_tr_b16 a[202:203], v43 offset:512
    ds_read_b64_tr_b16 a[204:205], v43 offset:8192
    ds_read_b64_tr_b16 a[206:207], v43 offset:8704
    s_waitcnt vmcnt(28) lgkmcnt(0)
    s_barrier
    s_lshl_b32 s38, s20, 12
    s_add_u32 s39, s38, 49152
    s_lshl_b32 s40, s20, 17
    s_add_u32 s40, s40, 1572864
    s_mov_b32 m0, s39
    s_add_u32 s39, s39, 1024
    buffer_load_dwordx4 v24, s[72:75], s40 offen  lds
    s_add_u32 s40, s40, 32768
    s_mov_b32 m0, s39
    s_add_u32 s39, s39, 1024
    buffer_load_dwordx4 v25, s[72:75], s40 offen  lds
    s_add_u32 s40, s40, 32768
    s_mov_b32 m0, s39
    s_add_u32 s39, s39, 1024
    buffer_load_dwordx4 v26, s[72:75], s40 offen  lds
    s_add_u32 s40, s40, 32768
    s_mov_b32 m0, s39
    s_add_u32 s39, s39, 1024
    buffer_load_dwordx4 v27, s[72:75], s40 offen  lds
    s_add_u32 s40, s40, 32768
    v_add_u32 v42, 65536, v40
    v_add_u32 v43, 65536, v41
    ds_read_b64_tr_b16 a[208:209], v42 offset:0
    ds_read_b64_tr_b16 a[210:211], v42 offset:512
    ds_read_b64_tr_b16 a[212:213], v42 offset:8192
    ds_read_b64_tr_b16 a[214:215], v42 offset:8704
    ds_read_b64_tr_b16 a[216:217], v43 offset:0
    ds_read_b64_tr_b16 a[218:219], v43 offset:512
    ds_read_b64_tr_b16 a[220:221], v43 offset:8192
    ds_read_b64_tr_b16 a[222:223], v43 offset:8704
    s_waitcnt vmcnt(28) lgkmcnt(0)
    s_barrier
    s_lshl_b32 s38, s20, 12
    s_add_u32 s39, s38, 65536
    s_lshl_b32 s40, s20, 17
    s_add_u32 s40, s40, 2097152
    s_mov_b32 m0, s39
    s_add_u32 s39, s39, 1024
    buffer_load_dwordx4 v24, s[72:75], s40 offen  lds
    s_add_u32 s40, s40, 32768
    s_mov_b32 m0, s39
    s_add_u32 s39, s39, 1024
    buffer_load_dwordx4 v25, s[72:75], s40 offen  lds
    s_add_u32 s40, s40, 32768
    s_mov_b32 m0, s39
    s_add_u32 s39, s39, 1024
    buffer_load_dwordx4 v26, s[72:75], s40 offen  lds
    s_add_u32 s40, s40, 32768
    s_mov_b32 m0, s39
    s_add_u32 s39, s39, 1024
    buffer_load_dwordx4 v27, s[72:75], s40 offen  lds
    s_add_u32 s40, s40, 32768
    v_add_u32 v42, 81920, v40
    v_add_u32 v43, 81920, v41
    ds_read_b64_tr_b16 a[224:225], v42 offset:0
    ds_read_b64_tr_b16 a[226:227], v42 offset:512
    ds_read_b64_tr_b16 a[228:229], v42 offset:8192
    ds_read_b64_tr_b16 a[230:231], v42 offset:8704
    ds_read_b64_tr_b16 a[232:233], v43 offset:0
    ds_read_b64_tr_b16 a[234:235], v43 offset:512
    ds_read_b64_tr_b16 a[236:237], v43 offset:8192
    ds_read_b64_tr_b16 a[238:239], v43 offset:8704
    s_waitcnt vmcnt(28) lgkmcnt(0)
    s_barrier
    s_lshl_b32 s38, s20, 12
    s_add_u32 s39, s38, 81920
    s_lshl_b32 s40, s20, 17
    s_add_u32 s40, s40, 2621440
    s_mov_b32 m0, s39
    s_add_u32 s39, s39, 1024
    buffer_load_dwordx4 v24, s[72:75], s40 offen  lds
    s_add_u32 s40, s40, 32768
    s_mov_b32 m0, s39
    s_add_u32 s39, s39, 1024
    buffer_load_dwordx4 v25, s[72:75], s40 offen  lds
    s_add_u32 s40, s40, 32768
    s_mov_b32 m0, s39
    s_add_u32 s39, s39, 1024
    buffer_load_dwordx4 v26, s[72:75], s40 offen  lds
    s_add_u32 s40, s40, 32768
    s_mov_b32 m0, s39
    s_add_u32 s39, s39, 1024
    buffer_load_dwordx4 v27, s[72:75], s40 offen  lds
    s_add_u32 s40, s40, 32768
    v_add_u32 v42, 98304, v40
    v_add_u32 v43, 98304, v41
    ds_read_b64_tr_b16 a[240:241], v42 offset:0
    ds_read_b64_tr_b16 a[242:243], v42 offset:512
    ds_read_b64_tr_b16 a[244:245], v42 offset:8192
    ds_read_b64_tr_b16 a[246:247], v42 offset:8704
    ds_read_b64_tr_b16 a[248:249], v43 offset:0
    ds_read_b64_tr_b16 a[250:251], v43 offset:512
    ds_read_b64_tr_b16 a[252:253], v43 offset:8192
    ds_read_b64_tr_b16 a[254:255], v43 offset:8704
    s_waitcnt vmcnt(28) lgkmcnt(0)
    s_barrier
    s_lshl_b32 s38, s20, 12
    s_add_u32 s39, s38, 98304
    s_lshl_b32 s40, s20, 17
    s_add_u32 s40, s40, 3145728
    s_mov_b32 m0, s39
    s_add_u32 s39, s39, 1024
    buffer_load_dwordx4 v24, s[72:75], s40 offen  lds
    s_add_u32 s40, s40, 32768
    s_mov_b32 m0, s39
    s_add_u32 s39, s39, 1024
    buffer_load_dwordx4 v25, s[72:75], s40 offen  lds
    s_add_u32 s40, s40, 32768
    s_mov_b32 m0, s39
    s_add_u32 s39, s39, 1024
    buffer_load_dwordx4 v26, s[72:75], s40 offen  lds
    s_add_u32 s40, s40, 32768
    s_mov_b32 m0, s39
    s_add_u32 s39, s39, 1024
    buffer_load_dwordx4 v27, s[72:75], s40 offen  lds
    s_add_u32 s40, s40, 32768
    v_add_u32 v42, 114688, v40
    v_add_u32 v43, 114688, v41
    ds_read_b64_tr_b16 v[80:81], v42 offset:0
    ds_read_b64_tr_b16 v[82:83], v42 offset:512
    ds_read_b64_tr_b16 v[84:85], v42 offset:8192
    ds_read_b64_tr_b16 v[86:87], v42 offset:8704
    ds_read_b64_tr_b16 v[88:89], v43 offset:0
    ds_read_b64_tr_b16 v[90:91], v43 offset:512
    ds_read_b64_tr_b16 v[92:93], v43 offset:8192
    ds_read_b64_tr_b16 v[94:95], v43 offset:8704
    s_waitcnt vmcnt(28) lgkmcnt(0)
    s_barrier
    s_lshl_b32 s38, s20, 12
    s_add_u32 s39, s38, 114688
    s_lshl_b32 s40, s20, 17
    s_add_u32 s40, s40, 3670016
    s_mov_b32 m0, s39
    s_add_u32 s39, s39, 1024
    buffer_load_dwordx4 v24, s[72:75], s40 offen  lds
    s_add_u32 s40, s40, 32768
    s_mov_b32 m0, s39
    s_add_u32 s39, s39, 1024
    buffer_load_dwordx4 v25, s[72:75], s40 offen  lds
    s_add_u32 s40, s40, 32768
    s_mov_b32 m0, s39
    s_add_u32 s39, s39, 1024
    buffer_load_dwordx4 v26, s[72:75], s40 offen  lds
    s_add_u32 s40, s40, 32768
    s_mov_b32 m0, s39
    s_add_u32 s39, s39, 1024
    buffer_load_dwordx4 v27, s[72:75], s40 offen  lds
    s_add_u32 s40, s40, 32768
    v_add_u32 v42, 131072, v40
    v_add_u32 v43, 131072, v41
    ds_read_b64_tr_b16 v[96:97], v42 offset:0
    ds_read_b64_tr_b16 v[98:99], v42 offset:512
    ds_read_b64_tr_b16 v[100:101], v42 offset:8192
    ds_read_b64_tr_b16 v[102:103], v42 offset:8704
    ds_read_b64_tr_b16 v[104:105], v43 offset:0
    ds_read_b64_tr_b16 v[106:107], v43 offset:512
    ds_read_b64_tr_b16 v[108:109], v43 offset:8192
    ds_read_b64_tr_b16 v[110:111], v43 offset:8704
    s_waitcnt vmcnt(28) lgkmcnt(0)
    s_barrier
    s_lshl_b32 s38, s20, 12
    s_add_u32 s39, s38, 131072
    s_lshl_b32 s40, s20, 17
    s_add_u32 s40, s40, 4194304
    s_mov_b32 m0, s39
    s_add_u32 s39, s39, 1024
    buffer_load_dwordx4 v24, s[72:75], s40 offen  lds
    s_add_u32 s40, s40, 32768
    s_mov_b32 m0, s39
    s_add_u32 s39, s39, 1024
    buffer_load_dwordx4 v25, s[72:75], s40 offen  lds
    s_add_u32 s40, s40, 32768
    s_mov_b32 m0, s39
    s_add_u32 s39, s39, 1024
    buffer_load_dwordx4 v26, s[72:75], s40 offen  lds
    s_add_u32 s40, s40, 32768
    s_mov_b32 m0, s39
    s_add_u32 s39, s39, 1024
    buffer_load_dwordx4 v27, s[72:75], s40 offen  lds
    s_add_u32 s40, s40, 32768
    v_add_u32 v42, 0, v40
    v_add_u32 v43, 0, v41
    ds_read_b64_tr_b16 v[112:113], v42 offset:0
    ds_read_b64_tr_b16 v[114:115], v42 offset:512
    ds_read_b64_tr_b16 v[116:117], v42 offset:8192
    ds_read_b64_tr_b16 v[118:119], v42 offset:8704
    ds_read_b64_tr_b16 v[120:121], v43 offset:0
    ds_read_b64_tr_b16 v[122:123], v43 offset:512
    ds_read_b64_tr_b16 v[124:125], v43 offset:8192
    ds_read_b64_tr_b16 v[126:127], v43 offset:8704
    s_waitcnt vmcnt(28) lgkmcnt(0)
    s_barrier
    v_add_u32 v42, 16384, v40
    v_add_u32 v43, 16384, v41
    ds_read_b64_tr_b16 v[128:129], v42 offset:0
    ds_read_b64_tr_b16 v[130:131], v42 offset:512
    ds_read_b64_tr_b16 v[132:133], v42 offset:8192
    ds_read_b64_tr_b16 v[134:135], v42 offset:8704
    ds_read_b64_tr_b16 v[136:137], v43 offset:0
    ds_read_b64_tr_b16 v[138:139], v43 offset:512
    ds_read_b64_tr_b16 v[140:141], v43 offset:8192
    ds_read_b64_tr_b16 v[142:143], v43 offset:8704
    s_waitcnt vmcnt(24) lgkmcnt(0)
    s_barrier
    v_add_u32 v42, 32768, v40
    v_add_u32 v43, 32768, v41
    ds_read_b64_tr_b16 v[144:145], v42 offset:0
    ds_read_b64_tr_b16 v[146:147], v42 offset:512
    ds_read_b64_tr_b16 v[148:149], v42 offset:8192
    ds_read_b64_tr_b16 v[150:151], v42 offset:8704
    ds_read_b64_tr_b16 v[152:153], v43 offset:0
    ds_read_b64_tr_b16 v[154:155], v43 offset:512
    ds_read_b64_tr_b16 v[156:157], v43 offset:8192
    ds_read_b64_tr_b16 v[158:159], v43 offset:8704
    s_waitcnt vmcnt(20) lgkmcnt(0)
    s_barrier
    v_add_u32 v42, 49152, v40
    v_add_u32 v43, 49152, v41
    ds_read_b64_tr_b16 v[160:161], v42 offset:0
    ds_read_b64_tr_b16 v[162:163], v42 offset:512
    ds_read_b64_tr_b16 v[164:165], v42 offset:8192
    ds_read_b64_tr_b16 v[166:167], v42 offset:8704
    ds_read_b64_tr_b16 v[168:169], v43 offset:0
    ds_read_b64_tr_b16 v[170:171], v43 offset:512
    ds_read_b64_tr_b16 v[172:173], v43 offset:8192
    ds_read_b64_tr_b16 v[174:175], v43 offset:8704
    s_waitcnt vmcnt(16) lgkmcnt(0)
    s_barrier
    v_add_u32 v42, 65536, v40
    v_add_u32 v43, 65536, v41
    ds_read_b64_tr_b16 v[176:177], v42 offset:0
    ds_read_b64_tr_b16 v[178:179], v42 offset:512
    ds_read_b64_tr_b16 v[180:181], v42 offset:8192
    ds_read_b64_tr_b16 v[182:183], v42 offset:8704
    ds_read_b64_tr_b16 v[184:185], v43 offset:0
    ds_read_b64_tr_b16 v[186:187], v43 offset:512
    ds_read_b64_tr_b16 v[188:189], v43 offset:8192
    ds_read_b64_tr_b16 v[190:191], v43 offset:8704
    s_waitcnt vmcnt(12) lgkmcnt(0)
    s_barrier
    v_add_u32 v42, 81920, v40
    v_add_u32 v43, 81920, v41
    ds_read_b64_tr_b16 v[192:193], v42 offset:0
    ds_read_b64_tr_b16 v[194:195], v42 offset:512
    ds_read_b64_tr_b16 v[196:197], v42 offset:8192
    ds_read_b64_tr_b16 v[198:199], v42 offset:8704
    ds_read_b64_tr_b16 v[200:201], v43 offset:0
    ds_read_b64_tr_b16 v[202:203], v43 offset:512
    ds_read_b64_tr_b16 v[204:205], v43 offset:8192
    ds_read_b64_tr_b16 v[206:207], v43 offset:8704
    s_waitcnt vmcnt(8) lgkmcnt(0)
    s_barrier
    v_add_u32 v42, 98304, v40
    v_add_u32 v43, 98304, v41
    ds_read_b64_tr_b16 v[208:209], v42 offset:0
    ds_read_b64_tr_b16 v[210:211], v42 offset:512
    ds_read_b64_tr_b16 v[212:213], v42 offset:8192
    ds_read_b64_tr_b16 v[214:215], v42 offset:8704
    ds_read_b64_tr_b16 v[216:217], v43 offset:0
    ds_read_b64_tr_b16 v[218:219], v43 offset:512
    ds_read_b64_tr_b16 v[220:221], v43 offset:8192
    ds_read_b64_tr_b16 v[222:223], v43 offset:8704
    s_waitcnt vmcnt(4) lgkmcnt(0)
    s_barrier
    v_add_u32 v42, 114688, v40
    v_add_u32 v43, 114688, v41
    ds_read_b64_tr_b16 v[224:225], v42 offset:0
    ds_read_b64_tr_b16 v[226:227], v42 offset:512
    ds_read_b64_tr_b16 v[228:229], v42 offset:8192
    ds_read_b64_tr_b16 v[230:231], v42 offset:8704
    ds_read_b64_tr_b16 v[232:233], v43 offset:0
    ds_read_b64_tr_b16 v[234:235], v43 offset:512
    ds_read_b64_tr_b16 v[236:237], v43 offset:8192
    ds_read_b64_tr_b16 v[238:239], v43 offset:8704
    s_waitcnt vmcnt(0) lgkmcnt(0)
    s_barrier
    v_add_u32 v42, 131072, v40
    v_add_u32 v43, 131072, v41
    ds_read_b64_tr_b16 v[240:241], v42 offset:0
    ds_read_b64_tr_b16 v[242:243], v42 offset:512
    ds_read_b64_tr_b16 v[244:245], v42 offset:8192
    ds_read_b64_tr_b16 v[246:247], v42 offset:8704
    ds_read_b64_tr_b16 v[248:249], v43 offset:0
    ds_read_b64_tr_b16 v[250:251], v43 offset:512
    ds_read_b64_tr_b16 v[252:253], v43 offset:8192
    ds_read_b64_tr_b16 v[254:255], v43 offset:8704
    s_waitcnt lgkmcnt(0)
    s_barrier
    v_lshlrev_b32 v24, 4, v0
    s_mul_i32 s38, s21, 147456
    s_mul_i32 s39, s20, 9216
    s_add_u32 s38, s38, s39
    s_mul_i32 s39, s20, 36864
    s_add_u32 s40, s39, 0
    s_mov_b32 m0, s40
    s_add_u32 s41, s38, 0
    buffer_load_dwordx4 v24, s[76:79], s41 offen  lds
    s_add_u32 s40, s39, 1024
    s_mov_b32 m0, s40
    s_add_u32 s41, s38, 1024
    buffer_load_dwordx4 v24, s[76:79], s41 offen  lds
    s_add_u32 s40, s39, 2048
    s_mov_b32 m0, s40
    s_add_u32 s41, s38, 2048
    buffer_load_dwordx4 v24, s[76:79], s41 offen  lds
    s_add_u32 s40, s39, 3072
    s_mov_b32 m0, s40
    s_add_u32 s41, s38, 3072
    buffer_load_dwordx4 v24, s[76:79], s41 offen  lds
    s_add_u32 s40, s39, 4096
    s_mov_b32 m0, s40
    s_add_u32 s41, s38, 4096
    buffer_load_dwordx4 v24, s[76:79], s41 offen  lds
    s_add_u32 s40, s39, 5120
    s_mov_b32 m0, s40
    s_add_u32 s41, s38, 5120
    buffer_load_dwordx4 v24, s[76:79], s41 offen  lds
    s_add_u32 s40, s39, 6144
    s_mov_b32 m0, s40
    s_add_u32 s41, s38, 6144
    buffer_load_dwordx4 v24, s[76:79], s41 offen  lds
    s_add_u32 s40, s39, 7168
    s_mov_b32 m0, s40
    s_add_u32 s41, s38, 7168
    buffer_load_dwordx4 v24, s[76:79], s41 offen  lds
    s_add_u32 s40, s39, 8192
    s_mov_b32 m0, s40
    s_add_u32 s41, s38, 8192
    buffer_load_dwordx4 v24, s[76:79], s41 offen  lds
    s_add_u32 s40, s39, 9216
    s_mov_b32 m0, s40
    s_add_u32 s41, s38, 36864
    buffer_load_dwordx4 v24, s[76:79], s41 offen  lds
    s_add_u32 s40, s39, 10240
    s_mov_b32 m0, s40
    s_add_u32 s41, s38, 37888
    buffer_load_dwordx4 v24, s[76:79], s41 offen  lds
    s_add_u32 s40, s39, 11264
    s_mov_b32 m0, s40
    s_add_u32 s41, s38, 38912
    buffer_load_dwordx4 v24, s[76:79], s41 offen  lds
    s_add_u32 s40, s39, 12288
    s_mov_b32 m0, s40
    s_add_u32 s41, s38, 39936
    buffer_load_dwordx4 v24, s[76:79], s41 offen  lds
    s_add_u32 s40, s39, 13312
    s_mov_b32 m0, s40
    s_add_u32 s41, s38, 40960
    buffer_load_dwordx4 v24, s[76:79], s41 offen  lds
    s_add_u32 s40, s39, 14336
    s_mov_b32 m0, s40
    s_add_u32 s41, s38, 41984
    buffer_load_dwordx4 v24, s[76:79], s41 offen  lds
    s_add_u32 s40, s39, 15360
    s_mov_b32 m0, s40
    s_add_u32 s41, s38, 43008
    buffer_load_dwordx4 v24, s[76:79], s41 offen  lds
    s_add_u32 s40, s39, 16384
    s_mov_b32 m0, s40
    s_add_u32 s41, s38, 44032
    buffer_load_dwordx4 v24, s[76:79], s41 offen  lds
    s_add_u32 s40, s39, 17408
    s_mov_b32 m0, s40
    s_add_u32 s41, s38, 45056
    buffer_load_dwordx4 v24, s[76:79], s41 offen  lds
    s_add_u32 s40, s39, 18432
    s_mov_b32 m0, s40
    s_add_u32 s41, s38, 73728
    buffer_load_dwordx4 v24, s[76:79], s41 offen  lds
    s_add_u32 s40, s39, 19456
    s_mov_b32 m0, s40
    s_add_u32 s41, s38, 74752
    buffer_load_dwordx4 v24, s[76:79], s41 offen  lds
    s_add_u32 s40, s39, 20480
    s_mov_b32 m0, s40
    s_add_u32 s41, s38, 75776
    buffer_load_dwordx4 v24, s[76:79], s41 offen  lds
    s_add_u32 s40, s39, 21504
    s_mov_b32 m0, s40
    s_add_u32 s41, s38, 76800
    buffer_load_dwordx4 v24, s[76:79], s41 offen  lds
    s_add_u32 s40, s39, 22528
    s_mov_b32 m0, s40
    s_add_u32 s41, s38, 77824
    buffer_load_dwordx4 v24, s[76:79], s41 offen  lds
    s_add_u32 s40, s39, 23552
    s_mov_b32 m0, s40
    s_add_u32 s41, s38, 78848
    buffer_load_dwordx4 v24, s[76:79], s41 offen  lds
    s_add_u32 s40, s39, 24576
    s_mov_b32 m0, s40
    s_add_u32 s41, s38, 79872
    buffer_load_dwordx4 v24, s[76:79], s41 offen  lds
    s_add_u32 s40, s39, 25600
    s_mov_b32 m0, s40
    s_add_u32 s41, s38, 80896
    buffer_load_dwordx4 v24, s[76:79], s41 offen  lds
    s_add_u32 s40, s39, 26624
    s_mov_b32 m0, s40
    s_add_u32 s41, s38, 81920
    buffer_load_dwordx4 v24, s[76:79], s41 offen  lds
    s_add_u32 s40, s39, 27648
    s_mov_b32 m0, s40
    s_add_u32 s41, s38, 110592
    buffer_load_dwordx4 v24, s[76:79], s41 offen  lds
    s_add_u32 s40, s39, 28672
    s_mov_b32 m0, s40
    s_add_u32 s41, s38, 111616
    buffer_load_dwordx4 v24, s[76:79], s41 offen  lds
    s_add_u32 s40, s39, 29696
    s_mov_b32 m0, s40
    s_add_u32 s41, s38, 112640
    buffer_load_dwordx4 v24, s[76:79], s41 offen  lds
    s_add_u32 s40, s39, 30720
    s_mov_b32 m0, s40
    s_add_u32 s41, s38, 113664
    buffer_load_dwordx4 v24, s[76:79], s41 offen  lds
    s_add_u32 s40, s39, 31744
    s_mov_b32 m0, s40
    s_add_u32 s41, s38, 114688
    buffer_load_dwordx4 v24, s[76:79], s41 offen  lds
    s_add_u32 s40, s39, 32768
    s_mov_b32 m0, s40
    s_add_u32 s41, s38, 115712
    buffer_load_dwordx4 v24, s[76:79], s41 offen  lds
    s_add_u32 s40, s39, 33792
    s_mov_b32 m0, s40
    s_add_u32 s41, s38, 116736
    buffer_load_dwordx4 v24, s[76:79], s41 offen  lds
    s_add_u32 s40, s39, 34816
    s_mov_b32 m0, s40
    s_add_u32 s41, s38, 117760
    buffer_load_dwordx4 v24, s[76:79], s41 offen  lds
    s_add_u32 s40, s39, 35840
    s_mov_b32 m0, s40
    s_add_u32 s41, s38, 118784
    buffer_load_dwordx4 v24, s[76:79], s41 offen  lds
    v_lshrrev_b32 v28, 4, v0
    v_lshrrev_b32 v29, 2, v0
    v_and_b32 v29, 3, v29
    v_and_b32 v30, 3, v0
    v_lshrrev_b32 v31, 1, v28
    v_lshlrev_b32 v31, 1, v31
    v_lshrrev_b32 v32, 1, v29
    v_add_u32 v31, v31, v32
    v_mul_u32_u24 v31, 36864, v31
    v_and_b32 v32, 1, v28
    v_lshlrev_b32 v32, 2, v32
    v_and_b32 v33, 1, v29
    v_add_u32 v32, v32, v33
    v_mul_u32_u24 v32, 1152, v32
    v_lshlrev_b32 v30, 3, v30
    v_add3_u32 v31, v31, v32, v30
    s_mul_i32 s39, s20, 288
    v_add_u32 v31, s39, v31
    s_waitcnt vmcnt(27)
    s_barrier
    ds_read_b64_tr_b16 v[44:45], v31 offset:0
    ds_read_b64_tr_b16 v[46:47], v31 offset:2304
    ds_read_b64_tr_b16 v[48:49], v31 offset:32
    ds_read_b64_tr_b16 v[50:51], v31 offset:2336
    ds_read_b64_tr_b16 v[52:53], v31 offset:64
    ds_read_b64_tr_b16 v[54:55], v31 offset:2368
    ds_read_b64_tr_b16 v[56:57], v31 offset:96
    ds_read_b64_tr_b16 v[58:59], v31 offset:2400
    ds_read_b64_tr_b16 v[60:61], v31 offset:128
    ds_read_b64_tr_b16 v[62:63], v31 offset:2432
    ds_read_b64_tr_b16 v[64:65], v31 offset:160
    ds_read_b64_tr_b16 v[66:67], v31 offset:2464
    s_waitcnt lgkmcnt(4)
    ds_read_b64_tr_b16 v[68:69], v31 offset:192
    ds_read_b64_tr_b16 v[70:71], v31 offset:2496
    ds_read_b64_tr_b16 v[72:73], v31 offset:224
    ds_read_b64_tr_b16 v[74:75], v31 offset:2528
    ds_read_b64_tr_b16 v[76:77], v31 offset:256
    ds_read_b64_tr_b16 v[78:79], v31 offset:2560
    s_waitcnt lgkmcnt(0)
    s_barrier
    ds_write_b128 v18, v[44:47] offset:0
    ds_write_b128 v18, v[48:51] offset:1024
    ds_write_b128 v18, v[52:55] offset:2048
    ds_write_b128 v18, v[56:59] offset:3072
    ds_write_b128 v18, v[60:63] offset:4096
    ds_write_b128 v18, v[64:67] offset:5120
    ds_write_b128 v18, v[68:71] offset:6144
    ds_write_b128 v18, v[72:75] offset:7168
    ds_write_b128 v18, v[76:79] offset:8192
    s_waitcnt lgkmcnt(0)
    s_waitcnt vmcnt(18)
    s_barrier
    ds_read_b64_tr_b16 v[44:45], v31 offset:9216
    ds_read_b64_tr_b16 v[46:47], v31 offset:11520
    ds_read_b64_tr_b16 v[48:49], v31 offset:9248
    ds_read_b64_tr_b16 v[50:51], v31 offset:11552
    ds_read_b64_tr_b16 v[52:53], v31 offset:9280
    ds_read_b64_tr_b16 v[54:55], v31 offset:11584
    ds_read_b64_tr_b16 v[56:57], v31 offset:9312
    ds_read_b64_tr_b16 v[58:59], v31 offset:11616
    ds_read_b64_tr_b16 v[60:61], v31 offset:9344
    ds_read_b64_tr_b16 v[62:63], v31 offset:11648
    ds_read_b64_tr_b16 v[64:65], v31 offset:9376
    ds_read_b64_tr_b16 v[66:67], v31 offset:11680
    s_waitcnt lgkmcnt(4)
    ds_read_b64_tr_b16 v[68:69], v31 offset:9408
    ds_read_b64_tr_b16 v[70:71], v31 offset:11712
    ds_read_b64_tr_b16 v[72:73], v31 offset:9440
    ds_read_b64_tr_b16 v[74:75], v31 offset:11744
    ds_read_b64_tr_b16 v[76:77], v31 offset:9472
    ds_read_b64_tr_b16 v[78:79], v31 offset:11776
    s_waitcnt lgkmcnt(0)
    s_barrier
    ds_write_b128 v18, v[44:47] offset:9216
    ds_write_b128 v18, v[48:51] offset:10240
    ds_write_b128 v18, v[52:55] offset:11264
    ds_write_b128 v18, v[56:59] offset:12288
    ds_write_b128 v18, v[60:63] offset:13312
    ds_write_b128 v18, v[64:67] offset:14336
    ds_write_b128 v18, v[68:71] offset:15360
    ds_write_b128 v18, v[72:75] offset:16384
    ds_write_b128 v18, v[76:79] offset:17408
    s_waitcnt lgkmcnt(0)
    s_waitcnt vmcnt(9)
    s_barrier
    ds_read_b64_tr_b16 v[44:45], v31 offset:18432
    ds_read_b64_tr_b16 v[46:47], v31 offset:20736
    ds_read_b64_tr_b16 v[48:49], v31 offset:18464
    ds_read_b64_tr_b16 v[50:51], v31 offset:20768
    ds_read_b64_tr_b16 v[52:53], v31 offset:18496
    ds_read_b64_tr_b16 v[54:55], v31 offset:20800
    ds_read_b64_tr_b16 v[56:57], v31 offset:18528
    ds_read_b64_tr_b16 v[58:59], v31 offset:20832
    ds_read_b64_tr_b16 v[60:61], v31 offset:18560
    ds_read_b64_tr_b16 v[62:63], v31 offset:20864
    ds_read_b64_tr_b16 v[64:65], v31 offset:18592
    ds_read_b64_tr_b16 v[66:67], v31 offset:20896
    s_waitcnt lgkmcnt(4)
    ds_read_b64_tr_b16 v[68:69], v31 offset:18624
    ds_read_b64_tr_b16 v[70:71], v31 offset:20928
    ds_read_b64_tr_b16 v[72:73], v31 offset:18656
    ds_read_b64_tr_b16 v[74:75], v31 offset:20960
    ds_read_b64_tr_b16 v[76:77], v31 offset:18688
    ds_read_b64_tr_b16 v[78:79], v31 offset:20992
    s_waitcnt lgkmcnt(0)
    s_barrier
    ds_write_b128 v18, v[44:47] offset:18432
    ds_write_b128 v18, v[48:51] offset:19456
    ds_write_b128 v18, v[52:55] offset:20480
    ds_write_b128 v18, v[56:59] offset:21504
    ds_write_b128 v18, v[60:63] offset:22528
    ds_write_b128 v18, v[64:67] offset:23552
    ds_write_b128 v18, v[68:71] offset:24576
    ds_write_b128 v18, v[72:75] offset:25600
    ds_write_b128 v18, v[76:79] offset:26624
    s_waitcnt lgkmcnt(0)
    s_waitcnt vmcnt(0)
    s_barrier
    ds_read_b64_tr_b16 v[44:45], v31 offset:27648
    ds_read_b64_tr_b16 v[46:47], v31 offset:29952
    ds_read_b64_tr_b16 v[48:49], v31 offset:27680
    ds_read_b64_tr_b16 v[50:51], v31 offset:29984
    ds_read_b64_tr_b16 v[52:53], v31 offset:27712
    ds_read_b64_tr_b16 v[54:55], v31 offset:30016
    ds_read_b64_tr_b16 v[56:57], v31 offset:27744
    ds_read_b64_tr_b16 v[58:59], v31 offset:30048
    ds_read_b64_tr_b16 v[60:61], v31 offset:27776
    ds_read_b64_tr_b16 v[62:63], v31 offset:30080
    ds_read_b64_tr_b16 v[64:65], v31 offset:27808
    ds_read_b64_tr_b16 v[66:67], v31 offset:30112
    s_waitcnt lgkmcnt(4)
    ds_read_b64_tr_b16 v[68:69], v31 offset:27840
    ds_read_b64_tr_b16 v[70:71], v31 offset:30144
    ds_read_b64_tr_b16 v[72:73], v31 offset:27872
    ds_read_b64_tr_b16 v[74:75], v31 offset:30176
    ds_read_b64_tr_b16 v[76:77], v31 offset:27904
    ds_read_b64_tr_b16 v[78:79], v31 offset:30208
    s_waitcnt lgkmcnt(0)
    s_barrier
    ds_write_b128 v18, v[44:47] offset:27648
    ds_write_b128 v18, v[48:51] offset:28672
    ds_write_b128 v18, v[52:55] offset:29696
    ds_write_b128 v18, v[56:59] offset:30720
    ds_write_b128 v18, v[60:63] offset:31744
    ds_write_b128 v18, v[64:67] offset:32768
    ds_write_b128 v18, v[68:71] offset:33792
    ds_write_b128 v18, v[72:75] offset:34816
    ds_write_b128 v18, v[76:79] offset:35840
    s_waitcnt lgkmcnt(0)
    s_waitcnt vmcnt(0) lgkmcnt(0)
    s_mov_b32 s44, 0
    s_lshl_b32 s37, s21, 4
    s_add_u32 s37, s37, 6029312
    v_lshrrev_b32 v21, 2, v1
Lsc_138:
    s_mov_b64 exec, 0xffff
    buffer_load_dword v20, v21, s[16:19], 0 offen sc1
    s_mov_b64 exec, 6
    buffer_load_dword v22, v21, s[8:11], s37 offen sc1
    buffer_load_dword v23, v21, s[8:11], s37 offen offset:512 sc1
    s_waitcnt vmcnt(0)
    v_readlane_b32 s38, v20, 9
    v_readlane_b32 s39, v20, 11
    v_readlane_b32 s40, v20, 10
    v_min_u32 v22, v22, v23
    v_cmp_eq_u32 vcc, 0, v22
    s_mov_b64 exec, -1
    s_cmp_lt_u32 s38, 32
    s_cbranch_scc1 Lsc_138r
    s_cmp_eq_u32 s39, 0
    s_cbranch_scc1 Lsc_138r
    s_cbranch_vccz Lsc_139
Lsc_138r:
    s_add_u32 s44, s44, 1
    s_cmp_gt_u32 s44, 3000000
    s_cbranch_scc1 L_tfail
    s_branch Lsc_138
Lsc_139:
    s_cmp_lg_u32 s20, 3
    s_cbranch_scc1 Lwm_140
    s_lshl_b32 s37, s21, 13
    s_add_u32 s37, s37, 23068672
    buffer_load_dword v24, v14, s[8:11], s37 offen sc1
    s_lshl_b32 s37, s21, 13
    s_add_u32 s37, s37, 39845888
    buffer_load_dword v24, v14, s[8:11], s37 offen sc1
Lwm_140:
    s_barrier
    s_cmp_lg_u32 s40, 0
    s_cbranch_scc1 L_slowteam
    s_mov_b32 s22, 0
    s_mov_b32 s26, 0
    s_mov_b32 s27, 294912
    s_mov_b32 s28, 589824
    s_mov_b32 s29, 884736
    s_mov_b32 s42, 893952
    s_mov_b32 s43, 903168
    s_lshl_b32 s45, s21, 13
    s_lshl_b32 s46, s21, 12
    s_mov_b32 s44, 0
    s_lshl_b32 s36, s20, 10
    s_lshl_b32 s47, s20, 11
    s_add_u32 s47, s47, s29
    s_add_u32 s49, s29, s36
    s_add_u32 s49, s49, 6144
    s_add_u32 s50, s45, 23068672
    s_add_u32 s51, s45, 39845888
    s_add_u32 s53, s46, s36
    s_add_u32 s56, s53, 65011712
    s_add_u32 s53, s53, 56623104
    s_add_u32 s52, s50, 262144
    s_add_u32 s37, s22, 2
    s_min_u32 s37, s37, 63
    s_lshl_b32 s37, s37, 9
    s_lshl_b32 s38, s21, 4
    s_add_u32 s6, s37, s38
    s_add_u32 s6, s6, 6029312
    s_lshl_b32 s37, s22, 9
    s_add_u32 s5, s37, s38
    s_add_u32 s5, s5, 6061568
    s_cmp_eq_u32 s22, 0
    s_cselect_b32 s5, 6131712, s5
    s_lshl_b32 s37, s20, 16
    s_add_u32 s58, s26, s37
    s_add_u32 s59, s58, 32768
    s_lshl_b32 s37, s20, 13
    s_add_u32 s60, s26, s37
    s_add_u32 s60, s60, 262144
    v_mov_b64 v[40:41], 0
    v_mov_b64 v[42:43], 0
    v_mov_b64 v[44:45], 0
    v_mov_b64 v[46:47], 0
    v_mov_b64 v[48:49], 0
    v_mov_b64 v[50:51], 0
    v_mov_b64 v[52:53], 0
    v_mov_b64 v[54:55], 0
    v_mov_b64 v[56:57], 0
    v_mov_b64 v[58:59], 0
    v_mov_b64 v[60:61], 0
    v_mov_b64 v[62:63], 0
    s_mul_i32 s36, s20, 4294966016
    s_add_u32 s36, s36, 6912
    v_add_u32 v20, s36, v12
    s_cmp_lg_u32 s20, 2
    s_cbranch_scc1 Lf_g3i
    v_lshrrev_b32 v20, 8, v1
    v_mul_u32_u24 v20, 2048, v20
    s_mov_b32 s41, 2048
    v_add3_u32 v20, v20, v19, s41
Lf_g3i:
    v_mov_b32 v0, 1
Lf_step:
    s_cmp_eq_u32 s20, 3
    s_cbranch_scc1 Lf_gdone
Lf_g3:
    buffer_load_dwordx4 v[24:27], v1, s[8:11], s47 offen sc1
    buffer_load_dwordx4 v[28:31], v1, s[8:11], s47 offen offset:1024 sc1
    buffer_load_dwordx4 v[32:35], v1, s[8:11], s49 offen sc1
    s_add_u32 s44, s44, 1
    s_cmp_gt_u32 s44, 3000000
    s_cbranch_scc1 L_tfail
    s_waitcnt vmcnt(1)
    v_max3_u32 v21, v24, v25, v26
    v_max3_u32 v22, v27, v28, v29
    v_max3_u32 v21, v21, v30, v31
    s_waitcnt vmcnt(0)
    v_max3_u32 v22, v22, v32, v33
    v_max3_u32 v21, v21, v34, v35
    v_max_u32 v21, v21, v22
    v_cmp_eq_u32 vcc, -1, v21
    s_cbranch_vccnz Lf_g3
    ds_write_b128 v12, v[24:27]
    ds_write_b128 v12, v[28:31] offset:1024
    ds_write_b128 v20, v[32:35]
    s_waitcnt lgkmcnt(0)
Lf_gdone:
    s_barrier
    ds_read_b128 v[24:27], v19 offset:0
    ds_read_b128 v[28:31], v19 offset:1024
    ds_read_b128 v[32:35], v19 offset:2048
    s_waitcnt lgkmcnt(2)
    v_smfmac_f32_16x16x64_bf16 v[40:43], v[24:27], a[0:7], v2
    v_smfmac_f32_16x16x64_bf16 v[48:51], v[24:27], a[144:151], v2
    ds_read_b128 v[36:39], v19 offset:3072
    v_smfmac_f32_16x16x64_bf16 v[44:47], v[24:27], a[8:15], v2
    v_smfmac_f32_16x16x64_bf16 v[52:55], v[24:27], a[152:159], v2
    s_waitcnt lgkmcnt(2)
    v_smfmac_f32_16x16x64_bf16 v[40:43], v[28:31], a[16:23], v2
    v_smfmac_f32_16x16x64_bf16 v[48:51], v[28:31], a[160:167], v2
    ds_read_b128 v[24:27], v19 offset:4096
    v_smfmac_f32_16x16x64_bf16 v[44:47], v[28:31], a[24:31], v2
    buffer_load_dwordx4 v[64:67], v13, s[8:11], s50 offen sc1
    v_smfmac_f32_16x16x64_bf16 v[52:55], v[28:31], a[168:175], v2
    s_waitcnt lgkmcnt(2)
    v_smfmac_f32_16x16x64_bf16 v[40:43], v[32:35], a[32:39], v2
    v_smfmac_f32_16x16x64_bf16 v[48:51], v[32:35], a[176:183], v2
    ds_read_b128 v[28:31], v19 offset:5120
    v_smfmac_f32_16x16x64_bf16 v[44:47], v[32:35], a[40:47], v2
    buffer_load_dwordx4 v[68:71], v13, s[8:11], s50 offen offset:256 sc1
    v_smfmac_f32_16x16x64_bf16 v[52:55], v[32:35], a[184:191], v2
    s_waitcnt lgkmcnt(2)
    v_smfmac_f32_16x16x64_bf16 v[40:43], v[36:39], a[48:55], v2
    v_smfmac_f32_16x16x64_bf16 v[48:51], v[36:39], a[192:199], v2
    ds_read_b128 v[32:35], v19 offset:6144
    v_smfmac_f32_16x16x64_bf16 v[44:47], v[36:39], a[56:63], v2
    v_smfmac_f32_16x16x64_bf16 v[52:55], v[36:39], a[200:207], v2
    s_waitcnt lgkmcnt(2)
    v_smfmac_f32_16x16x64_bf16 v[40:43], v[24:27], a[64:71], v2
    v_smfmac_f32_16x16x64_bf16 v[48:51], v[24:27], a[208:215], v2
    ds_read_b128 v[36:39], v19 offset:7168
    v_smfmac_f32_16x16x64_bf16 v[44:47], v[24:27], a[72:79], v2
    buffer_load_dwordx4 v[72:75], v13, s[8:11], s51 offen sc1
    v_smfmac_f32_16x16x64_bf16 v[52:55], v[24:27], a[216:223], v2
    s_waitcnt lgkmcnt(2)
    v_smfmac_f32_16x16x64_bf16 v[40:43], v[28:31], a[80:87], v2
    v_smfmac_f32_16x16x64_bf16 v[48:51], v[28:31], a[224:231], v2
    ds_read_b128 v[24:27], v19 offset:8192
    v_smfmac_f32_16x16x64_bf16 v[44:47], v[28:31], a[88:95], v2
    buffer_load_dwordx4 v[76:79], v13, s[8:11], s51 offen offset:256 sc1
    v_smfmac_f32_16x16x64_bf16 v[52:55], v[28:31], a[232:239], v2
    s_waitcnt lgkmcnt(2)
    v_smfmac_f32_16x16x64_bf16 v[40:43], v[32:35], a[96:103], v2
    v_smfmac_f32_16x16x64_bf16 v[48:51], v[32:35], a[240:247], v2
    v_smfmac_f32_16x16x64_bf16 v[44:47], v[32:35], a[104:111], v2
    v_smfmac_f32_16x16x64_bf16 v[52:55], v[32:35], a[248:255], v2
    s_waitcnt lgkmcnt(1)
    v_smfmac_f32_16x16x64_bf16 v[40:43], v[36:39], a[112:119], v2
    v_smfmac_f32_16x16x64_bf16 v[48:51], v[36:39], v[80:87], v2
    v_smfmac_f32_16x16x64_bf16 v[44:47], v[36:39], a[120:127], v2
    v_smfmac_f32_16x16x64_bf16 v[52:55], v[36:39], v[88:95], v2
    s_waitcnt lgkmcnt(0)
    v_smfmac_f32_16x16x64_bf16 v[40:43], v[24:27], a[128:135], v2
    v_smfmac_f32_16x16x64_bf16 v[48:51], v[24:27], v[96:103], v2
    v_smfmac_f32_16x16x64_bf16 v[44:47], v[24:27], a[136:143], v2
    v_smfmac_f32_16x16x64_bf16 v[52:55], v[24:27], v[104:111], v2
    s_cmp_eq_u32 s20, 3
    s_cbranch_scc0 Lf_noio
    buffer_load_dword v0, v14, s[8:11], s52 offen sc1
    s_add_u32 s52, s52, 16777216
    buffer_load_dword v0, v14, s[8:11], s52 offen sc1
    s_mov_b64 exec, 6
    v_lshrrev_b32 v20, 2, v1
    buffer_load_dword v0, v20, s[8:11], s6 offen sc1
    s_mov_b64 exec, 1
    v_mov_b32 v21, 1
    buffer_store_dword v21, off, s[8:11], s5 sc1
    s_mov_b64 exec, -1
Lf_noio:
    v_smfmac_f32_16x16x64_bf16 v[56:59], v[28:31], v[192:199], v2
    v_smfmac_f32_16x16x64_bf16 v[60:63], v[28:31], v[200:207], v2
    s_nop 2
    v_pk_add_f32 v[40:41], v[40:41], v[42:43]
    v_pk_add_f32 v[48:49], v[48:49], v[50:51]
    v_cvt_pk_bf16_f32 v42, v40, v41
    v_cvt_pk_bf16_f32 v43, v48, v49
    v_pk_add_f32 v[44:45], v[44:45], v[46:47]
    v_pk_add_f32 v[52:53], v[52:53], v[54:55]
    ds_write2_b32 v6, v42, v43 offset0:0 offset1:4
    v_cvt_pk_bf16_f32 v46, v44, v45
    v_cvt_pk_bf16_f32 v47, v52, v53
    ds_write2_b32 v6, v46, v47 offset0:160 offset1:164
    v_smfmac_f32_16x16x64_bf16 v[56:59], v[32:35], v[208:215], v2
    v_smfmac_f32_16x16x64_bf16 v[60:63], v[32:35], v[216:223], v2
    ds_read_b128 v[28:31], v19 offset:0
    v_smfmac_f32_16x16x64_bf16 v[56:59], v[36:39], v[224:231], v2
    s_waitcnt lgkmcnt(1)
    ds_read_b64_tr_b16 v[40:41], v7
    ds_read_b64_tr_b16 v[42:43], v7 offset:320
    v_smfmac_f32_16x16x64_bf16 v[60:63], v[36:39], v[232:239], v2
    ds_read_b128 v[32:35], v19 offset:1024
    v_smfmac_f32_16x16x64_bf16 v[56:59], v[24:27], v[240:247], v2
    v_smfmac_f32_16x16x64_bf16 v[60:63], v[24:27], v[248:255], v2
    ds_read_b128 v[36:39], v19 offset:2048
    s_cmp_eq_u32 s20, 3
    s_waitcnt lgkmcnt(2) vmcnt(6)
    s_cbranch_scc1 Lf_kw
    s_waitcnt vmcnt(2)
Lf_kw:
    v_mfma_f32_16x16x32_bf16 v[52:55], v[40:43], v[40:43], 0
    v_mfma_f32_16x16x32_bf16 v[44:47], v[64:67], v[40:43], 0
    v_mfma_f32_16x16x32_bf16 v[48:51], v[68:71], v[40:43], 0
    ds_read_b128 v[24:27], v19 offset:3072
    v_smfmac_f32_16x16x64_bf16 v[56:59], v[28:31], v[112:119], v2
    v_smfmac_f32_16x16x64_bf16 v[60:63], v[28:31], v[120:127], v2
    s_nop 2
    s_mov_b64 exec, s[34:35]
    ds_write_b128 v9, v[52:55]
    s_mov_b64 exec, s[30:31]
    ds_write_b128 v8, v[44:47]
    ds_write_b128 v8, v[48:51] offset:128
    s_mov_b64 exec, -1
    s_waitcnt lgkmcnt(3)
    v_smfmac_f32_16x16x64_bf16 v[56:59], v[32:35], v[128:135], v2
    v_smfmac_f32_16x16x64_bf16 v[60:63], v[32:35], v[136:143], v2
    s_not_b64 exec, s[30:31]
    buffer_store_dwordx4 v[40:43], v1, s[8:11], s53 offen sc1
    s_mov_b64 exec, -1
    ds_read_b128 v[28:31], v19 offset:4096
    v_smfmac_f32_16x16x64_bf16 v[56:59], v[36:39], v[144:151], v2
    v_smfmac_f32_16x16x64_bf16 v[60:63], v[36:39], v[152:159], v2
    s_waitcnt lgkmcnt(1)
    s_barrier
    ds_read_b128 v[64:67], v19 offset:11776
    ds_read_b128 v[68:71], v19 offset:13056
    ds_read_b64 v[40:41], v10 offset:0
    ds_read_b64 v[42:43], v10 offset:1280
    v_smfmac_f32_16x16x64_bf16 v[56:59], v[24:27], v[160:167], v2
    v_smfmac_f32_16x16x64_bf16 v[60:63], v[24:27], v[168:175], v2
    ds_read_b128 v[32:35], v19 offset:9216
    ds_read_b128 v[36:39], v19 offset:10496
    ds_read_b64 v[44:45], v10 offset:2560
    ds_read_b64 v[46:47], v10 offset:3840
    s_waitcnt lgkmcnt(8)
    v_smfmac_f32_16x16x64_bf16 v[56:59], v[28:31], v[176:183], v2
    v_smfmac_f32_16x16x64_bf16 v[60:63], v[28:31], v[184:191], v2
    s_cmp_eq_u32 s22, 63
    s_waitcnt lgkmcnt(4)
    v_pk_add_f32 v[64:65], v[64:65], v[68:69]
    v_pk_add_f32 v[66:67], v[66:67], v[70:71]
    v_pk_add_f32 v[40:41], v[40:41], v[42:43]
    s_waitcnt lgkmcnt(0)
    v_pk_add_f32 v[32:33], v[32:33], v[36:37]
    v_pk_add_f32 v[34:35], v[34:35], v[38:39]
    v_pk_add_f32 v[44:45], v[44:45], v[46:47]
    v_pk_add_f32 v[32:33], v[32:33], v[64:65]
    v_pk_add_f32 v[34:35], v[34:35], v[66:67]
    v_pk_add_f32 v[40:41], v[40:41], v[44:45]
    v_max3_f32 v20, v32, v33, v34
    v_max3_f32 v21, v35, v40, v41
    v_max_f32 v20, v20, v21
    v_pk_add_f32 v[60:61], v[60:61], v[62:63]
    v_pk_add_f32 v[56:57], v[56:57], v[58:59]
    v_max_f32_dpp v20, v20, v20 row_ror:8 row_mask:0xf bank_mask:0xf
    v_cvt_pk_bf16_f32 v58, v60, v61
    v_mov_b32 v21, v20
    v_cvt_pk_bf16_f32 v56, v56, v57
    v_mov_b32 v57, 0
    v_permlane16_swap_b32 v20, v21
    v_max_f32 v20, v20, v21
    v_mov_b32 v21, v20
    v_mov_b32 v59, 0
    v_mov_b32 v43, 0
    v_permlane32_swap_b32 v20, v21
    v_max_f32 v20, v20, v21
    v_mul_f32 v20, s54, v20
    s_cbranch_scc1 Lf_last
    v_pk_fma_f32 v[32:33], v[32:33], s[54:55], v[20:21] op_sel_hi:[1,1,0] neg_lo:[0,0,1] neg_hi:[0,0,1]
    v_pk_fma_f32 v[34:35], v[34:35], s[54:55], v[20:21] op_sel_hi:[1,1,0] neg_lo:[0,0,1] neg_hi:[0,0,1]
    v_pk_fma_f32 v[40:41], v[40:41], s[54:55], v[20:21] op_sel_hi:[1,1,0] neg_lo:[0,0,1] neg_hi:[0,0,1]
    v_exp_f32 v32, v32
    v_exp_f32 v33, v33
    ds_read_b128 v[64:67], v18 offset:8192
    ds_read_b128 v[68:71], v18 offset:17408
    v_exp_f32 v34, v34
    v_exp_f32 v35, v35
    v_mov_b32 v52, 0x3f803f80
    v_cvt_pk_bf16_f32 v36, v32, v33
    v_exp_f32 v40, v40
    v_cvt_pk_bf16_f32 v37, v34, v35
    v_exp_f32 v41, v41
    v_mov_b32 v53, 0x3f803f80
    v_mov_b32_dpp v38, v36 row_ror:8 row_mask:0xf bank_mask:0xf
    v_mov_b32_dpp v39, v37 row_ror:8 row_mask:0xf bank_mask:0xf
    v_mov_b32 v54, 0x3f803f80
    v_mov_b32 v55, 0x3f803f80
    v_cvt_pk_bf16_f32 v42, v40, v41
    v_mov_b32 v48, 0x3f803f80
    v_mov_b32 v49, 0
    s_cmp_eq_u32 s20, 3
    s_waitcnt vmcnt(5)
    s_cbranch_scc1 Lf_vw
    s_waitcnt vmcnt(1)
Lf_vw:
    v_mfma_f32_16x16x32_bf16 v[24:27], v[52:55], v[36:39], 0
    v_mfma_f32_16x16x32_bf16 v[44:47], v[72:75], v[36:39], 0
    v_mfma_f32_16x16x32_bf16 v[28:31], v[76:79], v[36:39], 0
    buffer_store_dwordx4 v[56:59], v1, s[8:11], s56 offen sc1
    s_nop 2
    v_mfma_f32_16x16x16_bf16 v[24:27], v[48:49], v[42:43], v[24:27]
    v_mfma_f32_16x16x16_bf16 v[44:47], v[56:57], v[42:43], v[44:47]
    v_mfma_f32_16x16x16_bf16 v[28:31], v[58:59], v[42:43], v[28:31]
    ds_read_b128 v[72:75], v18 offset:26624
    ds_read_b128 v[76:79], v18 offset:35840
    ds_read_b128 v[32:35], v18 offset:18432
    s_nop 2
    v_rcp_f32 v20, v24
    ds_read_b128 v[36:39], v18 offset:27648
    v_pk_mul_f32 v[44:45], v[44:45], v[20:21] op_sel_hi:[1,0]
    v_pk_mul_f32 v[46:47], v[46:47], v[20:21] op_sel_hi:[1,0]
    v_pk_mul_f32 v[28:29], v[28:29], v[20:21] op_sel_hi:[1,0]
    v_pk_mul_f32 v[30:31], v[30:31], v[20:21] op_sel_hi:[1,0]
    v_cvt_pk_bf16_f32 v44, v44, v45
    v_cvt_pk_bf16_f32 v45, v46, v47
    v_cvt_pk_bf16_f32 v28, v28, v29
    v_cvt_pk_bf16_f32 v29, v30, v31
    s_mov_b64 exec, s[30:31]
    ds_write_b64 v11, v[44:45]
    ds_write_b64 v11, v[28:29] offset:256
    s_mov_b64 exec, -1
    v_mov_b64 v[40:41], 0
    v_mov_b64 v[42:43], 0
    v_mov_b64 v[52:53], 0
    v_mov_b64 v[54:55], 0
    s_waitcnt lgkmcnt(0)
    ds_read_b128 v[24:27], v18 offset:0
    ds_read_b128 v[28:31], v18 offset:9216
    s_barrier
    ds_read_b128 v[44:47], v19
    ds_read_b128 v[48:51], v19 offset:1024
    s_waitcnt lgkmcnt(0)
    s_nop 0
    v_smfmac_f32_16x16x64_bf16 v[40:43], v[44:47], v[64:71], v2
    v_smfmac_f32_16x16x64_bf16 v[40:43], v[48:51], v[72:79], v2
    ds_read_b128 v[64:67], v18 offset:1024
    ds_read_b128 v[68:71], v18 offset:10240
    s_nop 0
    v_smfmac_f32_16x16x64_bf16 v[52:55], v[44:47], v[24:31], v2
    ds_read_b128 v[72:75], v18 offset:19456
    ds_read_b128 v[76:79], v18 offset:28672
    v_smfmac_f32_16x16x64_bf16 v[52:55], v[48:51], v[32:39], v2
    ds_read_b128 v[24:27], v18 offset:2048
    ds_read_b128 v[28:31], v18 offset:11264
    v_pk_add_f32 v[40:41], v[40:41], v[42:43]
    v_cvt_pk_bf16_f32 v56, v40, v41
    v_mov_b64 v[40:41], 0
    v_mov_b64 v[42:43], 0
    v_mov_b32 v57, v56
    s_waitcnt lgkmcnt(2)
    v_smfmac_f32_16x16x64_bf16 v[40:43], v[44:47], v[64:71], v2
    ds_read_b128 v[32:35], v18 offset:20480
    ds_read_b128 v[36:39], v18 offset:29696
    v_smfmac_f32_16x16x64_bf16 v[40:43], v[48:51], v[72:79], v2
    ds_read_b128 v[64:67], v18 offset:3072
    ds_read_b128 v[68:71], v18 offset:12288
    v_pk_add_f32 v[52:53], v[52:53], v[54:55]
    v_cvt_pk_bf16_f32 v20, v52, v53
    v_mov_b64 v[52:53], 0
    v_mov_b64 v[54:55], 0
    v_permlane16_swap_b32 v56, v57
    v_mov_b32 v58, v56
    v_mov_b32 v59, v57
    s_waitcnt lgkmcnt(2)
    v_smfmac_f32_16x16x64_bf16 v[52:55], v[44:47], v[24:31], v2
    ds_read_b128 v[72:75], v18 offset:21504
    ds_read_b128 v[76:79], v18 offset:30720
    v_smfmac_f32_16x16x64_bf16 v[52:55], v[48:51], v[32:39], v2
    ds_read_b128 v[24:27], v18 offset:4096
    ds_read_b128 v[28:31], v18 offset:13312
    v_pk_add_f32 v[40:41], v[40:41], v[42:43]
    v_cvt_pk_bf16_f32 v21, v40, v41
    v_mov_b64 v[40:41], 0
    v_mov_b64 v[42:43], 0
    v_permlane32_swap_b32 v56, v58
    v_permlane32_swap_b32 v57, v59
    s_mov_b64 exec, 0xffff
    buffer_store_dwordx4 v[56:59], v3, s[8:11], s60 offen
    s_mov_b64 exec, -1
    s_waitcnt lgkmcnt(2)
    v_smfmac_f32_16x16x64_bf16 v[40:43], v[44:47], v[64:71], v2
    ds_read_b128 v[32:35], v18 offset:22528
    ds_read_b128 v[36:39], v18 offset:31744
    v_smfmac_f32_16x16x64_bf16 v[40:43], v[48:51], v[72:79], v2
    ds_read_b128 v[64:67], v18 offset:5120
    ds_read_b128 v[68:71], v18 offset:14336
    v_pk_add_f32 v[52:53], v[52:53], v[54:55]
    v_cvt_pk_bf16_f32 v22, v52, v53
    v_mov_b64 v[52:53], 0
    v_mov_b64 v[54:55], 0
    s_nop 0
    ds_read_b128 v[56:59], v18 offset:23552
    ds_read_b128 v[60:63], v18 offset:32768
    s_waitcnt lgkmcnt(4)
    v_smfmac_f32_16x16x64_bf16 v[52:55], v[44:47], v[24:31], v2
    ds_read_b128 v[72:75], v18 offset:6144
    ds_read_b128 v[76:79], v18 offset:15360
    v_smfmac_f32_16x16x64_bf16 v[52:55], v[48:51], v[32:39], v2
    ds_read_b128 v[24:27], v18 offset:24576
    ds_read_b128 v[28:31], v18 offset:33792
    v_pk_add_f32 v[40:41], v[40:41], v[42:43]
    v_cvt_pk_bf16_f32 v23, v40, v41
    v_mov_b64 v[40:41], 0
    v_mov_b64 v[42:43], 0
    buffer_store_dwordx4 v[20:23], v3, s[8:11], s58 offen
    s_waitcnt lgkmcnt(4)
    v_smfmac_f32_16x16x64_bf16 v[40:43], v[44:47], v[64:71], v2
    ds_read_b128 v[32:35], v18 offset:7168
    ds_read_b128 v[36:39], v18 offset:16384
    v_smfmac_f32_16x16x64_bf16 v[40:43], v[48:51], v[56:63], v2
    ds_read_b128 v[64:67], v18 offset:25600
    ds_read_b128 v[68:71], v18 offset:34816
    v_pk_add_f32 v[52:53], v[52:53], v[54:55]
    v_cvt_pk_bf16_f32 v20, v52, v53
    v_mov_b64 v[52:53], 0
    v_mov_b64 v[54:55], 0
    s_nop 0
    s_waitcnt lgkmcnt(4)
    v_smfmac_f32_16x16x64_bf16 v[52:55], v[44:47], v[72:79], v2
    v_smfmac_f32_16x16x64_bf16 v[52:55], v[48:51], v[24:31], v2
    s_nop 3
    v_pk_add_f32 v[40:41], v[40:41], v[42:43]
    v_cvt_pk_bf16_f32 v21, v40, v41
    v_mov_b64 v[40:41], 0
    v_mov_b64 v[42:43], 0
    s_nop 0
    s_waitcnt lgkmcnt(0)
    v_smfmac_f32_16x16x64_bf16 v[40:43], v[44:47], v[32:39], v2
    v_smfmac_f32_16x16x64_bf16 v[40:43], v[48:51], v[64:71], v2
    s_nop 3
    v_pk_add_f32 v[52:53], v[52:53], v[54:55]
    v_cvt_pk_bf16_f32 v22, v52, v53
    s_nop 4
    v_pk_add_f32 v[40:41], v[40:41], v[42:43]
    v_cvt_pk_bf16_f32 v23, v40, v41
    buffer_store_dwordx4 v[20:23], v3, s[8:11], s59 offen
    s_cmp_eq_u32 s23, 0
    s_cbranch_scc0 Lf_red
    s_mov_b32 s98, s28
    s_add_u32 s99, s28, 4096
    s_mov_b32 s97, s6
    s_mov_b32 s36, s28
    s_mov_b32 s28, s26
    s_mov_b32 s26, s27
    s_mov_b32 s27, s36
    s_mov_b32 s36, s29
    s_mov_b32 s29, s42
    s_mov_b32 s42, s43
    s_mov_b32 s43, s36
    s_add_u32 s45, s45, 262144
    s_add_u32 s46, s46, 131072
    s_add_u32 s22, s22, 1
    s_lshl_b32 s36, s20, 10
    s_lshl_b32 s47, s20, 11
    s_add_u32 s47, s47, s29
    s_add_u32 s49, s29, s36
    s_add_u32 s49, s49, 6144
    s_add_u32 s50, s45, 23068672
    s_add_u32 s51, s45, 39845888
    s_add_u32 s53, s46, s36
    s_add_u32 s56, s53, 65011712
    s_add_u32 s53, s53, 56623104
    s_add_u32 s52, s50, 262144
    s_add_u32 s37, s22, 2
    s_min_u32 s37, s37, 63
    s_lshl_b32 s37, s37, 9
    s_lshl_b32 s38, s21, 4
    s_add_u32 s6, s37, s38
    s_add_u32 s6, s6, 6029312
    s_lshl_b32 s37, s22, 9
    s_add_u32 s5, s37, s38
    s_add_u32 s5, s5, 6061568
    s_cmp_eq_u32 s22, 0
    s_cselect_b32 s5, 6131712, s5
    s_lshl_b32 s37, s20, 16
    s_add_u32 s58, s26, s37
    s_add_u32 s59, s58, 32768
    s_lshl_b32 s37, s20, 13
    s_add_u32 s60, s26, s37
    s_add_u32 s60, s60, 262144
    v_mov_b64 v[56:57], 0
    v_mov_b64 v[58:59], 0
    v_mov_b64 v[60:61], 0
    v_mov_b64 v[62:63], 0
    s_cmp_lg_u32 s20, 3
    s_cbranch_scc1 Lf_kvok
    s_waitcnt vmcnt(6)
    s_mov_b64 exec, 6
Lf_kvlp:
    v_cmp_eq_u32 vcc, 0, v0
    s_cbranch_vccz Lf_kvok
    s_add_u32 s44, s44, 1
    s_cmp_gt_u32 s44, 3000000
    s_cbranch_scc1 L_tfail
    v_lshrrev_b32 v21, 2, v1
    buffer_load_dword v0, v21, s[8:11], s97 offen sc1
    s_waitcnt vmcnt(0)
    s_branch Lf_kvlp
Lf_kvok:
    s_mov_b64 exec, -1
    s_cmp_eq_u32 s25, 0
    s_cbranch_scc1 Lf_norst
    s_sleep 7
    s_nop 7
    v_mov_b32 v20, -1
    v_mov_b32 v21, -1
    v_mov_b32 v22, -1
    v_mov_b32 v23, -1
    buffer_store_dwordx4 v[20:23], v4, s[8:11], s98 offen offset:0
    buffer_store_dwordx4 v[20:23], v4, s[8:11], s98 offen offset:1024
    buffer_store_dwordx4 v[20:23], v4, s[8:11], s98 offen offset:2048
    buffer_store_dwordx4 v[20:23], v4, s[8:11], s98 offen offset:3072
    buffer_store_dwordx4 v[20:23], v4, s[8:11], s99 offen offset:0
    buffer_store_dwordx4 v[20:23], v4, s[8:11], s99 offen offset:1024
    buffer_store_dwordx4 v[20:23], v4, s[8:11], s99 offen offset:2048
    buffer_store_dwordx4 v[20:23], v4, s[8:11], s99 offen offset:3072
    s_sleep 2
    s_nop 7
    s_branch Lf_nored
Lf_norst:
    s_sleep 8
    s_sleep 4
    s_nop 7
    s_branch Lf_nored
Lf_red:
    s_mov_b32 s94, s26
    s_add_u32 s95, s26, 4096
    s_mov_b32 s96, s42
    s_mov_b32 s97, s43
    s_cmp_eq_u32 s7, 0
    s_cbranch_scc0 Lf_early
    v_mov_b32 v22, -1
    v_mov_b32 v23, -1
    s_mov_b64 exec, s[30:31]
    buffer_store_dwordx2 v[22:23], v5, s[8:11], s97 offen
    s_mov_b64 exec, -1
    s_mov_b32 s36, s28
    s_mov_b32 s28, s26
    s_mov_b32 s26, s27
    s_mov_b32 s27, s36
    s_mov_b32 s36, s29
    s_mov_b32 s29, s42
    s_mov_b32 s42, s43
    s_mov_b32 s43, s36
    s_add_u32 s45, s45, 262144
    s_add_u32 s46, s46, 131072
    s_add_u32 s22, s22, 1
    s_lshl_b32 s36, s20, 10
    s_lshl_b32 s47, s20, 11
    s_add_u32 s47, s47, s29
    s_add_u32 s49, s29, s36
    s_add_u32 s49, s49, 6144
    s_add_u32 s50, s45, 23068672
    s_add_u32 s51, s45, 39845888
    s_add_u32 s53, s46, s36
    s_add_u32 s56, s53, 65011712
    s_add_u32 s53, s53, 56623104
    s_add_u32 s52, s50, 262144
    s_add_u32 s37, s22, 2
    s_min_u32 s37, s37, 63
    s_lshl_b32 s37, s37, 9
    s_lshl_b32 s38, s21, 4
    s_add_u32 s6, s37, s38
    s_add_u32 s6, s6, 6029312
    s_lshl_b32 s37, s22, 9
    s_add_u32 s5, s37, s38
    s_add_u32 s5, s5, 6061568
    s_cmp_eq_u32 s22, 0
    s_cselect_b32 s5, 6131712, s5
    s_lshl_b32 s37, s20, 16
    s_add_u32 s58, s26, s37
    s_add_u32 s59, s58, 32768
    s_lshl_b32 s37, s20, 13
    s_add_u32 s60, s26, s37
    s_add_u32 s60, s60, 262144
    v_mov_b64 v[56:57], 0
    v_mov_b64 v[58:59], 0
    v_mov_b64 v[60:61], 0
    v_mov_b64 v[62:63], 0
    s_sleep 2
    s_nop 9
Lf_rl:
    buffer_load_dwordx4 v[24:27], v4, s[8:11], s94 offen offset:0 sc1
    buffer_load_dwordx4 v[28:31], v4, s[8:11], s94 offen offset:1024 sc1
    buffer_load_dwordx4 v[32:35], v4, s[8:11], s94 offen offset:2048 sc1
    buffer_load_dwordx4 v[36:39], v4, s[8:11], s94 offen offset:3072 sc1
    buffer_load_dwordx4 v[40:43], v4, s[8:11], s95 offen offset:0 sc1
    buffer_load_dwordx4 v[44:47], v4, s[8:11], s95 offen offset:1024 sc1
    buffer_load_dwordx4 v[48:51], v4, s[8:11], s95 offen offset:2048 sc1
    buffer_load_dwordx4 v[52:55], v4, s[8:11], s95 offen offset:3072 sc1
    s_add_u32 s44, s44, 1
    s_cmp_gt_u32 s44, 3000000
    s_cbranch_scc1 L_tfail
    s_waitcnt vmcnt(7)
    v_mfma_f32_16x16x32_bf16 v[64:67], v[24:27], v[14:17], 0
    v_max3_u32 v20, v24, v25, v26
    v_max_u32 v20, v20, v27
    s_waitcnt vmcnt(6)
    v_mfma_f32_16x16x32_bf16 v[64:67], v[28:31], v[14:17], v[64:67]
    v_max3_u32 v20, v20, v28, v29
    v_max3_u32 v20, v20, v30, v31
    s_waitcnt vmcnt(5)
    v_mfma_f32_16x16x32_bf16 v[64:67], v[32:35], v[14:17], v[64:67]
    v_max3_u32 v20, v20, v32, v33
    v_max3_u32 v20, v20, v34, v35
    s_waitcnt vmcnt(4)
    v_mfma_f32_16x16x32_bf16 v[64:67], v[36:39], v[14:17], v[64:67]
    v_max3_u32 v20, v20, v36, v37
    v_max3_u32 v20, v20, v38, v39
    s_waitcnt vmcnt(3)
    v_mfma_f32_16x16x32_bf16 v[64:67], v[40:43], v[14:17], v[64:67]
    v_max3_u32 v20, v20, v40, v41
    v_max3_u32 v20, v20, v42, v43
    s_waitcnt vmcnt(2)
    v_mfma_f32_16x16x32_bf16 v[64:67], v[44:47], v[14:17], v[64:67]
    v_max3_u32 v20, v20, v44, v45
    v_max3_u32 v20, v20, v46, v47
    s_waitcnt vmcnt(1)
    v_mfma_f32_16x16x32_bf16 v[64:67], v[48:51], v[14:17], v[64:67]
    v_max3_u32 v20, v20, v48, v49
    v_max3_u32 v20, v20, v50, v51
    s_waitcnt vmcnt(0)
    v_mfma_f32_16x16x32_bf16 v[64:67], v[52:55], v[14:17], v[64:67]
    v_max3_u32 v20, v20, v52, v53
    v_max3_u32 v20, v20, v54, v55
    v_cmp_eq_u32 vcc, -1, v20
    s_cbranch_vccnz Lf_rl
Lf_rok:
    s_nop 3
    v_cvt_pk_bf16_f32 v64, v64, v65
    v_cvt_pk_bf16_f32 v65, v66, v67
    s_mov_b64 exec, s[30:31]
    buffer_store_dwordx2 v[64:65], v5, s[8:11], s96 offen
    s_mov_b64 exec, -1
Lf_nored:
    s_mul_i32 s36, s20, 4294966016
    s_add_u32 s36, s36, 6912
    v_add_u32 v20, s36, v12
    s_cmp_lg_u32 s20, 2
    s_cbranch_scc1 Lf_g3n
    v_lshrrev_b32 v20, 8, v1
    v_mul_u32_u24 v20, 2048, v20
    s_mov_b32 s41, 2048
    v_add3_u32 v20, v20, v19, s41
Lf_g3n:
    v_mov_b64 v[40:41], 0
    v_mov_b64 v[42:43], 0
    v_mov_b64 v[44:45], 0
    v_mov_b64 v[46:47], 0
    v_mov_b64 v[48:49], 0
    v_mov_b64 v[50:51], 0
    v_mov_b64 v[52:53], 0
    v_mov_b64 v[54:55], 0
    s_barrier
    s_branch Lf_step
Lf_last:
    buffer_store_dwordx4 v[56:59], v1, s[8:11], s56 offen sc1
    s_branch L_tdone
Lf_early:
    buffer_load_dwordx4 v[24:27], v4, s[8:11], s94 offen offset:0 sc1
    buffer_load_dwordx4 v[28:31], v4, s[8:11], s94 offen offset:1024 sc1
    buffer_load_dwordx4 v[32:35], v4, s[8:11], s94 offen offset:2048 sc1
    buffer_load_dwordx4 v[36:39], v4, s[8:11], s94 offen offset:3072 sc1
    buffer_load_dwordx4 v[40:43], v4, s[8:11], s95 offen offset:0 sc1
    buffer_load_dwordx4 v[44:47], v4, s[8:11], s95 offen offset:1024 sc1
    buffer_load_dwordx4 v[48:51], v4, s[8:11], s95 offen offset:2048 sc1
    buffer_load_dwordx4 v[52:55], v4, s[8:11], s95 offen offset:3072 sc1
    v_mov_b32 v22, -1
    v_mov_b32 v23, -1
    s_mov_b64 exec, s[30:31]
    buffer_store_dwordx2 v[22:23], v5, s[8:11], s97 offen
    s_mov_b64 exec, -1
    s_mov_b32 s36, s28
    s_mov_b32 s28, s26
    s_mov_b32 s26, s27
    s_mov_b32 s27, s36
    s_mov_b32 s36, s29
    s_mov_b32 s29, s42
    s_mov_b32 s42, s43
    s_mov_b32 s43, s36
    s_add_u32 s45, s45, 262144
    s_add_u32 s46, s46, 131072
    s_add_u32 s22, s22, 1
    s_lshl_b32 s36, s20, 10
    s_lshl_b32 s47, s20, 11
    s_add_u32 s47, s47, s29
    s_add_u32 s49, s29, s36
    s_add_u32 s49, s49, 6144
    s_add_u32 s50, s45, 23068672
    s_add_u32 s51, s45, 39845888
    s_add_u32 s53, s46, s36
    s_add_u32 s56, s53, 65011712
    s_add_u32 s53, s53, 56623104
    s_add_u32 s52, s50, 262144
    s_add_u32 s37, s22, 2
    s_min_u32 s37, s37, 63
    s_lshl_b32 s37, s37, 9
    s_lshl_b32 s38, s21, 4
    s_add_u32 s6, s37, s38
    s_add_u32 s6, s6, 6029312
    s_lshl_b32 s37, s22, 9
    s_add_u32 s5, s37, s38
    s_add_u32 s5, s5, 6061568
    s_cmp_eq_u32 s22, 0
    s_cselect_b32 s5, 6131712, s5
    s_lshl_b32 s37, s20, 16
    s_add_u32 s58, s26, s37
    s_add_u32 s59, s58, 32768
    s_lshl_b32 s37, s20, 13
    s_add_u32 s60, s26, s37
    s_add_u32 s60, s60, 262144
    v_mov_b64 v[56:57], 0
    v_mov_b64 v[58:59], 0
    v_mov_b64 v[60:61], 0
    v_mov_b64 v[62:63], 0
    s_waitcnt vmcnt(8)
    v_mfma_f32_16x16x32_bf16 v[64:67], v[24:27], v[14:17], 0
    v_max3_u32 v20, v24, v25, v26
    v_max_u32 v20, v20, v27
    s_waitcnt vmcnt(7)
    v_mfma_f32_16x16x32_bf16 v[64:67], v[28:31], v[14:17], v[64:67]
    v_max3_u32 v20, v20, v28, v29
    v_max3_u32 v20, v20, v30, v31
    s_waitcnt vmcnt(6)
    v_mfma_f32_16x16x32_bf16 v[64:67], v[32:35], v[14:17], v[64:67]
    v_max3_u32 v20, v20, v32, v33
    v_max3_u32 v20, v20, v34, v35
    s_waitcnt vmcnt(5)
    v_mfma_f32_16x16x32_bf16 v[64:67], v[36:39], v[14:17], v[64:67]
    v_max3_u32 v20, v20, v36, v37
    v_max3_u32 v20, v20, v38, v39
    s_waitcnt vmcnt(4)
    v_mfma_f32_16x16x32_bf16 v[64:67], v[40:43], v[14:17], v[64:67]
    v_max3_u32 v20, v20, v40, v41
    v_max3_u32 v20, v20, v42, v43
    s_waitcnt vmcnt(3)
    v_mfma_f32_16x16x32_bf16 v[64:67], v[44:47], v[14:17], v[64:67]
    v_max3_u32 v20, v20, v44, v45
    v_max3_u32 v20, v20, v46, v47
    s_waitcnt vmcnt(2)
    v_mfma_f32_16x16x32_bf16 v[64:67], v[48:51], v[14:17], v[64:67]
    v_max3_u32 v20, v20, v48, v49
    v_max3_u32 v20, v20, v50, v51
    s_waitcnt vmcnt(1)
    v_mfma_f32_16x16x32_bf16 v[64:67], v[52:55], v[14:17], v[64:67]
    v_max3_u32 v20, v20, v52, v53
    v_max3_u32 v20, v20, v54, v55
    v_cmp_eq_u32 vcc, -1, v20
    s_cbranch_vccnz Lf_rl
    s_branch Lf_rok
L_slowteam:
    s_mov_b32 s22, 0
    s_mov_b32 s26, 0
    s_mov_b32 s27, 294912
    s_mov_b32 s28, 589824
    s_mov_b32 s29, 884736
    s_mov_b32 s42, 893952
    s_mov_b32 s43, 903168
    s_lshl_b32 s45, s21, 13
    s_lshl_b32 s46, s21, 12
    s_mov_b32 s44, 0
    s_lshl_b32 s36, s20, 10
    s_lshl_b32 s47, s20, 11
    s_add_u32 s47, s47, s29
    s_add_u32 s49, s29, s36
    s_add_u32 s49, s49, 6144
    s_add_u32 s50, s45, 23068672
    s_add_u32 s51, s45, 39845888
    s_add_u32 s53, s46, s36
    s_add_u32 s56, s53, 65011712
    s_add_u32 s53, s53, 56623104
    s_add_u32 s52, s50, 262144
    s_add_u32 s37, s22, 2
    s_min_u32 s37, s37, 63
    s_lshl_b32 s37, s37, 9
    s_lshl_b32 s38, s21, 4
    s_add_u32 s6, s37, s38
    s_add_u32 s6, s6, 6029312
    s_lshl_b32 s37, s22, 9
    s_add_u32 s5, s37, s38
    s_add_u32 s5, s5, 6061568
    s_cmp_eq_u32 s22, 0
    s_cselect_b32 s5, 6131712, s5
    s_lshl_b32 s37, s20, 16
    s_add_u32 s58, s26, s37
    s_add_u32 s59, s58, 32768
    s_lshl_b32 s37, s20, 13
    s_add_u32 s60, s26, s37
    s_add_u32 s60, s60, 262144
    v_mov_b64 v[40:41], 0
    v_mov_b64 v[42:43], 0
    v_mov_b64 v[44:45], 0
    v_mov_b64 v[46:47], 0
    v_mov_b64 v[48:49], 0
    v_mov_b64 v[50:51], 0
    v_mov_b64 v[52:53], 0
    v_mov_b64 v[54:55], 0
    v_mov_b64 v[56:57], 0
    v_mov_b64 v[58:59], 0
    v_mov_b64 v[60:61], 0
    v_mov_b64 v[62:63], 0
    s_mul_i32 s36, s20, 4294966016
    s_add_u32 s36, s36, 6912
    v_add_u32 v20, s36, v12
    s_cmp_lg_u32 s20, 2
    s_cbranch_scc1 Ls_g3i
    v_lshrrev_b32 v20, 8, v1
    v_mul_u32_u24 v20, 2048, v20
    s_mov_b32 s41, 2048
    v_add3_u32 v20, v20, v19, s41
Ls_g3i:
    v_mov_b32 v0, 1
Ls_step:
    s_cmp_eq_u32 s20, 3
    s_cbranch_scc1 Ls_gdone
Ls_g3:
    buffer_load_dwordx4 v[24:27], v1, s[8:11], s47 offen sc1
    buffer_load_dwordx4 v[28:31], v1, s[8:11], s47 offen offset:1024 sc1
    buffer_load_dwordx4 v[32:35], v1, s[8:11], s49 offen sc1
    s_add_u32 s44, s44, 1
    s_cmp_gt_u32 s44, 3000000
    s_cbranch_scc1 L_tfail
    s_waitcnt vmcnt(1)
    v_max3_u32 v21, v24, v25, v26
    v_max3_u32 v22, v27, v28, v29
    v_max3_u32 v21, v21, v30, v31
    s_waitcnt vmcnt(0)
    v_max3_u32 v22, v22, v32, v33
    v_max3_u32 v21, v21, v34, v35
    v_max_u32 v21, v21, v22
    v_cmp_eq_u32 vcc, -1, v21
    s_cbranch_vccnz Ls_g3
    ds_write_b128 v12, v[24:27]
    ds_write_b128 v12, v[28:31] offset:1024
    ds_write_b128 v20, v[32:35]
    s_waitcnt lgkmcnt(0)
Ls_gdone:
    s_barrier
    ds_read_b128 v[24:27], v19 offset:0
    ds_read_b128 v[28:31], v19 offset:1024
    ds_read_b128 v[32:35], v19 offset:2048
    s_waitcnt lgkmcnt(2)
    v_smfmac_f32_16x16x64_bf16 v[40:43], v[24:27], a[0:7], v2
    v_smfmac_f32_16x16x64_bf16 v[48:51], v[24:27], a[144:151], v2
    ds_read_b128 v[36:39], v19 offset:3072
    v_smfmac_f32_16x16x64_bf16 v[44:47], v[24:27], a[8:15], v2
    v_smfmac_f32_16x16x64_bf16 v[52:55], v[24:27], a[152:159], v2
    s_waitcnt lgkmcnt(2)
    v_smfmac_f32_16x16x64_bf16 v[40:43], v[28:31], a[16:23], v2
    v_smfmac_f32_16x16x64_bf16 v[48:51], v[28:31], a[160:167], v2
    ds_read_b128 v[24:27], v19 offset:4096
    v_smfmac_f32_16x16x64_bf16 v[44:47], v[28:31], a[24:31], v2
    buffer_load_dwordx4 v[64:67], v13, s[8:11], s50 offen sc1
    v_smfmac_f32_16x16x64_bf16 v[52:55], v[28:31], a[168:175], v2
    s_waitcnt lgkmcnt(2)
    v_smfmac_f32_16x16x64_bf16 v[40:43], v[32:35], a[32:39], v2
    v_smfmac_f32_16x16x64_bf16 v[48:51], v[32:35], a[176:183], v2
    ds_read_b128 v[28:31], v19 offset:5120
    v_smfmac_f32_16x16x64_bf16 v[44:47], v[32:35], a[40:47], v2
    buffer_load_dwordx4 v[68:71], v13, s[8:11], s50 offen offset:256 sc1
    v_smfmac_f32_16x16x64_bf16 v[52:55], v[32:35], a[184:191], v2
    s_waitcnt lgkmcnt(2)
    v_smfmac_f32_16x16x64_bf16 v[40:43], v[36:39], a[48:55], v2
    v_smfmac_f32_16x16x64_bf16 v[48:51], v[36:39], a[192:199], v2
    ds_read_b128 v[32:35], v19 offset:6144
    v_smfmac_f32_16x16x64_bf16 v[44:47], v[36:39], a[56:63], v2
    v_smfmac_f32_16x16x64_bf16 v[52:55], v[36:39], a[200:207], v2
    s_waitcnt lgkmcnt(2)
    v_smfmac_f32_16x16x64_bf16 v[40:43], v[24:27], a[64:71], v2
    v_smfmac_f32_16x16x64_bf16 v[48:51], v[24:27], a[208:215], v2
    ds_read_b128 v[36:39], v19 offset:7168
    v_smfmac_f32_16x16x64_bf16 v[44:47], v[24:27], a[72:79], v2
    buffer_load_dwordx4 v[72:75], v13, s[8:11], s51 offen sc1
    v_smfmac_f32_16x16x64_bf16 v[52:55], v[24:27], a[216:223], v2
    s_waitcnt lgkmcnt(2)
    v_smfmac_f32_16x16x64_bf16 v[40:43], v[28:31], a[80:87], v2
    v_smfmac_f32_16x16x64_bf16 v[48:51], v[28:31], a[224:231], v2
    ds_read_b128 v[24:27], v19 offset:8192
    v_smfmac_f32_16x16x64_bf16 v[44:47], v[28:31], a[88:95], v2
    buffer_load_dwordx4 v[76:79], v13, s[8:11], s51 offen offset:256 sc1
    v_smfmac_f32_16x16x64_bf16 v[52:55], v[28:31], a[232:239], v2
    s_waitcnt lgkmcnt(2)
    v_smfmac_f32_16x16x64_bf16 v[40:43], v[32:35], a[96:103], v2
    v_smfmac_f32_16x16x64_bf16 v[48:51], v[32:35], a[240:247], v2
    v_smfmac_f32_16x16x64_bf16 v[44:47], v[32:35], a[104:111], v2
    v_smfmac_f32_16x16x64_bf16 v[52:55], v[32:35], a[248:255], v2
    s_waitcnt lgkmcnt(1)
    v_smfmac_f32_16x16x64_bf16 v[40:43], v[36:39], a[112:119], v2
    v_smfmac_f32_16x16x64_bf16 v[48:51], v[36:39], v[80:87], v2
    v_smfmac_f32_16x16x64_bf16 v[44:47], v[36:39], a[120:127], v2
    v_smfmac_f32_16x16x64_bf16 v[52:55], v[36:39], v[88:95], v2
    s_waitcnt lgkmcnt(0)
    v_smfmac_f32_16x16x64_bf16 v[40:43], v[24:27], a[128:135], v2
    v_smfmac_f32_16x16x64_bf16 v[48:51], v[24:27], v[96:103], v2
    v_smfmac_f32_16x16x64_bf16 v[44:47], v[24:27], a[136:143], v2
    v_smfmac_f32_16x16x64_bf16 v[52:55], v[24:27], v[104:111], v2
    s_cmp_eq_u32 s20, 3
    s_cbranch_scc0 Ls_noio
    buffer_load_dword v0, v14, s[8:11], s52 offen sc1
    s_add_u32 s52, s52, 16777216
    buffer_load_dword v0, v14, s[8:11], s52 offen sc1
    s_mov_b64 exec, 6
    v_lshrrev_b32 v20, 2, v1
    buffer_load_dword v0, v20, s[8:11], s6 offen sc1
    s_mov_b64 exec, 1
    v_mov_b32 v21, 1
    buffer_store_dword v21, off, s[8:11], s5 sc1
    s_mov_b64 exec, -1
Ls_noio:
    v_smfmac_f32_16x16x64_bf16 v[56:59], v[28:31], v[192:199], v2
    v_smfmac_f32_16x16x64_bf16 v[60:63], v[28:31], v[200:207], v2
    s_nop 2
    v_pk_add_f32 v[40:41], v[40:41], v[42:43]
    v_pk_add_f32 v[48:49], v[48:49], v[50:51]
    v_cvt_pk_bf16_f32 v42, v40, v41
    v_cvt_pk_bf16_f32 v43, v48, v49
    v_pk_add_f32 v[44:45], v[44:45], v[46:47]
    v_pk_add_f32 v[52:53], v[52:53], v[54:55]
    ds_write2_b32 v6, v42, v43 offset0:0 offset1:4
    v_cvt_pk_bf16_f32 v46, v44, v45
    v_cvt_pk_bf16_f32 v47, v52, v53
    ds_write2_b32 v6, v46, v47 offset0:160 offset1:164
    v_smfmac_f32_16x16x64_bf16 v[56:59], v[32:35], v[208:215], v2
    v_smfmac_f32_16x16x64_bf16 v[60:63], v[32:35], v[216:223], v2
    ds_read_b128 v[28:31], v19 offset:0
    v_smfmac_f32_16x16x64_bf16 v[56:59], v[36:39], v[224:231], v2
    s_waitcnt lgkmcnt(1)
    ds_read_b64_tr_b16 v[40:41], v7
    ds_read_b64_tr_b16 v[42:43], v7 offset:320
    v_smfmac_f32_16x16x64_bf16 v[60:63], v[36:39], v[232:239], v2
    ds_read_b128 v[32:35], v19 offset:1024
    v_smfmac_f32_16x16x64_bf16 v[56:59], v[24:27], v[240:247], v2
    v_smfmac_f32_16x16x64_bf16 v[60:63], v[24:27], v[248:255], v2
    ds_read_b128 v[36:39], v19 offset:2048
    s_cmp_eq_u32 s20, 3
    s_waitcnt lgkmcnt(2) vmcnt(6)
    s_cbranch_scc1 Ls_kw
    s_waitcnt vmcnt(2)
Ls_kw:
    v_mfma_f32_16x16x32_bf16 v[52:55], v[40:43], v[40:43], 0
    v_mfma_f32_16x16x32_bf16 v[44:47], v[64:67], v[40:43], 0
    v_mfma_f32_16x16x32_bf16 v[48:51], v[68:71], v[40:43], 0
    ds_read_b128 v[24:27], v19 offset:3072
    v_smfmac_f32_16x16x64_bf16 v[56:59], v[28:31], v[112:119], v2
    v_smfmac_f32_16x16x64_bf16 v[60:63], v[28:31], v[120:127], v2
    s_nop 2
    s_mov_b64 exec, s[34:35]
    ds_write_b128 v9, v[52:55]
    s_mov_b64 exec, s[30:31]
    ds_write_b128 v8, v[44:47]
    ds_write_b128 v8, v[48:51] offset:128
    s_mov_b64 exec, -1
    s_waitcnt lgkmcnt(3)
    v_smfmac_f32_16x16x64_bf16 v[56:59], v[32:35], v[128:135], v2
    v_smfmac_f32_16x16x64_bf16 v[60:63], v[32:35], v[136:143], v2
    s_not_b64 exec, s[30:31]
    buffer_store_dwordx4 v[40:43], v1, s[8:11], s53 offen sc1
    s_mov_b64 exec, -1
    ds_read_b128 v[28:31], v19 offset:4096
    v_smfmac_f32_16x16x64_bf16 v[56:59], v[36:39], v[144:151], v2
    v_smfmac_f32_16x16x64_bf16 v[60:63], v[36:39], v[152:159], v2
    s_waitcnt lgkmcnt(1)
    s_barrier
    ds_read_b128 v[64:67], v19 offset:11776
    ds_read_b128 v[68:71], v19 offset:13056
    ds_read_b64 v[40:41], v10 offset:0
    ds_read_b64 v[42:43], v10 offset:1280
    v_smfmac_f32_16x16x64_bf16 v[56:59], v[24:27], v[160:167], v2
    v_smfmac_f32_16x16x64_bf16 v[60:63], v[24:27], v[168:175], v2
    ds_read_b128 v[32:35], v19 offset:9216
    ds_read_b128 v[36:39], v19 offset:10496
    ds_read_b64 v[44:45], v10 offset:2560
    ds_read_b64 v[46:47], v10 offset:3840
    s_waitcnt lgkmcnt(8)
    v_smfmac_f32_16x16x64_bf16 v[56:59], v[28:31], v[176:183], v2
    v_smfmac_f32_16x16x64_bf16 v[60:63], v[28:31], v[184:191], v2
    s_cmp_eq_u32 s22, 63
    s_waitcnt lgkmcnt(4)
    v_pk_add_f32 v[64:65], v[64:65], v[68:69]
    v_pk_add_f32 v[66:67], v[66:67], v[70:71]
    v_pk_add_f32 v[40:41], v[40:41], v[42:43]
    s_waitcnt lgkmcnt(0)
    v_pk_add_f32 v[32:33], v[32:33], v[36:37]
    v_pk_add_f32 v[34:35], v[34:35], v[38:39]
    v_pk_add_f32 v[44:45], v[44:45], v[46:47]
    v_pk_add_f32 v[32:33], v[32:33], v[64:65]
    v_pk_add_f32 v[34:35], v[34:35], v[66:67]
    v_pk_add_f32 v[40:41], v[40:41], v[44:45]
    v_max3_f32 v20, v32, v33, v34
    v_max3_f32 v21, v35, v40, v41
    v_max_f32 v20, v20, v21
    v_pk_add_f32 v[60:61], v[60:61], v[62:63]
    v_pk_add_f32 v[56:57], v[56:57], v[58:59]
    v_max_f32_dpp v20, v20, v20 row_ror:8 row_mask:0xf bank_mask:0xf
    v_cvt_pk_bf16_f32 v58, v60, v61
    v_mov_b32 v21, v20
    v_cvt_pk_bf16_f32 v56, v56, v57
    v_mov_b32 v57, 0
    v_permlane16_swap_b32 v20, v21
    v_max_f32 v20, v20, v21
    v_mov_b32 v21, v20
    v_mov_b32 v59, 0
    v_mov_b32 v43, 0
    v_permlane32_swap_b32 v20, v21
    v_max_f32 v20, v20, v21
    v_mul_f32 v20, s54, v20
    s_cbranch_scc1 Ls_last
    v_pk_fma_f32 v[32:33], v[32:33], s[54:55], v[20:21] op_sel_hi:[1,1,0] neg_lo:[0,0,1] neg_hi:[0,0,1]
    v_pk_fma_f32 v[34:35], v[34:35], s[54:55], v[20:21] op_sel_hi:[1,1,0] neg_lo:[0,0,1] neg_hi:[0,0,1]
    v_pk_fma_f32 v[40:41], v[40:41], s[54:55], v[20:21] op_sel_hi:[1,1,0] neg_lo:[0,0,1] neg_hi:[0,0,1]
    v_exp_f32 v32, v32
    v_exp_f32 v33, v33
    ds_read_b128 v[64:67], v18 offset:8192
    ds_read_b128 v[68:71], v18 offset:17408
    v_exp_f32 v34, v34
    v_exp_f32 v35, v35
    v_mov_b32 v52, 0x3f803f80
    v_cvt_pk_bf16_f32 v36, v32, v33
    v_exp_f32 v40, v40
    v_cvt_pk_bf16_f32 v37, v34, v35
    v_exp_f32 v41, v41
    v_mov_b32 v53, 0x3f803f80
    v_mov_b32_dpp v38, v36 row_ror:8 row_mask:0xf bank_mask:0xf
    v_mov_b32_dpp v39, v37 row_ror:8 row_mask:0xf bank_mask:0xf
    v_mov_b32 v54, 0x3f803f80
    v_mov_b32 v55, 0x3f803f80
    v_cvt_pk_bf16_f32 v42, v40, v41
    v_mov_b32 v48, 0x3f803f80
    v_mov_b32 v49, 0
    s_cmp_eq_u32 s20, 3
    s_waitcnt vmcnt(5)
    s_cbranch_scc1 Ls_vw
    s_waitcnt vmcnt(1)
Ls_vw:
    v_mfma_f32_16x16x32_bf16 v[24:27], v[52:55], v[36:39], 0
    v_mfma_f32_16x16x32_bf16 v[44:47], v[72:75], v[36:39], 0
    v_mfma_f32_16x16x32_bf16 v[28:31], v[76:79], v[36:39], 0
    buffer_store_dwordx4 v[56:59], v1, s[8:11], s56 offen sc1
    s_nop 2
    v_mfma_f32_16x16x16_bf16 v[24:27], v[48:49], v[42:43], v[24:27]
    v_mfma_f32_16x16x16_bf16 v[44:47], v[56:57], v[42:43], v[44:47]
    v_mfma_f32_16x16x16_bf16 v[28:31], v[58:59], v[42:43], v[28:31]
    ds_read_b128 v[72:75], v18 offset:26624
    ds_read_b128 v[76:79], v18 offset:35840
    ds_read_b128 v[32:35], v18 offset:18432
    s_nop 2
    v_rcp_f32 v20, v24
    ds_read_b128 v[36:39], v18 offset:27648
    v_pk_mul_f32 v[44:45], v[44:45], v[20:21] op_sel_hi:[1,0]
    v_pk_mul_f32 v[46:47], v[46:47], v[20:21] op_sel_hi:[1,0]
    v_pk_mul_f32 v[28:29], v[28:29], v[20:21] op_sel_hi:[1,0]
    v_pk_mul_f32 v[30:31], v[30:31], v[20:21] op_sel_hi:[1,0]
    v_cvt_pk_bf16_f32 v44, v44, v45
    v_cvt_pk_bf16_f32 v45, v46, v47
    v_cvt_pk_bf16_f32 v28, v28, v29
    v_cvt_pk_bf16_f32 v29, v30, v31
    s_mov_b64 exec, s[30:31]
    ds_write_b64 v11, v[44:45]
    ds_write_b64 v11, v[28:29] offset:256
    s_mov_b64 exec, -1
    v_mov_b64 v[40:41], 0
    v_mov_b64 v[42:43], 0
    v_mov_b64 v[52:53], 0
    v_mov_b64 v[54:55], 0
    s_waitcnt lgkmcnt(0)
    ds_read_b128 v[24:27], v18 offset:0
    ds_read_b128 v[28:31], v18 offset:9216
    s_barrier
    ds_read_b128 v[44:47], v19
    ds_read_b128 v[48:51], v19 offset:1024
    s_waitcnt lgkmcnt(0)
    s_nop 0
    v_smfmac_f32_16x16x64_bf16 v[40:43], v[44:47], v[64:71], v2
    v_smfmac_f32_16x16x64_bf16 v[40:43], v[48:51], v[72:79], v2
    ds_read_b128 v[64:67], v18 offset:1024
    ds_read_b128 v[68:71], v18 offset:10240
    s_nop 0
    v_smfmac_f32_16x16x64_bf16 v[52:55], v[44:47], v[24:31], v2
    ds_read_b128 v[72:75], v18 offset:19456
    ds_read_b128 v[76:79], v18 offset:28672
    v_smfmac_f32_16x16x64_bf16 v[52:55], v[48:51], v[32:39], v2
    ds_read_b128 v[24:27], v18 offset:2048
    ds_read_b128 v[28:31], v18 offset:11264
    v_pk_add_f32 v[40:41], v[40:41], v[42:43]
    v_cvt_pk_bf16_f32 v56, v40, v41
    v_mov_b64 v[40:41], 0
    v_mov_b64 v[42:43], 0
    v_mov_b32 v57, v56
    s_waitcnt lgkmcnt(2)
    v_smfmac_f32_16x16x64_bf16 v[40:43], v[44:47], v[64:71], v2
    ds_read_b128 v[32:35], v18 offset:20480
    ds_read_b128 v[36:39], v18 offset:29696
    v_smfmac_f32_16x16x64_bf16 v[40:43], v[48:51], v[72:79], v2
    ds_read_b128 v[64:67], v18 offset:3072
    ds_read_b128 v[68:71], v18 offset:12288
    v_pk_add_f32 v[52:53], v[52:53], v[54:55]
    v_cvt_pk_bf16_f32 v20, v52, v53
    v_mov_b64 v[52:53], 0
    v_mov_b64 v[54:55], 0
    v_permlane16_swap_b32 v56, v57
    v_mov_b32 v58, v56
    v_mov_b32 v59, v57
    s_waitcnt lgkmcnt(2)
    v_smfmac_f32_16x16x64_bf16 v[52:55], v[44:47], v[24:31], v2
    ds_read_b128 v[72:75], v18 offset:21504
    ds_read_b128 v[76:79], v18 offset:30720
    v_smfmac_f32_16x16x64_bf16 v[52:55], v[48:51], v[32:39], v2
    ds_read_b128 v[24:27], v18 offset:4096
    ds_read_b128 v[28:31], v18 offset:13312
    v_pk_add_f32 v[40:41], v[40:41], v[42:43]
    v_cvt_pk_bf16_f32 v21, v40, v41
    v_mov_b64 v[40:41], 0
    v_mov_b64 v[42:43], 0
    v_permlane32_swap_b32 v56, v58
    v_permlane32_swap_b32 v57, v59
    s_mov_b64 exec, 0xffff
    buffer_store_dwordx4 v[56:59], v3, s[8:11], s60 offen sc1
    s_mov_b64 exec, -1
    s_waitcnt lgkmcnt(2)
    v_smfmac_f32_16x16x64_bf16 v[40:43], v[44:47], v[64:71], v2
    ds_read_b128 v[32:35], v18 offset:22528
    ds_read_b128 v[36:39], v18 offset:31744
    v_smfmac_f32_16x16x64_bf16 v[40:43], v[48:51], v[72:79], v2
    ds_read_b128 v[64:67], v18 offset:5120
    ds_read_b128 v[68:71], v18 offset:14336
    v_pk_add_f32 v[52:53], v[52:53], v[54:55]
    v_cvt_pk_bf16_f32 v22, v52, v53
    v_mov_b64 v[52:53], 0
    v_mov_b64 v[54:55], 0
    s_nop 0
    ds_read_b128 v[56:59], v18 offset:23552
    ds_read_b128 v[60:63], v18 offset:32768
    s_waitcnt lgkmcnt(4)
    v_smfmac_f32_16x16x64_bf16 v[52:55], v[44:47], v[24:31], v2
    ds_read_b128 v[72:75], v18 offset:6144
    ds_read_b128 v[76:79], v18 offset:15360
    v_smfmac_f32_16x16x64_bf16 v[52:55], v[48:51], v[32:39], v2
    ds_read_b128 v[24:27], v18 offset:24576
    ds_read_b128 v[28:31], v18 offset:33792
    v_pk_add_f32 v[40:41], v[40:41], v[42:43]
    v_cvt_pk_bf16_f32 v23, v40, v41
    v_mov_b64 v[40:41], 0
    v_mov_b64 v[42:43], 0
    buffer_store_dwordx4 v[20:23], v3, s[8:11], s58 offen sc1
    s_waitcnt lgkmcnt(4)
    v_smfmac_f32_16x16x64_bf16 v[40:43], v[44:47], v[64:71], v2
    ds_read_b128 v[32:35], v18 offset:7168
    ds_read_b128 v[36:39], v18 offset:16384
    v_smfmac_f32_16x16x64_bf16 v[40:43], v[48:51], v[56:63], v2
    ds_read_b128 v[64:67], v18 offset:25600
    ds_read_b128 v[68:71], v18 offset:34816
    v_pk_add_f32 v[52:53], v[52:53], v[54:55]
    v_cvt_pk_bf16_f32 v20, v52, v53
    v_mov_b64 v[52:53], 0
    v_mov_b64 v[54:55], 0
    s_nop 0
    s_waitcnt lgkmcnt(4)
    v_smfmac_f32_16x16x64_bf16 v[52:55], v[44:47], v[72:79], v2
    v_smfmac_f32_16x16x64_bf16 v[52:55], v[48:51], v[24:31], v2
    s_nop 3
    v_pk_add_f32 v[40:41], v[40:41], v[42:43]
    v_cvt_pk_bf16_f32 v21, v40, v41
    v_mov_b64 v[40:41], 0
    v_mov_b64 v[42:43], 0
    s_nop 0
    s_waitcnt lgkmcnt(0)
    v_smfmac_f32_16x16x64_bf16 v[40:43], v[44:47], v[32:39], v2
    v_smfmac_f32_16x16x64_bf16 v[40:43], v[48:51], v[64:71], v2
    s_nop 3
    v_pk_add_f32 v[52:53], v[52:53], v[54:55]
    v_cvt_pk_bf16_f32 v22, v52, v53
    s_nop 4
    v_pk_add_f32 v[40:41], v[40:41], v[42:43]
    v_cvt_pk_bf16_f32 v23, v40, v41
    buffer_store_dwordx4 v[20:23], v3, s[8:11], s59 offen sc1
    s_cmp_eq_u32 s23, 0
    s_cbranch_scc0 Ls_red
    s_mov_b32 s98, s28
    s_add_u32 s99, s28, 4096
    s_mov_b32 s97, s6
    s_mov_b32 s36, s28
    s_mov_b32 s28, s26
    s_mov_b32 s26, s27
    s_mov_b32 s27, s36
    s_mov_b32 s36, s29
    s_mov_b32 s29, s42
    s_mov_b32 s42, s43
    s_mov_b32 s43, s36
    s_add_u32 s45, s45, 262144
    s_add_u32 s46, s46, 131072
    s_add_u32 s22, s22, 1
    s_lshl_b32 s36, s20, 10
    s_lshl_b32 s47, s20, 11
    s_add_u32 s47, s47, s29
    s_add_u32 s49, s29, s36
    s_add_u32 s49, s49, 6144
    s_add_u32 s50, s45, 23068672
    s_add_u32 s51, s45, 39845888
    s_add_u32 s53, s46, s36
    s_add_u32 s56, s53, 65011712
    s_add_u32 s53, s53, 56623104
    s_add_u32 s52, s50, 262144
    s_add_u32 s37, s22, 2
    s_min_u32 s37, s37, 63
    s_lshl_b32 s37, s37, 9
    s_lshl_b32 s38, s21, 4
    s_add_u32 s6, s37, s38
    s_add_u32 s6, s6, 6029312
    s_lshl_b32 s37, s22, 9
    s_add_u32 s5, s37, s38
    s_add_u32 s5, s5, 6061568
    s_cmp_eq_u32 s22, 0
    s_cselect_b32 s5, 6131712, s5
    s_lshl_b32 s37, s20, 16
    s_add_u32 s58, s26, s37
    s_add_u32 s59, s58, 32768
    s_lshl_b32 s37, s20, 13
    s_add_u32 s60, s26, s37
    s_add_u32 s60, s60, 262144
    v_mov_b64 v[56:57], 0
    v_mov_b64 v[58:59], 0
    v_mov_b64 v[60:61], 0
    v_mov_b64 v[62:63], 0
    s_cmp_lg_u32 s20, 3
    s_cbranch_scc1 Ls_kvok
    s_waitcnt vmcnt(6)
    s_mov_b64 exec, 6
Ls_kvlp:
    v_cmp_eq_u32 vcc, 0, v0
    s_cbranch_vccz Ls_kvok
    s_add_u32 s44, s44, 1
    s_cmp_gt_u32 s44, 3000000
    s_cbranch_scc1 L_tfail
    v_lshrrev_b32 v21, 2, v1
    buffer_load_dword v0, v21, s[8:11], s97 offen sc1
    s_waitcnt vmcnt(0)
    s_branch Ls_kvlp
Ls_kvok:
    s_mov_b64 exec, -1
    s_cmp_eq_u32 s25, 0
    s_cbranch_scc1 Ls_norst
    s_sleep 5
    v_mov_b32 v20, -1
    v_mov_b32 v21, -1
    v_mov_b32 v22, -1
    v_mov_b32 v23, -1
    buffer_store_dwordx4 v[20:23], v4, s[8:11], s98 offen offset:0 sc1
    buffer_store_dwordx4 v[20:23], v4, s[8:11], s98 offen offset:1024 sc1
    buffer_store_dwordx4 v[20:23], v4, s[8:11], s98 offen offset:2048 sc1
    buffer_store_dwordx4 v[20:23], v4, s[8:11], s98 offen offset:3072 sc1
    buffer_store_dwordx4 v[20:23], v4, s[8:11], s99 offen offset:0 sc1
    buffer_store_dwordx4 v[20:23], v4, s[8:11], s99 offen offset:1024 sc1
    buffer_store_dwordx4 v[20:23], v4, s[8:11], s99 offen offset:2048 sc1
    buffer_store_dwordx4 v[20:23], v4, s[8:11], s99 offen offset:3072 sc1
    s_sleep 8
    s_sleep 8
    s_sleep 1
    s_nop 7
    s_branch Ls_nored
Ls_norst:
    s_sleep 8
    s_sleep 8
    s_sleep 8
    s_sleep 1
    s_branch Ls_nored
Ls_red:
    s_mov_b32 s94, s26
    s_add_u32 s95, s26, 4096
    s_mov_b32 s96, s42
    s_mov_b32 s97, s43
    s_cmp_eq_u32 s7, 0
    s_cbranch_scc0 Ls_early
    v_mov_b32 v22, -1
    v_mov_b32 v23, -1
    s_mov_b64 exec, s[30:31]
    buffer_store_dwordx2 v[22:23], v5, s[8:11], s97 offen sc1
    s_mov_b64 exec, -1
    s_mov_b32 s36, s28
    s_mov_b32 s28, s26
    s_mov_b32 s26, s27
    s_mov_b32 s27, s36
    s_mov_b32 s36, s29
    s_mov_b32 s29, s42
    s_mov_b32 s42, s43
    s_mov_b32 s43, s36
    s_add_u32 s45, s45, 262144
    s_add_u32 s46, s46, 131072
    s_add_u32 s22, s22, 1
    s_lshl_b32 s36, s20, 10
    s_lshl_b32 s47, s20, 11
    s_add_u32 s47, s47, s29
    s_add_u32 s49, s29, s36
    s_add_u32 s49, s49, 6144
    s_add_u32 s50, s45, 23068672
    s_add_u32 s51, s45, 39845888
    s_add_u32 s53, s46, s36
    s_add_u32 s56, s53, 65011712
    s_add_u32 s53, s53, 56623104
    s_add_u32 s52, s50, 262144
    s_add_u32 s37, s22, 2
    s_min_u32 s37, s37, 63
    s_lshl_b32 s37, s37, 9
    s_lshl_b32 s38, s21, 4
    s_add_u32 s6, s37, s38
    s_add_u32 s6, s6, 6029312
    s_lshl_b32 s37, s22, 9
    s_add_u32 s5, s37, s38
    s_add_u32 s5, s5, 6061568
    s_cmp_eq_u32 s22, 0
    s_cselect_b32 s5, 6131712, s5
    s_lshl_b32 s37, s20, 16
    s_add_u32 s58, s26, s37
    s_add_u32 s59, s58, 32768
    s_lshl_b32 s37, s20, 13
    s_add_u32 s60, s26, s37
    s_add_u32 s60, s60, 262144
    v_mov_b64 v[56:57], 0
    v_mov_b64 v[58:59], 0
    v_mov_b64 v[60:61], 0
    v_mov_b64 v[62:63], 0
    s_sleep 8
    s_sleep 1
    s_nop 5
Ls_rl:
    buffer_load_dwordx4 v[24:27], v4, s[8:11], s94 offen offset:0 sc1
    buffer_load_dwordx4 v[28:31], v4, s[8:11], s94 offen offset:1024 sc1
    buffer_load_dwordx4 v[32:35], v4, s[8:11], s94 offen offset:2048 sc1
    buffer_load_dwordx4 v[36:39], v4, s[8:11], s94 offen offset:3072 sc1
    buffer_load_dwordx4 v[40:43], v4, s[8:11], s95 offen offset:0 sc1
    buffer_load_dwordx4 v[44:47], v4, s[8:11], s95 offen offset:1024 sc1
    buffer_load_dwordx4 v[48:51], v4, s[8:11], s95 offen offset:2048 sc1
    buffer_load_dwordx4 v[52:55], v4, s[8:11], s95 offen offset:3072 sc1
    s_add_u32 s44, s44, 1
    s_cmp_gt_u32 s44, 3000000
    s_cbranch_scc1 L_tfail
    s_waitcnt vmcnt(7)
    v_mfma_f32_16x16x32_bf16 v[64:67], v[24:27], v[14:17], 0
    v_max3_u32 v20, v24, v25, v26
    v_max_u32 v20, v20, v27
    s_waitcnt vmcnt(6)
    v_mfma_f32_16x16x32_bf16 v[64:67], v[28:31], v[14:17], v[64:67]
    v_max3_u32 v20, v20, v28, v29
    v_max3_u32 v20, v20, v30, v31
    s_waitcnt vmcnt(5)
    v_mfma_f32_16x16x32_bf16 v[64:67], v[32:35], v[14:17], v[64:67]
    v_max3_u32 v20, v20, v32, v33
    v_max3_u32 v20, v20, v34, v35
    s_waitcnt vmcnt(4)
    v_mfma_f32_16x16x32_bf16 v[64:67], v[36:39], v[14:17], v[64:67]
    v_max3_u32 v20, v20, v36, v37
    v_max3_u32 v20, v20, v38, v39
    s_waitcnt vmcnt(3)
    v_mfma_f32_16x16x32_bf16 v[64:67], v[40:43], v[14:17], v[64:67]
    v_max3_u32 v20, v20, v40, v41
    v_max3_u32 v20, v20, v42, v43
    s_waitcnt vmcnt(2)
    v_mfma_f32_16x16x32_bf16 v[64:67], v[44:47], v[14:17], v[64:67]
    v_max3_u32 v20, v20, v44, v45
    v_max3_u32 v20, v20, v46, v47
    s_waitcnt vmcnt(1)
    v_mfma_f32_16x16x32_bf16 v[64:67], v[48:51], v[14:17], v[64:67]
    v_max3_u32 v20, v20, v48, v49
    v_max3_u32 v20, v20, v50, v51
    s_waitcnt vmcnt(0)
    v_mfma_f32_16x16x32_bf16 v[64:67], v[52:55], v[14:17], v[64:67]
    v_max3_u32 v20, v20, v52, v53
    v_max3_u32 v20, v20, v54, v55
    v_cmp_eq_u32 vcc, -1, v20
    s_cbranch_vccnz Ls_rl
Ls_rok:
    s_nop 3
    v_cvt_pk_bf16_f32 v64, v64, v65
    v_cvt_pk_bf16_f32 v65, v66, v67
    s_mov_b64 exec, s[30:31]
    buffer_store_dwordx2 v[64:65], v5, s[8:11], s96 offen sc1
    s_mov_b64 exec, -1
Ls_nored:
    s_mul_i32 s36, s20, 4294966016
    s_add_u32 s36, s36, 6912
    v_add_u32 v20, s36, v12
    s_cmp_lg_u32 s20, 2
    s_cbranch_scc1 Ls_g3n
    v_lshrrev_b32 v20, 8, v1
    v_mul_u32_u24 v20, 2048, v20
    s_mov_b32 s41, 2048
    v_add3_u32 v20, v20, v19, s41
Ls_g3n:
    v_mov_b64 v[40:41], 0
    v_mov_b64 v[42:43], 0
    v_mov_b64 v[44:45], 0
    v_mov_b64 v[46:47], 0
    v_mov_b64 v[48:49], 0
    v_mov_b64 v[50:51], 0
    v_mov_b64 v[52:53], 0
    v_mov_b64 v[54:55], 0
    s_barrier
    s_branch Ls_step
Ls_last:
    buffer_store_dwordx4 v[56:59], v1, s[8:11], s56 offen sc1
    s_branch L_tdone
Ls_early:
    buffer_load_dwordx4 v[24:27], v4, s[8:11], s94 offen offset:0 sc1
    buffer_load_dwordx4 v[28:31], v4, s[8:11], s94 offen offset:1024 sc1
    buffer_load_dwordx4 v[32:35], v4, s[8:11], s94 offen offset:2048 sc1
    buffer_load_dwordx4 v[36:39], v4, s[8:11], s94 offen offset:3072 sc1
    buffer_load_dwordx4 v[40:43], v4, s[8:11], s95 offen offset:0 sc1
    buffer_load_dwordx4 v[44:47], v4, s[8:11], s95 offen offset:1024 sc1
    buffer_load_dwordx4 v[48:51], v4, s[8:11], s95 offen offset:2048 sc1
    buffer_load_dwordx4 v[52:55], v4, s[8:11], s95 offen offset:3072 sc1
    v_mov_b32 v22, -1
    v_mov_b32 v23, -1
    s_mov_b64 exec, s[30:31]
    buffer_store_dwordx2 v[22:23], v5, s[8:11], s97 offen sc1
    s_mov_b64 exec, -1
    s_mov_b32 s36, s28
    s_mov_b32 s28, s26
    s_mov_b32 s26, s27
    s_mov_b32 s27, s36
    s_mov_b32 s36, s29
    s_mov_b32 s29, s42
    s_mov_b32 s42, s43
    s_mov_b32 s43, s36
    s_add_u32 s45, s45, 262144
    s_add_u32 s46, s46, 131072
    s_add_u32 s22, s22, 1
    s_lshl_b32 s36, s20, 10
    s_lshl_b32 s47, s20, 11
    s_add_u32 s47, s47, s29
    s_add_u32 s49, s29, s36
    s_add_u32 s49, s49, 6144
    s_add_u32 s50, s45, 23068672
    s_add_u32 s51, s45, 39845888
    s_add_u32 s53, s46, s36
    s_add_u32 s56, s53, 65011712
    s_add_u32 s53, s53, 56623104
    s_add_u32 s52, s50, 262144
    s_add_u32 s37, s22, 2
    s_min_u32 s37, s37, 63
    s_lshl_b32 s37, s37, 9
    s_lshl_b32 s38, s21, 4
    s_add_u32 s6, s37, s38
    s_add_u32 s6, s6, 6029312
    s_lshl_b32 s37, s22, 9
    s_add_u32 s5, s37, s38
    s_add_u32 s5, s5, 6061568
    s_cmp_eq_u32 s22, 0
    s_cselect_b32 s5, 6131712, s5
    s_lshl_b32 s37, s20, 16
    s_add_u32 s58, s26, s37
    s_add_u32 s59, s58, 32768
    s_lshl_b32 s37, s20, 13
    s_add_u32 s60, s26, s37
    s_add_u32 s60, s60, 262144
    v_mov_b64 v[56:57], 0
    v_mov_b64 v[58:59], 0
    v_mov_b64 v[60:61], 0
    v_mov_b64 v[62:63], 0
    s_waitcnt vmcnt(8)
    v_mfma_f32_16x16x32_bf16 v[64:67], v[24:27], v[14:17], 0
    v_max3_u32 v20, v24, v25, v26
    v_max_u32 v20, v20, v27
    s_waitcnt vmcnt(7)
    v_mfma_f32_16x16x32_bf16 v[64:67], v[28:31], v[14:17], v[64:67]
    v_max3_u32 v20, v20, v28, v29
    v_max3_u32 v20, v20, v30, v31
    s_waitcnt vmcnt(6)
    v_mfma_f32_16x16x32_bf16 v[64:67], v[32:35], v[14:17], v[64:67]
    v_max3_u32 v20, v20, v32, v33
    v_max3_u32 v20, v20, v34, v35
    s_waitcnt vmcnt(5)
    v_mfma_f32_16x16x32_bf16 v[64:67], v[36:39], v[14:17], v[64:67]
    v_max3_u32 v20, v20, v36, v37
    v_max3_u32 v20, v20, v38, v39
    s_waitcnt vmcnt(4)
    v_mfma_f32_16x16x32_bf16 v[64:67], v[40:43], v[14:17], v[64:67]
    v_max3_u32 v20, v20, v40, v41
    v_max3_u32 v20, v20, v42, v43
    s_waitcnt vmcnt(3)
    v_mfma_f32_16x16x32_bf16 v[64:67], v[44:47], v[14:17], v[64:67]
    v_max3_u32 v20, v20, v44, v45
    v_max3_u32 v20, v20, v46, v47
    s_waitcnt vmcnt(2)
    v_mfma_f32_16x16x32_bf16 v[64:67], v[48:51], v[14:17], v[64:67]
    v_max3_u32 v20, v20, v48, v49
    v_max3_u32 v20, v20, v50, v51
    s_waitcnt vmcnt(1)
    v_mfma_f32_16x16x32_bf16 v[64:67], v[52:55], v[14:17], v[64:67]
    v_max3_u32 v20, v20, v52, v53
    v_max3_u32 v20, v20, v54, v55
    v_cmp_eq_u32 vcc, -1, v20
    s_cbranch_vccnz Ls_rl
    s_branch Ls_rok
L_tdone:
    s_waitcnt vmcnt(0)
    s_barrier
    s_cmp_lg_u32 s20, 3
    s_cbranch_scc1 L_tfail
    s_lshl_b32 s36, s21, 4
    s_add_u32 s36, s36, 6093824
    s_mov_b64 exec, 1
    v_mov_b32 v20, 1
    buffer_store_dword v20, off, s[8:11], s36 sc1
    s_add_u32 s36, s36, 512
    buffer_store_dword v20, off, s[8:11], s36 sc1
    s_mov_b64 exec, -1
L_tfail:
L_end:
    s_waitcnt vmcnt(0)
L_exit:
    s_endpgm
.section .rodata,"a"
.p2align 6
.amdhsa_kernel sequential_preLN__memory_aug_recurrent_mem_tr__dense_activation_relu__prompt_kernel
  .amdhsa_next_free_vgpr 512
  .amdhsa_next_free_sgpr 102
  .amdhsa_accum_offset 256
  .amdhsa_group_segment_fixed_size 0
  .amdhsa_kernarg_size 104
  .amdhsa_user_sgpr_count 2
  .amdhsa_user_sgpr_kernarg_segment_ptr 1
  .amdhsa_system_sgpr_workgroup_id_x 1
.end_amdhsa_kernel
```
